```python
import torch

def _softmax(x, axis=-1):
    return torch.softmax(x, dim=axis)

def _gelu(x):
    return torch.nn.functional.gelu(x, approximate='tanh')

def _silu(x):
    return torch.nn.functional.silu(x)

def _sigmoid(x):
    return torch.sigmoid(x)

def _layernorm(x, axis=-1, eps=1e-05):
    m = x.mean(dim=axis, keepdim=True)
    v = x.var(dim=axis, keepdim=True, unbiased=False)
    return (x - m) / torch.sqrt(v + eps)

def _scatter_add(tgt, idx, src, axis=0):
    return tgt.clone().index_add_(axis, idx, src)

def _segment_sum(src, seg, n):
    out = torch.zeros((n,) + src.shape[1:], dtype=src.dtype)
    return out.index_add_(0, seg, src)

def _pad(x, pw):
    flat = tuple((v for pair in reversed(pw) for v in pair))
    return torch.nn.functional.pad(x, flat)
kernel_name = 'adaLN_cond__softmax_full_mha__glu_gated_geglu__prompt'

def setup_inputs():

    _w = lambda a: (lambda t: t.to(torch.bfloat16) if t.is_floating_point() else t)(torch.as_tensor(a))

    def _A_setup():
        B, S, D = (1, 2048, 448)
        return {'x': _w((lambda *s: torch.randn(*s, dtype=torch.bfloat16) * 0.05)(B, S, D)), 'wqkv': _w((lambda *s: torch.randn(*s, dtype=torch.bfloat16) * 0.05)(D, 3 * D)), 'wo': _w((lambda *s: torch.randn(*s, dtype=torch.bfloat16) * 0.05)(D, D))}
    _A_in = _A_setup()

    def _B_setup():
        B, S, Dm, Df = (1, 2048, 448, 1792)
        return {'x': _w((lambda *s: torch.randn(*s, dtype=torch.bfloat16) * 0.05)(B, S, Dm)), 'w_gate': _w((lambda *s: torch.randn(*s, dtype=torch.bfloat16) * 0.8)(Dm, Df) * Dm ** (-0.5)), 'w_up': _w((lambda *s: torch.randn(*s, dtype=torch.bfloat16) * 0.8)(Dm, Df) * Dm ** (-0.5)), 'w_down': _w((lambda *s: torch.randn(*s, dtype=torch.bfloat16) * 0.8)(Df, Dm) * Df ** (-0.5))}
    _B_in = _B_setup()
    return {'A_x': _A_in['x'], 'A_wqkv': _A_in['wqkv'], 'A_wo': _A_in['wo'], 'B_x': _B_in['x'], 'B_w_gate': _B_in['w_gate'], 'B_w_up': _B_in['w_up'], 'B_w_down': _B_in['w_down'], 'c': _w((lambda *s: torch.randn(*s, dtype=torch.bfloat16) * 0.1)(1, 448) * 8.0), 'w_mod': _w((lambda *s: torch.randn(*s, dtype=torch.bfloat16) * 0.1)(448, 6 * 448) * 448 ** (-0.5) * 8.0)}

def reference(A_x, A_wqkv, A_wo, B_x, B_w_gate, B_w_up, B_w_down, c, w_mod):

    def _A_ref(x, wqkv, wo):
        B, S, D = x.shape
        H = 16
        Dh = D // H
        qkv = (lambda x, *d: x.permute(*d))((x @ wqkv).reshape(B, S, 3, H, Dh), 2, 0, 3, 1, 4)
        q, k, v = (qkv[0], qkv[1], qkv[2])
        scale = Dh ** (-0.5)
        scores = torch.einsum('bhqd,bhkd->bhqk', q, k) * scale
        p = _softmax(scores, axis=-1)
        o = torch.einsum('bhqk,bhkd->bhqd', p, v)
        return (lambda x, *d: x.permute(*d))(o, 0, 2, 1, 3).reshape(B, S, D) @ wo

    def _B_ref(x, w_gate, w_up, w_down):
        g = torch.einsum('bsd,df->bsf', x, w_gate)
        u = torch.einsum('bsd,df->bsf', x, w_up)
        h = _gelu(g) * u
        return torch.einsum('bsf,fd->bsd', h, w_down)
    x = A_x
    mod = (_silu(c) @ w_mod).reshape(c.shape[0], 6, 1, -1)
    sa, ca, ga, sb, cb, gb = (mod[:, 0].clone(), mod[:, 1].clone(), mod[:, 2].clone(), mod[:, 3].clone(), mod[:, 4].clone(), mod[:, 5].clone())
    h = _layernorm(x, axis=-1) * (1 + ca) + sa
    x = x + ga * _A_ref(h, A_wqkv, A_wo)
    h = _layernorm(x, axis=-1) * (1 + cb) + sb
    x = x + gb * _B_ref(h, B_w_gate, B_w_up, B_w_down)
    return x
```

```asm
; @launch grid=(256,1,1) block=(256,1,1) lds=163840
.amdgcn_target "amdgcn-amd-amdhsa--gfx950"
.text
.globl adaLN_cond__softmax_full_mha__glu_gated_geglu__prompt_kernel
.p2align 8
.type adaLN_cond__softmax_full_mha__glu_gated_geglu__prompt_kernel,@function
adaLN_cond__softmax_full_mha__glu_gated_geglu__prompt_kernel:
s_cmp_ge_u32 s2, 256
s_cbranch_scc1 adaLN_cond__softmax_full_mha__glu_gated_geglu__prompt_kernel_exit
v_lshrrev_b32 v2, 6, v0
v_and_b32 v1, 63, v0
v_readfirstlane_b32 s3, v2
s_and_b32 s4, s2, 7
s_lshr_b32 s5, s2, 3
s_load_dwordx2 s[8:9], s[0:1], 88
s_mov_b32 s10, 32505856
s_mov_b32 s11, 131072
s_cmp_lg_u32 s3, 3
s_cbranch_scc1 cpf_1
s_getpc_b64 s[28:29]
cpf_pc_2:
s_sub_u32 s28, s28, (cpf_pc_2 - adaLN_cond__softmax_full_mha__glu_gated_geglu__prompt_kernel)
s_subb_u32 s29, s29, 0
s_mul_i32 s30, s5, 12
v_min_u32 v2, 11, v1
v_add_u32 v2, s30, v2
v_lshlrev_b32 v2, 7, v2
v_mov_b32 v3, s29
v_add_co_u32 v2, vcc, s28, v2
s_nop 1
v_addc_co_u32 v3, vcc, 0, v3, vcc
global_load_dword v191, v[2:3], off
cpf_1:
s_load_dwordx2 s[12:13], s[0:1], 0
s_mov_b32 s14, 1835008
s_mov_b32 s15, 131072
s_load_dwordx2 s[16:17], s[0:1], 8
s_mov_b32 s18, 1204224
s_mov_b32 s19, 131072
s_load_dwordx2 s[20:21], s[0:1], 56
s_mov_b32 s22, 896
s_mov_b32 s23, 131072
s_load_dwordx2 s[24:25], s[0:1], 64
s_mov_b32 s26, 2408448
s_mov_b32 s27, 131072
s_load_dwordx2 s[48:49], s[0:1], 80
s_mov_b32 s50, 256
s_mov_b32 s51, 131072
s_getreg_b32 s44, hwreg(HW_REG_XCC_ID, 0, 4)
s_waitcnt lgkmcnt(0)
s_lshl_b32 s45, s4, 2
s_lshr_b32 s28, s5, 3
s_add_u32 s45, s45, s28
s_and_b32 s28, s5, 7
s_cmp_eq_u32 s28, 0
s_cselect_b32 s45, s45, 99
s_and_b32 s6, s3, 1
s_lshr_b32 s7, s3, 1
s_lshr_b32 s28, s5, 3
s_lshl_b32 s28, s28, 6
s_lshl_b32 s29, s4, 8
s_add_u32 s89, s28, s29
s_and_b32 s90, s5, 7
s_cmp_lg_u32 s3, 0
s_cbranch_scc1 p0_5
s_or_b32 s28, s2, s3
s_cmp_lg_u32 s28, 0
s_cbranch_scc1 nonce_skip_7
s_memrealtime s[28:29]
s_waitcnt lgkmcnt(0)
s_lshl_b32 s28, s28, 4
s_or_b32 s28, s28, 0x80000000
v_mov_b32 v2, 0
v_mov_b32 v3, s28
s_mov_b64 exec, 1
buffer_store_dword v3, v2, s[48:51], 0 offen sc1
s_mov_b64 exec, -1
nonce_skip_7:
p0_5:
s_cmp_ge_u32 s45, 28
s_cbranch_scc1 p0_3
v_lshrrev_b32 v2, 2, v0
v_and_b32 v3, 3, v0
v_mul_u32_u24 v4, 5376, v2
v_lshl_add_u32 v4, v3, 4, v4
s_lshl_b32 s29, s45, 6
v_lshrrev_b32 v5, 1, v2
v_lshlrev_b32 v5, 2, v5
buffer_load_dword v72, v5, s[20:23], 0 offen offset:0
buffer_load_dword v73, v5, s[20:23], 0 offen offset:128
buffer_load_dword v74, v5, s[20:23], 0 offen offset:256
buffer_load_dword v75, v5, s[20:23], 0 offen offset:384
buffer_load_dword v76, v5, s[20:23], 0 offen offset:512
buffer_load_dword v77, v5, s[20:23], 0 offen offset:640
buffer_load_dword v78, v5, s[20:23], 0 offen offset:768
s_add_u32 s30, s29, 0
buffer_load_dwordx4 v[80:83], v4, s[24:27], s30 offen
s_add_u32 s30, s29, 344064
buffer_load_dwordx4 v[84:87], v4, s[24:27], s30 offen
s_add_u32 s30, s29, 688128
buffer_load_dwordx4 v[88:91], v4, s[24:27], s30 offen
s_add_u32 s30, s29, 1032192
buffer_load_dwordx4 v[92:95], v4, s[24:27], s30 offen
s_add_u32 s30, s29, 1376256
buffer_load_dwordx4 v[96:99], v4, s[24:27], s30 offen
s_add_u32 s30, s29, 1720320
buffer_load_dwordx4 v[100:103], v4, s[24:27], s30 offen
s_add_u32 s30, s29, 2064384
buffer_load_dwordx4 v[104:107], v4, s[24:27], s30 offen
p0_3:
s_mul_i32 s30, s89, 896
s_lshl_b32 s28, s3, 1
s_add_u32 s28, s28, 0
s_mul_i32 s29, s28, 7168
s_add_u32 s31, s29, s30
s_mov_b32 s36, 43008
s_cmp_lt_u32 s28, 3
s_cselect_b32 s36, s36, 86016
s_add_u32 s32, s29, s36
s_lshl_b32 s28, s3, 1
s_add_u32 s28, s28, 1
s_mul_i32 s29, s28, 7168
s_add_u32 s33, s29, s30
s_mov_b32 s36, 43008
s_cmp_lt_u32 s28, 3
s_cselect_b32 s36, s36, 86016
s_add_u32 s34, s29, s36
v_add_u32 v2, 0, v1
v_cmp_le_u32 vcc, 56, v2
v_subrev_u32 v3, 56, v2
s_nop 0
v_cndmask_b32 v2, v2, v3, vcc
v_mov_b32 v3, 0
v_addc_co_u32 v3, vcc, 0, v3, vcc
v_lshrrev_b32 v4, 1, v3
v_xor_b32 v2, v2, v4
v_lshlrev_b32 v2, 4, v2
v_mul_u32_u24 v3, 896, v3
v_xor_b32 v4, 64, v2
v_add_u32 v2, v2, v3
v_add_u32 v4, v4, v3
s_add_u32 m0, s32, 0
s_nop 0
buffer_load_dwordx4 v2, s[12:15], s31 offen lds
s_add_u32 m0, s34, 0
s_nop 0
buffer_load_dwordx4 v4, s[12:15], s33 offen lds
v_add_u32 v2, 8, v1
v_cmp_le_u32 vcc, 56, v2
v_subrev_u32 v3, 56, v2
s_nop 0
v_cndmask_b32 v2, v2, v3, vcc
v_mov_b32 v3, 1
v_addc_co_u32 v3, vcc, 0, v3, vcc
v_lshrrev_b32 v4, 1, v3
v_xor_b32 v2, v2, v4
v_lshlrev_b32 v2, 4, v2
v_mul_u32_u24 v3, 896, v3
v_xor_b32 v4, 64, v2
v_add_u32 v2, v2, v3
v_add_u32 v4, v4, v3
s_add_u32 m0, s32, 1024
s_nop 0
buffer_load_dwordx4 v2, s[12:15], s31 offen lds
s_add_u32 m0, s34, 1024
s_nop 0
buffer_load_dwordx4 v4, s[12:15], s33 offen lds
v_add_u32 v2, 16, v1
v_cmp_le_u32 vcc, 56, v2
v_subrev_u32 v3, 56, v2
s_nop 0
v_cndmask_b32 v2, v2, v3, vcc
v_mov_b32 v3, 2
v_addc_co_u32 v3, vcc, 0, v3, vcc
v_lshrrev_b32 v4, 1, v3
v_xor_b32 v2, v2, v4
v_lshlrev_b32 v2, 4, v2
v_mul_u32_u24 v3, 896, v3
v_xor_b32 v4, 64, v2
v_add_u32 v2, v2, v3
v_add_u32 v4, v4, v3
s_add_u32 m0, s32, 2048
s_nop 0
buffer_load_dwordx4 v2, s[12:15], s31 offen lds
s_add_u32 m0, s34, 2048
s_nop 0
buffer_load_dwordx4 v4, s[12:15], s33 offen lds
v_add_u32 v2, 24, v1
v_cmp_le_u32 vcc, 56, v2
v_subrev_u32 v3, 56, v2
s_nop 0
v_cndmask_b32 v2, v2, v3, vcc
v_mov_b32 v3, 3
v_addc_co_u32 v3, vcc, 0, v3, vcc
v_lshrrev_b32 v4, 1, v3
v_xor_b32 v2, v2, v4
v_lshlrev_b32 v2, 4, v2
v_mul_u32_u24 v3, 896, v3
v_xor_b32 v4, 64, v2
v_add_u32 v2, v2, v3
v_add_u32 v4, v4, v3
s_add_u32 m0, s32, 3072
s_nop 0
buffer_load_dwordx4 v2, s[12:15], s31 offen lds
s_add_u32 m0, s34, 3072
s_nop 0
buffer_load_dwordx4 v4, s[12:15], s33 offen lds
v_add_u32 v2, 32, v1
v_cmp_le_u32 vcc, 56, v2
v_subrev_u32 v3, 56, v2
s_nop 0
v_cndmask_b32 v2, v2, v3, vcc
v_mov_b32 v3, 4
v_addc_co_u32 v3, vcc, 0, v3, vcc
v_lshrrev_b32 v4, 1, v3
v_xor_b32 v2, v2, v4
v_lshlrev_b32 v2, 4, v2
v_mul_u32_u24 v3, 896, v3
v_xor_b32 v4, 64, v2
v_add_u32 v2, v2, v3
v_add_u32 v4, v4, v3
s_add_u32 m0, s32, 4096
s_nop 0
buffer_load_dwordx4 v2, s[12:15], s31 offen lds
s_add_u32 m0, s34, 4096
s_nop 0
buffer_load_dwordx4 v4, s[12:15], s33 offen lds
v_add_u32 v2, 40, v1
v_cmp_le_u32 vcc, 56, v2
v_subrev_u32 v3, 56, v2
s_nop 0
v_cndmask_b32 v2, v2, v3, vcc
v_mov_b32 v3, 5
v_addc_co_u32 v3, vcc, 0, v3, vcc
v_lshrrev_b32 v4, 1, v3
v_xor_b32 v2, v2, v4
v_lshlrev_b32 v2, 4, v2
v_mul_u32_u24 v3, 896, v3
v_xor_b32 v4, 64, v2
v_add_u32 v2, v2, v3
v_add_u32 v4, v4, v3
s_add_u32 m0, s32, 5120
s_nop 0
buffer_load_dwordx4 v2, s[12:15], s31 offen lds
s_add_u32 m0, s34, 5120
s_nop 0
buffer_load_dwordx4 v4, s[12:15], s33 offen lds
v_add_u32 v2, 48, v1
v_cmp_le_u32 vcc, 56, v2
v_subrev_u32 v3, 56, v2
s_nop 0
v_cndmask_b32 v2, v2, v3, vcc
v_mov_b32 v3, 6
v_addc_co_u32 v3, vcc, 0, v3, vcc
v_lshrrev_b32 v4, 1, v3
v_xor_b32 v2, v2, v4
v_lshlrev_b32 v2, 4, v2
v_mul_u32_u24 v3, 896, v3
v_xor_b32 v4, 64, v2
v_add_u32 v2, v2, v3
v_add_u32 v4, v4, v3
s_add_u32 m0, s32, 6144
s_nop 0
buffer_load_dwordx4 v2, s[12:15], s31 offen lds
s_add_u32 m0, s34, 6144
s_nop 0
buffer_load_dwordx4 v4, s[12:15], s33 offen lds
s_cmp_lg_u32 s3, 0
s_cbranch_scc1 p0_8
v_mov_b32 v2, 0
buffer_load_dword v190, v2, s[48:51], 0 offen sc1
p0_8:
s_cmp_eq_u32 s3, 2
s_cbranch_scc1 ps2_9
s_cmp_eq_u32 s3, 3
s_cbranch_scc1 ps3_10
s_load_dwordx2 s[12:13], s[0:1], 32
s_mov_b32 s14, 1605632
s_mov_b32 s15, 131072
s_load_dwordx2 s[40:41], s[0:1], 40
s_mov_b32 s42, 1605632
s_mov_b32 s43, 131072
s_branch pse_11
ps2_9:
s_load_dwordx2 s[12:13], s[0:1], 48
s_mov_b32 s14, 1605632
s_mov_b32 s15, 131072
s_load_dwordx2 s[40:41], s[0:1], 48
s_mov_b32 s42, 1605632
s_mov_b32 s43, 131072
s_branch pse_11
ps3_10:
s_load_dwordx2 s[12:13], s[0:1], 16
s_mov_b32 s14, 401408
s_mov_b32 s15, 131072
s_load_dwordx2 s[40:41], s[0:1], 16
s_mov_b32 s42, 401408
s_mov_b32 s43, 131072
pse_11:
s_add_u32 s28, s3, 0
s_min_u32 s28, s28, 20
s_lshl_b32 s28, s28, 6
v_add_u32 v2, s28, v1
v_mul_u32_u24 v3, 3121, v2
v_lshrrev_b32 v3, 16, v3
v_mul_u32_u24 v4, 21, v3
v_sub_u32 v4, v2, v4
v_mul_u32_u24 v3, 2688, v3
v_lshl_add_u32 v184, v4, 4, v3
s_add_u32 s28, s3, 4
s_min_u32 s28, s28, 20
s_lshl_b32 s28, s28, 6
v_add_u32 v2, s28, v1
v_mul_u32_u24 v3, 3121, v2
v_lshrrev_b32 v3, 16, v3
v_mul_u32_u24 v4, 21, v3
v_sub_u32 v4, v2, v4
v_mul_u32_u24 v3, 2688, v3
v_lshl_add_u32 v185, v4, 4, v3
s_add_u32 s28, s3, 8
s_min_u32 s28, s28, 20
s_lshl_b32 s28, s28, 6
v_add_u32 v2, s28, v1
v_mul_u32_u24 v3, 3121, v2
v_lshrrev_b32 v3, 16, v3
v_mul_u32_u24 v4, 21, v3
v_sub_u32 v4, v2, v4
v_mul_u32_u24 v3, 2688, v3
v_lshl_add_u32 v186, v4, 4, v3
s_add_u32 s28, s3, 12
s_min_u32 s28, s28, 20
s_lshl_b32 s28, s28, 6
v_add_u32 v2, s28, v1
v_mul_u32_u24 v3, 3121, v2
v_lshrrev_b32 v3, 16, v3
v_mul_u32_u24 v4, 21, v3
v_sub_u32 v4, v2, v4
v_mul_u32_u24 v3, 2688, v3
v_lshl_add_u32 v187, v4, 4, v3
s_add_u32 s28, s3, 16
s_min_u32 s28, s28, 20
s_lshl_b32 s28, s28, 6
v_add_u32 v2, s28, v1
v_mul_u32_u24 v3, 3121, v2
v_lshrrev_b32 v3, 16, v3
v_mul_u32_u24 v4, 21, v3
v_sub_u32 v4, v2, v4
v_mul_u32_u24 v3, 2688, v3
v_lshl_add_u32 v188, v4, 4, v3
s_add_u32 s28, s3, 20
s_min_u32 s28, s28, 20
s_lshl_b32 s28, s28, 6
v_add_u32 v2, s28, v1
v_mul_u32_u24 v3, 3121, v2
v_lshrrev_b32 v3, 16, v3
v_mul_u32_u24 v4, 21, v3
v_sub_u32 v4, v2, v4
v_mul_u32_u24 v3, 2688, v3
v_lshl_add_u32 v189, v4, 4, v3
s_mul_i32 s35, s90, 336
s_lshr_b32 s28, s5, 3
s_add_u32 s28, s28, 0
s_and_b32 s28, s28, 3
s_lshl_b32 s28, s28, 2
s_lshr_b32 s28, 5168, s28
s_and_b32 s28, s28, 15
s_mul_i32 s37, s28, 21504
s_mul_i32 s34, s28, 172032
s_add_u32 s34, s34, s35
s_add_u32 s28, s3, 0
s_min_u32 s28, s28, 20
s_lshl_b32 s28, s28, 10
s_add_u32 s28, s28, s37
s_mov_b32 m0, s28
s_nop 0
buffer_load_dwordx4 v184, s[16:19], s34 offen  lds
s_add_u32 s28, s3, 4
s_min_u32 s28, s28, 20
s_lshl_b32 s28, s28, 10
s_add_u32 s28, s28, s37
s_mov_b32 m0, s28
s_nop 0
buffer_load_dwordx4 v185, s[16:19], s34 offen  lds
s_add_u32 s28, s3, 8
s_min_u32 s28, s28, 20
s_lshl_b32 s28, s28, 10
s_add_u32 s28, s28, s37
s_mov_b32 m0, s28
s_nop 0
buffer_load_dwordx4 v186, s[16:19], s34 offen  lds
s_add_u32 s28, s3, 12
s_min_u32 s28, s28, 20
s_lshl_b32 s28, s28, 10
s_add_u32 s28, s28, s37
s_mov_b32 m0, s28
s_nop 0
buffer_load_dwordx4 v187, s[16:19], s34 offen  lds
s_add_u32 s28, s3, 16
s_min_u32 s28, s28, 20
s_lshl_b32 s28, s28, 10
s_add_u32 s28, s28, s37
s_mov_b32 m0, s28
s_nop 0
buffer_load_dwordx4 v188, s[16:19], s34 offen  lds
s_add_u32 s28, s3, 20
s_min_u32 s28, s28, 20
s_lshl_b32 s28, s28, 10
s_add_u32 s28, s28, s37
s_mov_b32 m0, s28
s_cmp_eq_u32 s3, 0
s_cselect_b64 exec, -1, 1
buffer_load_dwordx4 v189, s[16:19], s34 offen  lds
s_mov_b64 exec, -1
s_lshr_b32 s28, s5, 3
s_add_u32 s28, s28, 1
s_and_b32 s28, s28, 3
s_lshl_b32 s28, s28, 2
s_lshr_b32 s28, 5168, s28
s_and_b32 s28, s28, 15
s_mul_i32 s37, s28, 21504
s_mul_i32 s34, s28, 172032
s_add_u32 s34, s34, s35
s_add_u32 s28, s3, 0
s_min_u32 s28, s28, 20
s_lshl_b32 s28, s28, 10
s_add_u32 s28, s28, s37
s_mov_b32 m0, s28
s_nop 0
buffer_load_dwordx4 v184, s[16:19], s34 offen  lds
s_add_u32 s28, s3, 4
s_min_u32 s28, s28, 20
s_lshl_b32 s28, s28, 10
s_add_u32 s28, s28, s37
s_mov_b32 m0, s28
s_nop 0
buffer_load_dwordx4 v185, s[16:19], s34 offen  lds
s_add_u32 s28, s3, 8
s_min_u32 s28, s28, 20
s_lshl_b32 s28, s28, 10
s_add_u32 s28, s28, s37
s_mov_b32 m0, s28
s_nop 0
buffer_load_dwordx4 v186, s[16:19], s34 offen  lds
s_add_u32 s28, s3, 12
s_min_u32 s28, s28, 20
s_lshl_b32 s28, s28, 10
s_add_u32 s28, s28, s37
s_mov_b32 m0, s28
s_nop 0
buffer_load_dwordx4 v187, s[16:19], s34 offen  lds
s_add_u32 s28, s3, 16
s_min_u32 s28, s28, 20
s_lshl_b32 s28, s28, 10
s_add_u32 s28, s28, s37
s_mov_b32 m0, s28
s_nop 0
buffer_load_dwordx4 v188, s[16:19], s34 offen  lds
s_add_u32 s28, s3, 20
s_min_u32 s28, s28, 20
s_lshl_b32 s28, s28, 10
s_add_u32 s28, s28, s37
s_mov_b32 m0, s28
s_cmp_eq_u32 s3, 0
s_cselect_b64 exec, -1, 1
buffer_load_dwordx4 v189, s[16:19], s34 offen  lds
s_mov_b64 exec, -1
s_cmp_ge_u32 s45, 28
s_cbranch_scc1 p0_12
s_waitcnt vmcnt(26)
v_mov_b32 v112, 0
v_mov_b32 v113, 0
v_mov_b32 v114, 0
v_mov_b32 v115, 0
v_mov_b32 v116, 0
v_mov_b32 v117, 0
v_mov_b32 v118, 0
v_mov_b32 v119, 0
v_bfe_u32 v3, v0, 2, 1
v_cmp_eq_u32 vcc, 1, v3
v_lshlrev_b32 v108, 16, v72
v_and_b32 v72, 0xffff0000, v72
v_cndmask_b32 v72, v108, v72, vcc
v_mul_f32 v108, 0xbfb8aa3b, v72
v_exp_f32 v108, v108
s_nop 0
v_add_f32 v108, 1.0, v108
v_rcp_f32 v108, v108
s_nop 0
v_mul_f32 v72, v72, v108
v_cvt_pk_bf16_f32 v72, v72, v72
v_and_b32 v72, 0xffff0000, v72
v_lshlrev_b32 v108, 16, v73
v_and_b32 v73, 0xffff0000, v73
v_cndmask_b32 v73, v108, v73, vcc
v_mul_f32 v108, 0xbfb8aa3b, v73
v_exp_f32 v108, v108
s_nop 0
v_add_f32 v108, 1.0, v108
v_rcp_f32 v108, v108
s_nop 0
v_mul_f32 v73, v73, v108
v_cvt_pk_bf16_f32 v73, v73, v73
v_and_b32 v73, 0xffff0000, v73
v_lshlrev_b32 v108, 16, v74
v_and_b32 v74, 0xffff0000, v74
v_cndmask_b32 v74, v108, v74, vcc
v_mul_f32 v108, 0xbfb8aa3b, v74
v_exp_f32 v108, v108
s_nop 0
v_add_f32 v108, 1.0, v108
v_rcp_f32 v108, v108
s_nop 0
v_mul_f32 v74, v74, v108
v_cvt_pk_bf16_f32 v74, v74, v74
v_and_b32 v74, 0xffff0000, v74
v_lshlrev_b32 v108, 16, v75
v_and_b32 v75, 0xffff0000, v75
v_cndmask_b32 v75, v108, v75, vcc
v_mul_f32 v108, 0xbfb8aa3b, v75
v_exp_f32 v108, v108
s_nop 0
v_add_f32 v108, 1.0, v108
v_rcp_f32 v108, v108
s_nop 0
v_mul_f32 v75, v75, v108
v_cvt_pk_bf16_f32 v75, v75, v75
v_and_b32 v75, 0xffff0000, v75
v_lshlrev_b32 v108, 16, v76
v_and_b32 v76, 0xffff0000, v76
v_cndmask_b32 v76, v108, v76, vcc
v_mul_f32 v108, 0xbfb8aa3b, v76
v_exp_f32 v108, v108
s_nop 0
v_add_f32 v108, 1.0, v108
v_rcp_f32 v108, v108
s_nop 0
v_mul_f32 v76, v76, v108
v_cvt_pk_bf16_f32 v76, v76, v76
v_and_b32 v76, 0xffff0000, v76
v_lshlrev_b32 v108, 16, v77
v_and_b32 v77, 0xffff0000, v77
v_cndmask_b32 v77, v108, v77, vcc
v_mul_f32 v108, 0xbfb8aa3b, v77
v_exp_f32 v108, v108
s_nop 0
v_add_f32 v108, 1.0, v108
v_rcp_f32 v108, v108
s_nop 0
v_mul_f32 v77, v77, v108
v_cvt_pk_bf16_f32 v77, v77, v77
v_and_b32 v77, 0xffff0000, v77
v_lshlrev_b32 v108, 16, v78
v_and_b32 v78, 0xffff0000, v78
v_cndmask_b32 v78, v108, v78, vcc
v_mul_f32 v108, 0xbfb8aa3b, v78
v_exp_f32 v108, v108
s_nop 0
v_add_f32 v108, 1.0, v108
v_rcp_f32 v108, v108
s_nop 0
v_mul_f32 v78, v78, v108
v_cvt_pk_bf16_f32 v78, v78, v78
v_and_b32 v78, 0xffff0000, v78
v_lshlrev_b32 v108, 16, v80
v_and_b32 v109, 0xffff0000, v80
v_fmac_f32 v112, v72, v108
v_fmac_f32 v113, v72, v109
v_lshlrev_b32 v108, 16, v81
v_and_b32 v109, 0xffff0000, v81
v_fmac_f32 v114, v72, v108
v_fmac_f32 v115, v72, v109
v_lshlrev_b32 v108, 16, v82
v_and_b32 v109, 0xffff0000, v82
v_fmac_f32 v116, v72, v108
v_fmac_f32 v117, v72, v109
v_lshlrev_b32 v108, 16, v83
v_and_b32 v109, 0xffff0000, v83
v_fmac_f32 v118, v72, v108
v_fmac_f32 v119, v72, v109
v_lshlrev_b32 v108, 16, v84
v_and_b32 v109, 0xffff0000, v84
v_fmac_f32 v112, v73, v108
v_fmac_f32 v113, v73, v109
v_lshlrev_b32 v108, 16, v85
v_and_b32 v109, 0xffff0000, v85
v_fmac_f32 v114, v73, v108
v_fmac_f32 v115, v73, v109
v_lshlrev_b32 v108, 16, v86
v_and_b32 v109, 0xffff0000, v86
v_fmac_f32 v116, v73, v108
v_fmac_f32 v117, v73, v109
v_lshlrev_b32 v108, 16, v87
v_and_b32 v109, 0xffff0000, v87
v_fmac_f32 v118, v73, v108
v_fmac_f32 v119, v73, v109
v_lshlrev_b32 v108, 16, v88
v_and_b32 v109, 0xffff0000, v88
v_fmac_f32 v112, v74, v108
v_fmac_f32 v113, v74, v109
v_lshlrev_b32 v108, 16, v89
v_and_b32 v109, 0xffff0000, v89
v_fmac_f32 v114, v74, v108
v_fmac_f32 v115, v74, v109
v_lshlrev_b32 v108, 16, v90
v_and_b32 v109, 0xffff0000, v90
v_fmac_f32 v116, v74, v108
v_fmac_f32 v117, v74, v109
v_lshlrev_b32 v108, 16, v91
v_and_b32 v109, 0xffff0000, v91
v_fmac_f32 v118, v74, v108
v_fmac_f32 v119, v74, v109
v_lshlrev_b32 v108, 16, v92
v_and_b32 v109, 0xffff0000, v92
v_fmac_f32 v112, v75, v108
v_fmac_f32 v113, v75, v109
v_lshlrev_b32 v108, 16, v93
v_and_b32 v109, 0xffff0000, v93
v_fmac_f32 v114, v75, v108
v_fmac_f32 v115, v75, v109
v_lshlrev_b32 v108, 16, v94
v_and_b32 v109, 0xffff0000, v94
v_fmac_f32 v116, v75, v108
v_fmac_f32 v117, v75, v109
v_lshlrev_b32 v108, 16, v95
v_and_b32 v109, 0xffff0000, v95
v_fmac_f32 v118, v75, v108
v_fmac_f32 v119, v75, v109
v_lshlrev_b32 v108, 16, v96
v_and_b32 v109, 0xffff0000, v96
v_fmac_f32 v112, v76, v108
v_fmac_f32 v113, v76, v109
v_lshlrev_b32 v108, 16, v97
v_and_b32 v109, 0xffff0000, v97
v_fmac_f32 v114, v76, v108
v_fmac_f32 v115, v76, v109
v_lshlrev_b32 v108, 16, v98
v_and_b32 v109, 0xffff0000, v98
v_fmac_f32 v116, v76, v108
v_fmac_f32 v117, v76, v109
v_lshlrev_b32 v108, 16, v99
v_and_b32 v109, 0xffff0000, v99
v_fmac_f32 v118, v76, v108
v_fmac_f32 v119, v76, v109
v_lshlrev_b32 v108, 16, v100
v_and_b32 v109, 0xffff0000, v100
v_fmac_f32 v112, v77, v108
v_fmac_f32 v113, v77, v109
v_lshlrev_b32 v108, 16, v101
v_and_b32 v109, 0xffff0000, v101
v_fmac_f32 v114, v77, v108
v_fmac_f32 v115, v77, v109
v_lshlrev_b32 v108, 16, v102
v_and_b32 v109, 0xffff0000, v102
v_fmac_f32 v116, v77, v108
v_fmac_f32 v117, v77, v109
v_lshlrev_b32 v108, 16, v103
v_and_b32 v109, 0xffff0000, v103
v_fmac_f32 v118, v77, v108
v_fmac_f32 v119, v77, v109
v_lshlrev_b32 v108, 16, v104
v_and_b32 v109, 0xffff0000, v104
v_fmac_f32 v112, v78, v108
v_fmac_f32 v113, v78, v109
v_lshlrev_b32 v108, 16, v105
v_and_b32 v109, 0xffff0000, v105
v_fmac_f32 v114, v78, v108
v_fmac_f32 v115, v78, v109
v_lshlrev_b32 v108, 16, v106
v_and_b32 v109, 0xffff0000, v106
v_fmac_f32 v116, v78, v108
v_fmac_f32 v117, v78, v109
v_lshlrev_b32 v108, 16, v107
v_and_b32 v109, 0xffff0000, v107
v_fmac_f32 v118, v78, v108
v_fmac_f32 v119, v78, v109
v_add_f32_dpp v112, v112, v112 row_ror:4 row_mask:0xf bank_mask:0xf
v_add_f32_dpp v113, v113, v113 row_ror:4 row_mask:0xf bank_mask:0xf
v_add_f32_dpp v114, v114, v114 row_ror:4 row_mask:0xf bank_mask:0xf
v_add_f32_dpp v115, v115, v115 row_ror:4 row_mask:0xf bank_mask:0xf
v_add_f32_dpp v116, v116, v116 row_ror:4 row_mask:0xf bank_mask:0xf
v_add_f32_dpp v117, v117, v117 row_ror:4 row_mask:0xf bank_mask:0xf
v_add_f32_dpp v118, v118, v118 row_ror:4 row_mask:0xf bank_mask:0xf
v_add_f32_dpp v119, v119, v119 row_ror:4 row_mask:0xf bank_mask:0xf
v_add_f32_dpp v112, v112, v112 row_ror:8 row_mask:0xf bank_mask:0xf
v_add_f32_dpp v113, v113, v113 row_ror:8 row_mask:0xf bank_mask:0xf
v_add_f32_dpp v114, v114, v114 row_ror:8 row_mask:0xf bank_mask:0xf
v_add_f32_dpp v115, v115, v115 row_ror:8 row_mask:0xf bank_mask:0xf
v_add_f32_dpp v116, v116, v116 row_ror:8 row_mask:0xf bank_mask:0xf
v_add_f32_dpp v117, v117, v117 row_ror:8 row_mask:0xf bank_mask:0xf
v_add_f32_dpp v118, v118, v118 row_ror:8 row_mask:0xf bank_mask:0xf
v_add_f32_dpp v119, v119, v119 row_ror:8 row_mask:0xf bank_mask:0xf
v_and_b32 v3, 3, v0
v_lshrrev_b32 v6, 4, v0
v_lshlrev_b32 v6, 7, v6
v_lshl_add_u32 v6, v3, 5, v6
v_add_u32 v6, 155136, v6
v_and_b32 v7, 12, v0
v_cmp_eq_u32 vcc, 0, v7
s_and_saveexec_b64 s[32:33], vcc
ds_write_b128 v6, v[112:115]
ds_write_b128 v6, v[116:119] offset:16
s_mov_b64 exec, s[32:33]
s_waitcnt lgkmcnt(0)
s_barrier
p0_12:
s_waitcnt vmcnt(12)
s_cmp_lg_u32 s3, 0
s_cbranch_scc1 p0_13
v_readfirstlane_b32 s88, v190
s_cmp_lg_u32 s88, 0
s_cbranch_scc1 p0_6
s_mov_b32 s38, 0
v_mov_b32 v2, 0
ns_poll_15:
buffer_load_dword v3, v2, s[48:51], 0 offen sc1
s_waitcnt vmcnt(0)
v_readfirstlane_b32 s88, v3
s_cmp_lg_u32 s88, 0
s_cbranch_scc1 ns_done_16
s_sleep 2
s_add_u32 s38, s38, 1
s_cmp_lt_u32 s38, 131072
s_cbranch_scc1 ns_poll_15
ns_done_16:
p0_6:
s_cmp_ge_u32 s45, 28
s_cbranch_scc1 p0_14
s_mov_b32 exec_hi, 0
v_lshlrev_b32 v6, 2, v1
v_add_u32 v7, 155136, v6
ds_read_b32 v80, v7 offset:0
ds_read_b32 v81, v7 offset:128
ds_read_b32 v82, v7 offset:256
ds_read_b32 v83, v7 offset:384
ds_read_b32 v84, v7 offset:512
ds_read_b32 v85, v7 offset:640
ds_read_b32 v86, v7 offset:768
ds_read_b32 v87, v7 offset:896
ds_read_b32 v88, v7 offset:1024
ds_read_b32 v89, v7 offset:1152
ds_read_b32 v90, v7 offset:1280
ds_read_b32 v91, v7 offset:1408
ds_read_b32 v92, v7 offset:1536
ds_read_b32 v93, v7 offset:1664
ds_read_b32 v94, v7 offset:1792
ds_read_b32 v95, v7 offset:1920
s_waitcnt lgkmcnt(0)
v_add_f32 v80, v80, v88
v_add_f32 v81, v81, v89
v_add_f32 v82, v82, v90
v_add_f32 v83, v83, v91
v_add_f32 v84, v84, v92
v_add_f32 v85, v85, v93
v_add_f32 v86, v86, v94
v_add_f32 v87, v87, v95
v_add_f32 v80, v80, v84
v_add_f32 v81, v81, v85
v_add_f32 v82, v82, v86
v_add_f32 v83, v83, v87
v_add_f32 v80, v80, v82
v_add_f32 v81, v81, v83
v_add_f32 v80, v80, v81
v_cvt_pk_bf16_f32 v80, v80, v80
v_and_b32 v80, 0xffff0000, v80
s_mul_hi_u32 s30, s45, 306783379
s_cmp_eq_u32 s30, 1
s_cselect_b32 s31, 1, 0
s_cmp_eq_u32 s30, 4
s_cselect_b32 s31, 1, s31
s_cmp_eq_u32 s31, 1
s_cbranch_scc0 mod_noadd_17
v_add_f32 v80, 1.0, v80
v_cvt_pk_bf16_f32 v80, v80, v80
v_and_b32 v80, 0xffff0000, v80
mod_noadd_17:
s_lshl_b32 s30, s45, 7
s_lshl_b32 s30, s30, 1
s_add_u32 s30, s30, 327680
v_mov_b32 v81, s88
v_lshlrev_b32 v6, 1, v6
buffer_store_dwordx2 v[80:81], v6, s[8:11], s30 offen sc1
s_mov_b64 exec, -1
p0_14:
v_mov_b32 v2, 157184
v_mov_b32 v3, s88
ds_write_b32 v2, v3
s_lshl_b32 s28, s4, 7
s_lshl_b32 s29, s5, 2
s_add_u32 s28, s28, s29
s_add_u32 s28, s28, 360448
s_or_b32 s29, s88, s44
v_mov_b32 v2, 0
v_mov_b32 v3, s29
s_mov_b64 exec, 1
buffer_store_dword v3, v2, s[8:11], s28 offen sc1
s_mov_b64 exec, -1
s_waitcnt lgkmcnt(0)
p0_13:
s_barrier
v_mov_b32 v14, 157184
ds_read_b32 v12, v14
v_and_b32 v2, 31, v1
s_lshl_b32 s28, s6, 5
v_add_u32 v2, s28, v2
v_bfe_u32 v3, v2, 1, 3
v_lshrrev_b32 v4, 5, v1
v_mul_u32_u24 v5, 896, v2
v_cmp_gt_u32 vcc, 24, v2
v_mov_b32 v6, 86016
v_mov_b32 v7, 43008
v_cndmask_b32 v6, v6, v7, vcc
v_add_u32 v2, v5, v6
v_add_u32 v5, 0, v4
v_xor_b32 v5, v5, v3
v_lshl_add_u32 v8, v5, 4, v2
v_add_u32 v5, 2, v4
v_xor_b32 v5, v5, v3
v_lshl_add_u32 v9, v5, 4, v2
v_add_u32 v5, 4, v4
v_xor_b32 v5, v5, v3
v_lshl_add_u32 v10, v5, 4, v2
v_add_u32 v5, 6, v4
v_xor_b32 v5, v5, v3
v_lshl_add_u32 v11, v5, 4, v2
s_cmp_eq_u32 s7, 1
s_cbranch_scc1 xf_18
ds_read_b128 v[16:19], v8 offset:0
ds_read_b128 v[20:23], v9 offset:0
ds_read_b128 v[24:27], v10 offset:0
ds_read_b128 v[28:31], v11 offset:0
ds_read_b128 v[32:35], v8 offset:128
ds_read_b128 v[36:39], v9 offset:128
ds_read_b128 v[40:43], v10 offset:128
ds_read_b128 v[44:47], v11 offset:128
ds_read_b128 v[48:51], v8 offset:256
ds_read_b128 v[52:55], v9 offset:256
ds_read_b128 v[56:59], v10 offset:256
ds_read_b128 v[60:63], v11 offset:256
ds_read_b128 v[64:67], v8 offset:384
ds_read_b128 v[68:71], v9 offset:384
s_branch xf_19
xf_18:
ds_read_b128 v[16:19], v10 offset:384
ds_read_b128 v[20:23], v11 offset:384
ds_read_b128 v[24:27], v8 offset:512
ds_read_b128 v[28:31], v9 offset:512
ds_read_b128 v[32:35], v10 offset:512
ds_read_b128 v[36:39], v11 offset:512
ds_read_b128 v[40:43], v8 offset:640
ds_read_b128 v[44:47], v9 offset:640
ds_read_b128 v[48:51], v10 offset:640
ds_read_b128 v[52:55], v11 offset:640
ds_read_b128 v[56:59], v8 offset:768
ds_read_b128 v[60:63], v9 offset:768
ds_read_b128 v[64:67], v10 offset:768
ds_read_b128 v[68:71], v11 offset:768
xf_19:
s_waitcnt lgkmcnt(0)
v_readfirstlane_b32 s88, v12
v_mov_b32 v10, 0x3f803f80
v_mov_b32 v2, 0
v_mov_b32 v3, 0
v_mov_b32 v4, 0
v_mov_b32 v5, 0
v_dot2c_f32_bf16 v2, v16, v10
v_dot2c_f32_bf16 v4, v16, v16
v_dot2c_f32_bf16 v3, v17, v10
v_dot2c_f32_bf16 v5, v17, v17
v_dot2c_f32_bf16 v2, v18, v10
v_dot2c_f32_bf16 v4, v18, v18
v_dot2c_f32_bf16 v3, v19, v10
v_dot2c_f32_bf16 v5, v19, v19
s_lshr_b32 s28, s5, 3
s_add_u32 s28, s28, 2
s_and_b32 s28, s28, 3
s_lshl_b32 s28, s28, 2
s_lshr_b32 s28, 5168, s28
s_and_b32 s28, s28, 15
s_mul_i32 s37, s28, 21504
s_mul_i32 s34, s28, 172032
s_add_u32 s34, s34, s35
s_add_u32 s28, s3, 0
s_min_u32 s28, s28, 20
s_lshl_b32 s28, s28, 10
s_add_u32 s28, s28, s37
s_mov_b32 m0, s28
s_nop 0
buffer_load_dwordx4 v184, s[16:19], s34 offen  lds
v_dot2c_f32_bf16 v2, v20, v10
v_dot2c_f32_bf16 v4, v20, v20
v_dot2c_f32_bf16 v3, v21, v10
v_dot2c_f32_bf16 v5, v21, v21
v_dot2c_f32_bf16 v2, v22, v10
v_dot2c_f32_bf16 v4, v22, v22
v_dot2c_f32_bf16 v3, v23, v10
v_dot2c_f32_bf16 v5, v23, v23
s_add_u32 s28, s3, 4
s_min_u32 s28, s28, 20
s_lshl_b32 s28, s28, 10
s_add_u32 s28, s28, s37
s_mov_b32 m0, s28
s_nop 0
buffer_load_dwordx4 v185, s[16:19], s34 offen  lds
v_dot2c_f32_bf16 v2, v24, v10
v_dot2c_f32_bf16 v4, v24, v24
v_dot2c_f32_bf16 v3, v25, v10
v_dot2c_f32_bf16 v5, v25, v25
v_dot2c_f32_bf16 v2, v26, v10
v_dot2c_f32_bf16 v4, v26, v26
v_dot2c_f32_bf16 v3, v27, v10
v_dot2c_f32_bf16 v5, v27, v27
s_add_u32 s28, s3, 8
s_min_u32 s28, s28, 20
s_lshl_b32 s28, s28, 10
s_add_u32 s28, s28, s37
s_mov_b32 m0, s28
s_nop 0
buffer_load_dwordx4 v186, s[16:19], s34 offen  lds
v_dot2c_f32_bf16 v2, v28, v10
v_dot2c_f32_bf16 v4, v28, v28
v_dot2c_f32_bf16 v3, v29, v10
v_dot2c_f32_bf16 v5, v29, v29
v_dot2c_f32_bf16 v2, v30, v10
v_dot2c_f32_bf16 v4, v30, v30
v_dot2c_f32_bf16 v3, v31, v10
v_dot2c_f32_bf16 v5, v31, v31
s_add_u32 s28, s3, 12
s_min_u32 s28, s28, 20
s_lshl_b32 s28, s28, 10
s_add_u32 s28, s28, s37
s_mov_b32 m0, s28
s_nop 0
buffer_load_dwordx4 v187, s[16:19], s34 offen  lds
v_dot2c_f32_bf16 v2, v32, v10
v_dot2c_f32_bf16 v4, v32, v32
v_dot2c_f32_bf16 v3, v33, v10
v_dot2c_f32_bf16 v5, v33, v33
v_dot2c_f32_bf16 v2, v34, v10
v_dot2c_f32_bf16 v4, v34, v34
v_dot2c_f32_bf16 v3, v35, v10
v_dot2c_f32_bf16 v5, v35, v35
s_add_u32 s28, s3, 16
s_min_u32 s28, s28, 20
s_lshl_b32 s28, s28, 10
s_add_u32 s28, s28, s37
s_mov_b32 m0, s28
s_nop 0
buffer_load_dwordx4 v188, s[16:19], s34 offen  lds
v_dot2c_f32_bf16 v2, v36, v10
v_dot2c_f32_bf16 v4, v36, v36
v_dot2c_f32_bf16 v3, v37, v10
v_dot2c_f32_bf16 v5, v37, v37
v_dot2c_f32_bf16 v2, v38, v10
v_dot2c_f32_bf16 v4, v38, v38
v_dot2c_f32_bf16 v3, v39, v10
v_dot2c_f32_bf16 v5, v39, v39
s_add_u32 s28, s3, 20
s_min_u32 s28, s28, 20
s_lshl_b32 s28, s28, 10
s_add_u32 s28, s28, s37
s_mov_b32 m0, s28
s_cmp_eq_u32 s3, 0
s_cselect_b64 exec, -1, 1
buffer_load_dwordx4 v189, s[16:19], s34 offen  lds
s_mov_b64 exec, -1
v_dot2c_f32_bf16 v2, v40, v10
v_dot2c_f32_bf16 v4, v40, v40
v_dot2c_f32_bf16 v3, v41, v10
v_dot2c_f32_bf16 v5, v41, v41
v_dot2c_f32_bf16 v2, v42, v10
v_dot2c_f32_bf16 v4, v42, v42
v_dot2c_f32_bf16 v3, v43, v10
v_dot2c_f32_bf16 v5, v43, v43
s_lshr_b32 s28, s5, 3
s_add_u32 s28, s28, 3
s_and_b32 s28, s28, 3
s_lshl_b32 s28, s28, 2
s_lshr_b32 s28, 5168, s28
s_and_b32 s28, s28, 15
s_mul_i32 s37, s28, 21504
s_mul_i32 s34, s28, 172032
s_add_u32 s34, s34, s35
s_add_u32 s28, s3, 0
s_min_u32 s28, s28, 20
s_lshl_b32 s28, s28, 10
s_add_u32 s28, s28, s37
s_mov_b32 m0, s28
s_nop 0
buffer_load_dwordx4 v184, s[16:19], s34 offen  lds
v_dot2c_f32_bf16 v2, v44, v10
v_dot2c_f32_bf16 v4, v44, v44
v_dot2c_f32_bf16 v3, v45, v10
v_dot2c_f32_bf16 v5, v45, v45
v_dot2c_f32_bf16 v2, v46, v10
v_dot2c_f32_bf16 v4, v46, v46
v_dot2c_f32_bf16 v3, v47, v10
v_dot2c_f32_bf16 v5, v47, v47
s_add_u32 s28, s3, 4
s_min_u32 s28, s28, 20
s_lshl_b32 s28, s28, 10
s_add_u32 s28, s28, s37
s_mov_b32 m0, s28
s_nop 0
buffer_load_dwordx4 v185, s[16:19], s34 offen  lds
v_dot2c_f32_bf16 v2, v48, v10
v_dot2c_f32_bf16 v4, v48, v48
v_dot2c_f32_bf16 v3, v49, v10
v_dot2c_f32_bf16 v5, v49, v49
v_dot2c_f32_bf16 v2, v50, v10
v_dot2c_f32_bf16 v4, v50, v50
v_dot2c_f32_bf16 v3, v51, v10
v_dot2c_f32_bf16 v5, v51, v51
s_add_u32 s28, s3, 8
s_min_u32 s28, s28, 20
s_lshl_b32 s28, s28, 10
s_add_u32 s28, s28, s37
s_mov_b32 m0, s28
s_nop 0
buffer_load_dwordx4 v186, s[16:19], s34 offen  lds
v_dot2c_f32_bf16 v2, v52, v10
v_dot2c_f32_bf16 v4, v52, v52
v_dot2c_f32_bf16 v3, v53, v10
v_dot2c_f32_bf16 v5, v53, v53
v_dot2c_f32_bf16 v2, v54, v10
v_dot2c_f32_bf16 v4, v54, v54
v_dot2c_f32_bf16 v3, v55, v10
v_dot2c_f32_bf16 v5, v55, v55
s_add_u32 s28, s3, 12
s_min_u32 s28, s28, 20
s_lshl_b32 s28, s28, 10
s_add_u32 s28, s28, s37
s_mov_b32 m0, s28
s_nop 0
buffer_load_dwordx4 v187, s[16:19], s34 offen  lds
v_dot2c_f32_bf16 v2, v56, v10
v_dot2c_f32_bf16 v4, v56, v56
v_dot2c_f32_bf16 v3, v57, v10
v_dot2c_f32_bf16 v5, v57, v57
v_dot2c_f32_bf16 v2, v58, v10
v_dot2c_f32_bf16 v4, v58, v58
v_dot2c_f32_bf16 v3, v59, v10
v_dot2c_f32_bf16 v5, v59, v59
s_add_u32 s28, s3, 16
s_min_u32 s28, s28, 20
s_lshl_b32 s28, s28, 10
s_add_u32 s28, s28, s37
s_mov_b32 m0, s28
s_nop 0
buffer_load_dwordx4 v188, s[16:19], s34 offen  lds
v_dot2c_f32_bf16 v2, v60, v10
v_dot2c_f32_bf16 v4, v60, v60
v_dot2c_f32_bf16 v3, v61, v10
v_dot2c_f32_bf16 v5, v61, v61
v_dot2c_f32_bf16 v2, v62, v10
v_dot2c_f32_bf16 v4, v62, v62
v_dot2c_f32_bf16 v3, v63, v10
v_dot2c_f32_bf16 v5, v63, v63
s_add_u32 s28, s3, 20
s_min_u32 s28, s28, 20
s_lshl_b32 s28, s28, 10
s_add_u32 s28, s28, s37
s_mov_b32 m0, s28
s_cmp_eq_u32 s3, 0
s_cselect_b64 exec, -1, 1
buffer_load_dwordx4 v189, s[16:19], s34 offen  lds
s_mov_b64 exec, -1
v_dot2c_f32_bf16 v2, v64, v10
v_dot2c_f32_bf16 v4, v64, v64
v_dot2c_f32_bf16 v3, v65, v10
v_dot2c_f32_bf16 v5, v65, v65
v_dot2c_f32_bf16 v2, v66, v10
v_dot2c_f32_bf16 v4, v66, v66
v_dot2c_f32_bf16 v3, v67, v10
v_dot2c_f32_bf16 v5, v67, v67
v_dot2c_f32_bf16 v2, v68, v10
v_dot2c_f32_bf16 v4, v68, v68
v_dot2c_f32_bf16 v3, v69, v10
v_dot2c_f32_bf16 v5, v69, v69
v_dot2c_f32_bf16 v2, v70, v10
v_dot2c_f32_bf16 v4, v70, v70
v_dot2c_f32_bf16 v3, v71, v10
v_dot2c_f32_bf16 v5, v71, v71
s_nop 1
v_add_f32 v2, v2, v3
v_add_f32 v3, v4, v5
v_mov_b32 v4, v2
v_mov_b32 v5, v3
s_nop 0
v_permlane32_swap_b32 v2, v4
v_permlane32_swap_b32 v3, v5
v_add_f32 v12, v2, v4
v_add_f32 v13, v3, v5
v_and_b32 v6, 31, v1
v_lshlrev_b32 v6, 3, v6
s_lshl_b32 s28, s3, 8
s_add_u32 s28, s28, 154112
v_add_u32 v7, s28, v6
ds_write_b64 v7, v[12:13]
s_xor_b32 s28, s3, 2
s_lshl_b32 s28, s28, 8
s_add_u32 s28, s28, 154112
v_add_u32 v14, s28, v6
s_waitcnt lgkmcnt(0)
s_barrier
ds_read_b64 v[4:5], v14
s_waitcnt lgkmcnt(0)
v_add_f32 v2, v12, v4
v_add_f32 v3, v13, v5
v_mul_f32 v2, 0x3b124925, v2
v_mul_f32 v3, 0x3b124925, v3
v_fma_f32 v3, -v2, v2, v3
v_max_f32 v3, 0, v3
v_add_f32 v3, 0x3727c5ac, v3
v_rsq_f32 v4, v3
s_nop 0
v_mul_f32 v6, v2, v4
v_mov_b32 v5, v4
v_mov_b32 v7, v6
v_lshlrev_b32 v72, 16, v16
v_and_b32 v73, 0xffff0000, v16
v_pk_fma_f32 v[72:73], v[72:73], v[4:5], v[6:7] neg_lo:[0,0,1] neg_hi:[0,0,1]
v_lshlrev_b32 v74, 16, v17
v_and_b32 v75, 0xffff0000, v17
v_pk_fma_f32 v[74:75], v[74:75], v[4:5], v[6:7] neg_lo:[0,0,1] neg_hi:[0,0,1]
s_lshr_b32 s28, s5, 3
s_add_u32 s28, s28, 0
s_mul_hi_u32 s29, s28, 1431655766
s_mul_i32 s29, s29, 3
s_sub_u32 s28, s28, s29
s_lshl_b32 s28, s28, 2
s_lshr_b32 s28, 1573, s28
s_and_b32 s28, s28, 15
s_mul_i32 s37, s28, 21504
s_mul_i32 s34, s28, 172032
s_add_u32 s34, s34, s35
s_add_u32 s28, s3, 0
s_min_u32 s28, s28, 20
s_lshl_b32 s28, s28, 10
s_add_u32 s28, s28, s37
s_mov_b32 m0, s28
s_nop 0
buffer_load_dwordx4 v184, s[16:19], s34 offen  lds
v_lshlrev_b32 v76, 16, v18
v_and_b32 v77, 0xffff0000, v18
v_pk_fma_f32 v[76:77], v[76:77], v[4:5], v[6:7] neg_lo:[0,0,1] neg_hi:[0,0,1]
v_lshlrev_b32 v78, 16, v19
v_and_b32 v79, 0xffff0000, v19
v_pk_fma_f32 v[78:79], v[78:79], v[4:5], v[6:7] neg_lo:[0,0,1] neg_hi:[0,0,1]
s_add_u32 s28, s3, 4
s_min_u32 s28, s28, 20
s_lshl_b32 s28, s28, 10
s_add_u32 s28, s28, s37
s_mov_b32 m0, s28
s_nop 0
buffer_load_dwordx4 v185, s[16:19], s34 offen  lds
v_lshlrev_b32 v80, 16, v20
v_and_b32 v81, 0xffff0000, v20
v_pk_fma_f32 v[80:81], v[80:81], v[4:5], v[6:7] neg_lo:[0,0,1] neg_hi:[0,0,1]
v_lshlrev_b32 v82, 16, v21
v_and_b32 v83, 0xffff0000, v21
v_pk_fma_f32 v[82:83], v[82:83], v[4:5], v[6:7] neg_lo:[0,0,1] neg_hi:[0,0,1]
s_add_u32 s28, s3, 8
s_min_u32 s28, s28, 20
s_lshl_b32 s28, s28, 10
s_add_u32 s28, s28, s37
s_mov_b32 m0, s28
s_nop 0
buffer_load_dwordx4 v186, s[16:19], s34 offen  lds
v_lshlrev_b32 v84, 16, v22
v_and_b32 v85, 0xffff0000, v22
v_pk_fma_f32 v[84:85], v[84:85], v[4:5], v[6:7] neg_lo:[0,0,1] neg_hi:[0,0,1]
v_lshlrev_b32 v86, 16, v23
v_and_b32 v87, 0xffff0000, v23
v_pk_fma_f32 v[86:87], v[86:87], v[4:5], v[6:7] neg_lo:[0,0,1] neg_hi:[0,0,1]
s_add_u32 s28, s3, 12
s_min_u32 s28, s28, 20
s_lshl_b32 s28, s28, 10
s_add_u32 s28, s28, s37
s_mov_b32 m0, s28
s_nop 0
buffer_load_dwordx4 v187, s[16:19], s34 offen  lds
v_lshlrev_b32 v88, 16, v24
v_and_b32 v89, 0xffff0000, v24
v_pk_fma_f32 v[88:89], v[88:89], v[4:5], v[6:7] neg_lo:[0,0,1] neg_hi:[0,0,1]
v_lshlrev_b32 v90, 16, v25
v_and_b32 v91, 0xffff0000, v25
v_pk_fma_f32 v[90:91], v[90:91], v[4:5], v[6:7] neg_lo:[0,0,1] neg_hi:[0,0,1]
s_add_u32 s28, s3, 16
s_min_u32 s28, s28, 20
s_lshl_b32 s28, s28, 10
s_add_u32 s28, s28, s37
s_mov_b32 m0, s28
s_nop 0
buffer_load_dwordx4 v188, s[16:19], s34 offen  lds
v_lshlrev_b32 v92, 16, v26
v_and_b32 v93, 0xffff0000, v26
v_pk_fma_f32 v[92:93], v[92:93], v[4:5], v[6:7] neg_lo:[0,0,1] neg_hi:[0,0,1]
v_lshlrev_b32 v94, 16, v27
v_and_b32 v95, 0xffff0000, v27
v_pk_fma_f32 v[94:95], v[94:95], v[4:5], v[6:7] neg_lo:[0,0,1] neg_hi:[0,0,1]
s_add_u32 s28, s3, 20
s_min_u32 s28, s28, 20
s_lshl_b32 s28, s28, 10
s_add_u32 s28, s28, s37
s_mov_b32 m0, s28
s_cmp_eq_u32 s3, 0
s_cselect_b64 exec, -1, 1
buffer_load_dwordx4 v189, s[16:19], s34 offen  lds
s_mov_b64 exec, -1
v_lshlrev_b32 v96, 16, v28
v_and_b32 v97, 0xffff0000, v28
v_pk_fma_f32 v[96:97], v[96:97], v[4:5], v[6:7] neg_lo:[0,0,1] neg_hi:[0,0,1]
v_lshlrev_b32 v98, 16, v29
v_and_b32 v99, 0xffff0000, v29
v_pk_fma_f32 v[98:99], v[98:99], v[4:5], v[6:7] neg_lo:[0,0,1] neg_hi:[0,0,1]
s_lshr_b32 s28, s5, 3
s_add_u32 s28, s28, 1
s_mul_hi_u32 s29, s28, 1431655766
s_mul_i32 s29, s29, 3
s_sub_u32 s28, s28, s29
s_lshl_b32 s28, s28, 2
s_lshr_b32 s28, 1573, s28
s_and_b32 s28, s28, 15
s_mul_i32 s37, s28, 21504
s_mul_i32 s34, s28, 172032
s_add_u32 s34, s34, s35
s_add_u32 s28, s3, 0
s_min_u32 s28, s28, 20
s_lshl_b32 s28, s28, 10
s_add_u32 s28, s28, s37
s_mov_b32 m0, s28
s_nop 0
buffer_load_dwordx4 v184, s[16:19], s34 offen  lds
v_lshlrev_b32 v100, 16, v30
v_and_b32 v101, 0xffff0000, v30
v_pk_fma_f32 v[100:101], v[100:101], v[4:5], v[6:7] neg_lo:[0,0,1] neg_hi:[0,0,1]
v_lshlrev_b32 v102, 16, v31
v_and_b32 v103, 0xffff0000, v31
v_pk_fma_f32 v[102:103], v[102:103], v[4:5], v[6:7] neg_lo:[0,0,1] neg_hi:[0,0,1]
s_add_u32 s28, s3, 4
s_min_u32 s28, s28, 20
s_lshl_b32 s28, s28, 10
s_add_u32 s28, s28, s37
s_mov_b32 m0, s28
s_nop 0
buffer_load_dwordx4 v185, s[16:19], s34 offen  lds
v_lshlrev_b32 v104, 16, v32
v_and_b32 v105, 0xffff0000, v32
v_pk_fma_f32 v[104:105], v[104:105], v[4:5], v[6:7] neg_lo:[0,0,1] neg_hi:[0,0,1]
v_lshlrev_b32 v106, 16, v33
v_and_b32 v107, 0xffff0000, v33
v_pk_fma_f32 v[106:107], v[106:107], v[4:5], v[6:7] neg_lo:[0,0,1] neg_hi:[0,0,1]
s_add_u32 s28, s3, 8
s_min_u32 s28, s28, 20
s_lshl_b32 s28, s28, 10
s_add_u32 s28, s28, s37
s_mov_b32 m0, s28
s_nop 0
buffer_load_dwordx4 v186, s[16:19], s34 offen  lds
v_lshlrev_b32 v108, 16, v34
v_and_b32 v109, 0xffff0000, v34
v_pk_fma_f32 v[108:109], v[108:109], v[4:5], v[6:7] neg_lo:[0,0,1] neg_hi:[0,0,1]
v_lshlrev_b32 v110, 16, v35
v_and_b32 v111, 0xffff0000, v35
v_pk_fma_f32 v[110:111], v[110:111], v[4:5], v[6:7] neg_lo:[0,0,1] neg_hi:[0,0,1]
s_add_u32 s28, s3, 12
s_min_u32 s28, s28, 20
s_lshl_b32 s28, s28, 10
s_add_u32 s28, s28, s37
s_mov_b32 m0, s28
s_nop 0
buffer_load_dwordx4 v187, s[16:19], s34 offen  lds
v_lshlrev_b32 v112, 16, v36
v_and_b32 v113, 0xffff0000, v36
v_pk_fma_f32 v[112:113], v[112:113], v[4:5], v[6:7] neg_lo:[0,0,1] neg_hi:[0,0,1]
v_lshlrev_b32 v114, 16, v37
v_and_b32 v115, 0xffff0000, v37
v_pk_fma_f32 v[114:115], v[114:115], v[4:5], v[6:7] neg_lo:[0,0,1] neg_hi:[0,0,1]
s_add_u32 s28, s3, 16
s_min_u32 s28, s28, 20
s_lshl_b32 s28, s28, 10
s_add_u32 s28, s28, s37
s_mov_b32 m0, s28
s_nop 0
buffer_load_dwordx4 v188, s[16:19], s34 offen  lds
v_lshlrev_b32 v116, 16, v38
v_and_b32 v117, 0xffff0000, v38
v_pk_fma_f32 v[116:117], v[116:117], v[4:5], v[6:7] neg_lo:[0,0,1] neg_hi:[0,0,1]
v_lshlrev_b32 v118, 16, v39
v_and_b32 v119, 0xffff0000, v39
v_pk_fma_f32 v[118:119], v[118:119], v[4:5], v[6:7] neg_lo:[0,0,1] neg_hi:[0,0,1]
s_add_u32 s28, s3, 20
s_min_u32 s28, s28, 20
s_lshl_b32 s28, s28, 10
s_add_u32 s28, s28, s37
s_mov_b32 m0, s28
s_cmp_eq_u32 s3, 0
s_cselect_b64 exec, -1, 1
buffer_load_dwordx4 v189, s[16:19], s34 offen  lds
s_mov_b64 exec, -1
v_lshlrev_b32 v120, 16, v40
v_and_b32 v121, 0xffff0000, v40
v_pk_fma_f32 v[120:121], v[120:121], v[4:5], v[6:7] neg_lo:[0,0,1] neg_hi:[0,0,1]
v_lshlrev_b32 v122, 16, v41
v_and_b32 v123, 0xffff0000, v41
v_pk_fma_f32 v[122:123], v[122:123], v[4:5], v[6:7] neg_lo:[0,0,1] neg_hi:[0,0,1]
s_lshr_b32 s28, s5, 3
s_add_u32 s28, s28, 2
s_mul_hi_u32 s29, s28, 1431655766
s_mul_i32 s29, s29, 3
s_sub_u32 s28, s28, s29
s_lshl_b32 s28, s28, 2
s_lshr_b32 s28, 1573, s28
s_and_b32 s28, s28, 15
s_mul_i32 s37, s28, 21504
s_mul_i32 s34, s28, 172032
s_add_u32 s34, s34, s35
s_add_u32 s28, s3, 0
s_min_u32 s28, s28, 20
s_lshl_b32 s28, s28, 10
s_add_u32 s28, s28, s37
s_mov_b32 m0, s28
s_nop 0
buffer_load_dwordx4 v184, s[16:19], s34 offen  lds
v_lshlrev_b32 v124, 16, v42
v_and_b32 v125, 0xffff0000, v42
v_pk_fma_f32 v[124:125], v[124:125], v[4:5], v[6:7] neg_lo:[0,0,1] neg_hi:[0,0,1]
v_lshlrev_b32 v126, 16, v43
v_and_b32 v127, 0xffff0000, v43
v_pk_fma_f32 v[126:127], v[126:127], v[4:5], v[6:7] neg_lo:[0,0,1] neg_hi:[0,0,1]
s_add_u32 s28, s3, 4
s_min_u32 s28, s28, 20
s_lshl_b32 s28, s28, 10
s_add_u32 s28, s28, s37
s_mov_b32 m0, s28
s_nop 0
buffer_load_dwordx4 v185, s[16:19], s34 offen  lds
v_lshlrev_b32 v128, 16, v44
v_and_b32 v129, 0xffff0000, v44
v_pk_fma_f32 v[128:129], v[128:129], v[4:5], v[6:7] neg_lo:[0,0,1] neg_hi:[0,0,1]
v_lshlrev_b32 v130, 16, v45
v_and_b32 v131, 0xffff0000, v45
v_pk_fma_f32 v[130:131], v[130:131], v[4:5], v[6:7] neg_lo:[0,0,1] neg_hi:[0,0,1]
s_cmp_lg_u32 s3, 0
s_cbranch_scc1 p0_20
v_lshlrev_b32 v239, 4, v1
s_mov_b32 s36, 327680
buffer_load_dwordx4 v[192:195], v239, s[8:11], s36 offen sc1
s_mov_b32 s36, 328704
buffer_load_dwordx4 v[196:199], v239, s[8:11], s36 offen sc1
s_mov_b32 s36, 329728
buffer_load_dwordx4 v[200:203], v239, s[8:11], s36 offen sc1
s_mov_b32 s36, 330752
buffer_load_dwordx4 v[204:207], v239, s[8:11], s36 offen sc1
s_mov_b32 s36, 331776
buffer_load_dwordx4 v[208:211], v239, s[8:11], s36 offen sc1
s_mov_b32 s36, 332800
buffer_load_dwordx4 v[212:215], v239, s[8:11], s36 offen sc1
s_mov_b32 s36, 333824
buffer_load_dwordx4 v[216:219], v239, s[8:11], s36 offen sc1
p0_20:
v_lshlrev_b32 v132, 16, v46
v_and_b32 v133, 0xffff0000, v46
v_pk_fma_f32 v[132:133], v[132:133], v[4:5], v[6:7] neg_lo:[0,0,1] neg_hi:[0,0,1]
v_lshlrev_b32 v134, 16, v47
v_and_b32 v135, 0xffff0000, v47
v_pk_fma_f32 v[134:135], v[134:135], v[4:5], v[6:7] neg_lo:[0,0,1] neg_hi:[0,0,1]
s_add_u32 s28, s3, 8
s_min_u32 s28, s28, 20
s_lshl_b32 s28, s28, 10
s_add_u32 s28, s28, s37
s_mov_b32 m0, s28
s_nop 0
buffer_load_dwordx4 v186, s[16:19], s34 offen  lds
v_lshlrev_b32 v136, 16, v48
v_and_b32 v137, 0xffff0000, v48
v_pk_fma_f32 v[136:137], v[136:137], v[4:5], v[6:7] neg_lo:[0,0,1] neg_hi:[0,0,1]
v_lshlrev_b32 v138, 16, v49
v_and_b32 v139, 0xffff0000, v49
v_pk_fma_f32 v[138:139], v[138:139], v[4:5], v[6:7] neg_lo:[0,0,1] neg_hi:[0,0,1]
s_add_u32 s28, s3, 12
s_min_u32 s28, s28, 20
s_lshl_b32 s28, s28, 10
s_add_u32 s28, s28, s37
s_mov_b32 m0, s28
s_nop 0
buffer_load_dwordx4 v187, s[16:19], s34 offen  lds
v_lshlrev_b32 v140, 16, v50
v_and_b32 v141, 0xffff0000, v50
v_pk_fma_f32 v[140:141], v[140:141], v[4:5], v[6:7] neg_lo:[0,0,1] neg_hi:[0,0,1]
v_lshlrev_b32 v142, 16, v51
v_and_b32 v143, 0xffff0000, v51
v_pk_fma_f32 v[142:143], v[142:143], v[4:5], v[6:7] neg_lo:[0,0,1] neg_hi:[0,0,1]
s_add_u32 s28, s3, 16
s_min_u32 s28, s28, 20
s_lshl_b32 s28, s28, 10
s_add_u32 s28, s28, s37
s_mov_b32 m0, s28
s_nop 0
buffer_load_dwordx4 v188, s[16:19], s34 offen  lds
v_lshlrev_b32 v144, 16, v52
v_and_b32 v145, 0xffff0000, v52
v_pk_fma_f32 v[144:145], v[144:145], v[4:5], v[6:7] neg_lo:[0,0,1] neg_hi:[0,0,1]
v_lshlrev_b32 v146, 16, v53
v_and_b32 v147, 0xffff0000, v53
v_pk_fma_f32 v[146:147], v[146:147], v[4:5], v[6:7] neg_lo:[0,0,1] neg_hi:[0,0,1]
s_add_u32 s28, s3, 20
s_min_u32 s28, s28, 20
s_lshl_b32 s28, s28, 10
s_add_u32 s28, s28, s37
s_mov_b32 m0, s28
s_cmp_eq_u32 s3, 0
s_cselect_b64 exec, -1, 1
buffer_load_dwordx4 v189, s[16:19], s34 offen  lds
s_mov_b64 exec, -1
v_lshlrev_b32 v148, 16, v54
v_and_b32 v149, 0xffff0000, v54
v_pk_fma_f32 v[148:149], v[148:149], v[4:5], v[6:7] neg_lo:[0,0,1] neg_hi:[0,0,1]
v_lshlrev_b32 v150, 16, v55
v_and_b32 v151, 0xffff0000, v55
v_pk_fma_f32 v[150:151], v[150:151], v[4:5], v[6:7] neg_lo:[0,0,1] neg_hi:[0,0,1]
v_lshlrev_b32 v152, 16, v56
v_and_b32 v153, 0xffff0000, v56
v_pk_fma_f32 v[152:153], v[152:153], v[4:5], v[6:7] neg_lo:[0,0,1] neg_hi:[0,0,1]
v_lshlrev_b32 v154, 16, v57
v_and_b32 v155, 0xffff0000, v57
v_pk_fma_f32 v[154:155], v[154:155], v[4:5], v[6:7] neg_lo:[0,0,1] neg_hi:[0,0,1]
v_lshlrev_b32 v156, 16, v58
v_and_b32 v157, 0xffff0000, v58
v_pk_fma_f32 v[156:157], v[156:157], v[4:5], v[6:7] neg_lo:[0,0,1] neg_hi:[0,0,1]
v_lshlrev_b32 v158, 16, v59
v_and_b32 v159, 0xffff0000, v59
v_pk_fma_f32 v[158:159], v[158:159], v[4:5], v[6:7] neg_lo:[0,0,1] neg_hi:[0,0,1]
v_lshlrev_b32 v160, 16, v60
v_and_b32 v161, 0xffff0000, v60
v_pk_fma_f32 v[160:161], v[160:161], v[4:5], v[6:7] neg_lo:[0,0,1] neg_hi:[0,0,1]
v_lshlrev_b32 v162, 16, v61
v_and_b32 v163, 0xffff0000, v61
v_pk_fma_f32 v[162:163], v[162:163], v[4:5], v[6:7] neg_lo:[0,0,1] neg_hi:[0,0,1]
v_lshlrev_b32 v164, 16, v62
v_and_b32 v165, 0xffff0000, v62
v_pk_fma_f32 v[164:165], v[164:165], v[4:5], v[6:7] neg_lo:[0,0,1] neg_hi:[0,0,1]
v_lshlrev_b32 v166, 16, v63
v_and_b32 v167, 0xffff0000, v63
v_pk_fma_f32 v[166:167], v[166:167], v[4:5], v[6:7] neg_lo:[0,0,1] neg_hi:[0,0,1]
v_lshlrev_b32 v168, 16, v64
v_and_b32 v169, 0xffff0000, v64
v_pk_fma_f32 v[168:169], v[168:169], v[4:5], v[6:7] neg_lo:[0,0,1] neg_hi:[0,0,1]
v_lshlrev_b32 v170, 16, v65
v_and_b32 v171, 0xffff0000, v65
v_pk_fma_f32 v[170:171], v[170:171], v[4:5], v[6:7] neg_lo:[0,0,1] neg_hi:[0,0,1]
v_lshlrev_b32 v172, 16, v66
v_and_b32 v173, 0xffff0000, v66
v_pk_fma_f32 v[172:173], v[172:173], v[4:5], v[6:7] neg_lo:[0,0,1] neg_hi:[0,0,1]
v_lshlrev_b32 v174, 16, v67
v_and_b32 v175, 0xffff0000, v67
v_pk_fma_f32 v[174:175], v[174:175], v[4:5], v[6:7] neg_lo:[0,0,1] neg_hi:[0,0,1]
v_lshlrev_b32 v176, 16, v68
v_and_b32 v177, 0xffff0000, v68
v_pk_fma_f32 v[176:177], v[176:177], v[4:5], v[6:7] neg_lo:[0,0,1] neg_hi:[0,0,1]
v_lshlrev_b32 v178, 16, v69
v_and_b32 v179, 0xffff0000, v69
v_pk_fma_f32 v[178:179], v[178:179], v[4:5], v[6:7] neg_lo:[0,0,1] neg_hi:[0,0,1]
v_lshlrev_b32 v180, 16, v70
v_and_b32 v181, 0xffff0000, v70
v_pk_fma_f32 v[180:181], v[180:181], v[4:5], v[6:7] neg_lo:[0,0,1] neg_hi:[0,0,1]
v_lshlrev_b32 v182, 16, v71
v_and_b32 v183, 0xffff0000, v71
v_pk_fma_f32 v[182:183], v[182:183], v[4:5], v[6:7] neg_lo:[0,0,1] neg_hi:[0,0,1]
s_cmp_eq_u32 s3, 2
s_cbranch_scc1 pi2_21
s_cmp_eq_u32 s3, 3
s_cbranch_scc1 pi3_22
v_add_u32 v2, 0, v1
v_mul_u32_u24 v3, 4682, v2
v_lshrrev_b32 v3, 16, v3
v_mul_u32_u24 v4, 14, v3
v_sub_u32 v4, v2, v4
v_mul_u32_u24 v3, 3584, v3
v_lshl_add_u32 v9, v4, 4, v3
v_add_u32 v2, 64, v1
v_mul_u32_u24 v3, 4682, v2
v_lshrrev_b32 v3, 16, v3
v_mul_u32_u24 v4, 14, v3
v_sub_u32 v4, v2, v4
v_mul_u32_u24 v3, 3584, v3
v_lshl_add_u32 v11, v4, 4, v3
v_add_u32 v2, 128, v1
v_mul_u32_u24 v3, 4682, v2
v_lshrrev_b32 v3, 16, v3
v_mul_u32_u24 v4, 14, v3
v_sub_u32 v4, v2, v4
v_mul_u32_u24 v3, 3584, v3
v_lshl_add_u32 v15, v4, 4, v3
v_add_u32 v2, 192, v1
v_mul_u32_u24 v3, 4682, v2
v_lshrrev_b32 v3, 16, v3
v_mul_u32_u24 v4, 14, v3
v_sub_u32 v4, v2, v4
v_mul_u32_u24 v3, 3584, v3
v_lshl_add_u32 v8, v4, 4, v3
s_min_u32 s28, s2, 223
s_mul_hi_u32 s29, s28, 153391690
s_mul_i32 s30, s29, 28
s_sub_u32 s30, s28, s30
s_mul_i32 s30, s30, 57344
s_mul_i32 s29, s29, 448
s_add_u32 s30, s30, s29
s_mul_i32 s29, s3, 224
s_add_u32 s30, s30, s29
s_mov_b32 s92, s30
s_mov_b32 s93, s30
s_branch pie_23
pi2_21:
v_add_u32 v2, 0, v1
v_mul_u32_u24 v3, 4682, v2
v_lshrrev_b32 v3, 16, v3
v_mul_u32_u24 v4, 14, v3
v_sub_u32 v4, v2, v4
v_mul_u32_u24 v3, 896, v3
v_lshl_add_u32 v9, v4, 4, v3
v_add_u32 v2, 64, v1
v_mul_u32_u24 v3, 4682, v2
v_lshrrev_b32 v3, 16, v3
v_mul_u32_u24 v4, 14, v3
v_sub_u32 v4, v2, v4
v_mul_u32_u24 v3, 896, v3
v_lshl_add_u32 v11, v4, 4, v3
v_add_u32 v2, 128, v1
v_mul_u32_u24 v3, 4682, v2
v_lshrrev_b32 v3, 16, v3
v_mul_u32_u24 v4, 14, v3
v_sub_u32 v4, v2, v4
v_mul_u32_u24 v3, 896, v3
v_lshl_add_u32 v15, v4, 4, v3
v_add_u32 v2, 192, v1
v_mul_u32_u24 v3, 4682, v2
v_lshrrev_b32 v3, 16, v3
v_mul_u32_u24 v4, 14, v3
v_sub_u32 v4, v2, v4
v_mul_u32_u24 v3, 896, v3
v_lshl_add_u32 v8, v4, 4, v3
s_min_u32 s28, s2, 223
s_cmp_ge_u32 s28, 112
s_cselect_b32 s29, 1, 0
s_mul_i32 s30, s29, 112
s_sub_u32 s30, s28, s30
s_mul_i32 s30, s30, 14336
s_mul_i32 s29, s29, 448
s_add_u32 s30, s30, s29
s_add_u32 s31, s30, 224
s_mov_b32 s92, s30
s_mov_b32 s93, s31
s_branch pie_23
pi3_22:
v_add_u32 v2, 0, v1
v_mul_u32_u24 v3, 4682, v2
v_lshrrev_b32 v3, 16, v3
v_mul_u32_u24 v4, 14, v3
v_sub_u32 v4, v2, v4
v_mul_u32_u24 v3, 896, v3
v_lshl_add_u32 v9, v4, 4, v3
v_add_u32 v2, 64, v1
v_mul_u32_u24 v3, 4682, v2
v_lshrrev_b32 v3, 16, v3
v_mul_u32_u24 v4, 14, v3
v_sub_u32 v4, v2, v4
v_mul_u32_u24 v3, 896, v3
v_lshl_add_u32 v11, v4, 4, v3
v_add_u32 v2, 128, v1
v_mul_u32_u24 v3, 4682, v2
v_lshrrev_b32 v3, 16, v3
v_mul_u32_u24 v4, 14, v3
v_sub_u32 v4, v2, v4
v_mul_u32_u24 v3, 896, v3
v_lshl_add_u32 v15, v4, 4, v3
v_add_u32 v2, 192, v1
v_mul_u32_u24 v3, 4682, v2
v_lshrrev_b32 v3, 16, v3
v_mul_u32_u24 v4, 14, v3
v_sub_u32 v4, v2, v4
v_mul_u32_u24 v3, 896, v3
v_lshl_add_u32 v8, v4, 4, v3
s_max_u32 s28, s2, 192
s_sub_u32 s28, s28, 192
s_lshr_b32 s29, s28, 2
s_mul_i32 s29, s29, 28
s_bfe_u32 s30, s28, 0x10001
s_lshl_b32 s30, s30, 4
s_add_u32 s29, s29, s30
s_mul_i32 s30, s29, 896
s_and_b32 s29, s28, 1
s_mul_i32 s29, s29, 448
s_add_u32 s30, s30, s29
s_add_u32 s31, s30, 224
s_mov_b32 s92, s30
s_mov_b32 s93, s31
pie_23:
s_and_b32 s28, s5, 7
s_sub_u32 s28, s28, 1
s_lshr_b32 s29, s5, 3
s_lshl_b32 s29, s29, 1
s_add_u32 s29, s29, s28
s_lshl_b32 s45, s4, 3
s_add_u32 s45, s45, s29
s_add_u32 s45, s45, 28
s_cmp_lt_u32 s28, 2
s_cselect_b32 s45, s45, 99
v_lshrrev_b32 v2, 2, v0
v_and_b32 v3, 3, v0
v_mul_u32_u24 v236, 5376, v2
v_lshl_add_u32 v236, v3, 4, v236
s_lshl_b32 s91, s45, 6
v_lshrrev_b32 v237, 1, v2
v_lshlrev_b32 v237, 2, v237
v_lshrrev_b32 v2, 5, v1
v_and_b32 v3, 15, v1
v_lshrrev_b32 v4, 2, v3
v_lshl_add_u32 v4, v2, 3, v4
v_mul_u32_u24 v4, 336, v4
v_bfe_u32 v5, v1, 4, 1
v_lshl_add_u32 v4, v5, 5, v4
v_and_b32 v5, 3, v1
v_lshl_add_u32 v4, v5, 3, v4
s_mul_i32 s28, s7, 75264
s_mul_i32 s29, s7, 168
s_sub_u32 s30, 168, s29
s_add_u32 s29, s29, s28
s_add_u32 s30, s30, s28
v_add_u32 v232, s29, v4
v_add_u32 v233, 43008, v232
v_add_u32 v234, s30, v4
v_add_u32 v235, 43008, v234
s_mul_i32 s28, s7, 896
s_add_u32 s28, s28, 150528
v_lshlrev_b32 v5, 5, v2
v_add_u32 v238, s28, v5
s_cmp_lg_u32 s3, 0
s_cbranch_scc1 p0_24
s_mov_b32 s38, 0
s_waitcnt vmcnt(4)
mp_25:
v_cmp_ne_u32 vcc, s88, v193
v_cmp_ne_u32 s[30:31], s88, v195
s_or_b64 vcc, vcc, s[30:31]
v_cmp_ne_u32 s[30:31], s88, v197
s_or_b64 vcc, vcc, s[30:31]
v_cmp_ne_u32 s[30:31], s88, v199
s_or_b64 vcc, vcc, s[30:31]
v_cmp_ne_u32 s[30:31], s88, v201
s_or_b64 vcc, vcc, s[30:31]
v_cmp_ne_u32 s[30:31], s88, v203
s_or_b64 vcc, vcc, s[30:31]
v_cmp_ne_u32 s[30:31], s88, v205
s_or_b64 vcc, vcc, s[30:31]
v_cmp_ne_u32 s[30:31], s88, v207
s_or_b64 vcc, vcc, s[30:31]
v_cmp_ne_u32 s[30:31], s88, v209
s_or_b64 vcc, vcc, s[30:31]
v_cmp_ne_u32 s[30:31], s88, v211
s_or_b64 vcc, vcc, s[30:31]
v_cmp_ne_u32 s[30:31], s88, v213
s_or_b64 vcc, vcc, s[30:31]
v_cmp_ne_u32 s[30:31], s88, v215
s_or_b64 vcc, vcc, s[30:31]
v_cmp_ne_u32 s[30:31], s88, v217
s_or_b64 vcc, vcc, s[30:31]
v_cmp_ne_u32 s[30:31], s88, v219
s_or_b64 vcc, vcc, s[30:31]
s_cbranch_vccz mp_26
s_add_u32 s38, s38, 1
s_cmp_ge_u32 s38, 131072
s_cbranch_scc1 mp_26
s_sleep 2
v_lshlrev_b32 v239, 4, v1
s_mov_b32 s36, 327680
buffer_load_dwordx4 v[192:195], v239, s[8:11], s36 offen sc1
s_mov_b32 s36, 328704
buffer_load_dwordx4 v[196:199], v239, s[8:11], s36 offen sc1
s_mov_b32 s36, 329728
buffer_load_dwordx4 v[200:203], v239, s[8:11], s36 offen sc1
s_mov_b32 s36, 330752
buffer_load_dwordx4 v[204:207], v239, s[8:11], s36 offen sc1
s_mov_b32 s36, 331776
buffer_load_dwordx4 v[208:211], v239, s[8:11], s36 offen sc1
s_mov_b32 s36, 332800
buffer_load_dwordx4 v[212:215], v239, s[8:11], s36 offen sc1
s_mov_b32 s36, 333824
buffer_load_dwordx4 v[216:219], v239, s[8:11], s36 offen sc1
s_waitcnt vmcnt(0)
s_branch mp_25
mp_26:
v_lshlrev_b32 v2, 3, v1
v_add_u32 v2, 150528, v2
v_mov_b32 v193, v194
ds_write_b64 v2, v[192:193] offset:0
v_mov_b32 v197, v198
ds_write_b64 v2, v[196:197] offset:512
v_mov_b32 v201, v202
ds_write_b64 v2, v[200:201] offset:1024
v_mov_b32 v205, v206
ds_write_b64 v2, v[204:205] offset:1536
v_mov_b32 v209, v210
ds_write_b64 v2, v[208:209] offset:2048
v_mov_b32 v213, v214
ds_write_b64 v2, v[212:213] offset:2560
v_mov_b32 v217, v218
ds_write_b64 v2, v[216:217] offset:3072
p0_24:
s_waitcnt lgkmcnt(0)
s_waitcnt vmcnt(18)
s_barrier
ds_read_b128 v[240:243], v238 offset:1792
ds_read_b128 v[244:247], v238 offset:1808
ds_read_b128 v[248:251], v238 offset:0
ds_read_b128 v[252:255], v238 offset:16
ds_read_b64_tr_b16 v[16:17], v232 offset:0
ds_read_b64_tr_b16 v[18:19], v232 offset:1344
ds_read_b64_tr_b16 v[20:21], v232 offset:56
ds_read_b64_tr_b16 v[22:23], v232 offset:1400
ds_read_b64_tr_b16 v[24:25], v232 offset:112
ds_read_b64_tr_b16 v[26:27], v232 offset:1456
ds_read_b64_tr_b16 v[28:29], v234 offset:0
ds_read_b64_tr_b16 v[30:31], v234 offset:1344
ds_read_b64_tr_b16 v[32:33], v234 offset:56
ds_read_b64_tr_b16 v[34:35], v234 offset:1400
ds_read_b64_tr_b16 v[36:37], v234 offset:112
ds_read_b64_tr_b16 v[38:39], v234 offset:1456
s_waitcnt lgkmcnt(12)
v_fma_f32 v72, v72, v240, v248
v_fma_f32 v73, v73, v241, v249
v_fma_f32 v74, v74, v242, v250
v_fma_f32 v75, v75, v243, v251
v_fma_f32 v76, v76, v244, v252
v_fma_f32 v77, v77, v245, v253
v_fma_f32 v78, v78, v246, v254
v_fma_f32 v79, v79, v247, v255
v_cvt_pk_bf16_f32 v64, v72, v73
v_cvt_pk_bf16_f32 v65, v74, v75
v_cvt_pk_bf16_f32 v66, v76, v77
v_cvt_pk_bf16_f32 v67, v78, v79
ds_read_b128 v[240:243], v238 offset:1856
ds_read_b128 v[244:247], v238 offset:1872
ds_read_b128 v[248:251], v238 offset:64
ds_read_b128 v[252:255], v238 offset:80
s_waitcnt lgkmcnt(4)
v_mfma_f32_32x32x16_bf16 v[184:199], v[16:19], v[64:67], 0
ds_read_b64_tr_b16 v[40:41], v232 offset:5376
ds_read_b64_tr_b16 v[42:43], v232 offset:6720
s_waitcnt lgkmcnt(2)
v_fma_f32 v80, v80, v240, v248
v_fma_f32 v81, v81, v241, v249
v_mfma_f32_32x32x16_bf16 v[200:215], v[20:23], v[64:67], 0
ds_read_b64_tr_b16 v[44:45], v232 offset:5432
ds_read_b64_tr_b16 v[46:47], v232 offset:6776
v_fma_f32 v82, v82, v242, v250
v_fma_f32 v83, v83, v243, v251
v_fma_f32 v84, v84, v244, v252
v_mfma_f32_32x32x16_bf16 v[216:231], v[24:27], v[64:67], 0
ds_read_b64_tr_b16 v[48:49], v232 offset:5488
ds_read_b64_tr_b16 v[50:51], v232 offset:6832
v_fma_f32 v85, v85, v245, v253
v_fma_f32 v86, v86, v246, v254
v_fma_f32 v87, v87, v247, v255
v_mfma_f32_32x32x16_bf16 a[0:15], v[28:31], v[64:67], 0
ds_read_b64_tr_b16 v[52:53], v234 offset:5376
ds_read_b64_tr_b16 v[54:55], v234 offset:6720
v_cvt_pk_bf16_f32 v68, v80, v81
v_cvt_pk_bf16_f32 v69, v82, v83
v_mfma_f32_32x32x16_bf16 a[16:31], v[32:35], v[64:67], 0
ds_read_b64_tr_b16 v[56:57], v234 offset:5432
ds_read_b64_tr_b16 v[58:59], v234 offset:6776
v_cvt_pk_bf16_f32 v70, v84, v85
v_cvt_pk_bf16_f32 v71, v86, v87
ds_read_b128 v[240:243], v238 offset:1920
ds_read_b128 v[244:247], v238 offset:1936
v_mfma_f32_32x32x16_bf16 a[32:47], v[36:39], v[64:67], 0
ds_read_b64_tr_b16 v[60:61], v234 offset:5488
ds_read_b64_tr_b16 v[62:63], v234 offset:6832
ds_read_b128 v[248:251], v238 offset:128
ds_read_b128 v[252:255], v238 offset:144
buffer_load_dwordx4 a[48:51], v9, s[12:15], s92 offen
buffer_load_dwordx4 a[52:55], v11, s[12:15], s92 offen
s_waitcnt lgkmcnt(2)
v_mfma_f32_32x32x16_bf16 v[184:199], v[40:43], v[68:71], v[184:199]
ds_read_b64_tr_b16 v[16:17], v232 offset:10752
ds_read_b64_tr_b16 v[18:19], v232 offset:12096
s_waitcnt lgkmcnt(2)
v_fma_f32 v88, v88, v240, v248
v_fma_f32 v89, v89, v241, v249
v_mfma_f32_32x32x16_bf16 v[200:215], v[44:47], v[68:71], v[200:215]
ds_read_b64_tr_b16 v[20:21], v232 offset:10808
ds_read_b64_tr_b16 v[22:23], v232 offset:12152
v_fma_f32 v90, v90, v242, v250
v_fma_f32 v91, v91, v243, v251
v_fma_f32 v92, v92, v244, v252
v_mfma_f32_32x32x16_bf16 v[216:231], v[48:51], v[68:71], v[216:231]
ds_read_b64_tr_b16 v[24:25], v232 offset:10864
ds_read_b64_tr_b16 v[26:27], v232 offset:12208
v_fma_f32 v93, v93, v245, v253
v_fma_f32 v94, v94, v246, v254
v_fma_f32 v95, v95, v247, v255
v_mfma_f32_32x32x16_bf16 a[0:15], v[52:55], v[68:71], a[0:15]
ds_read_b64_tr_b16 v[28:29], v234 offset:10752
ds_read_b64_tr_b16 v[30:31], v234 offset:12096
v_cvt_pk_bf16_f32 v64, v88, v89
v_cvt_pk_bf16_f32 v65, v90, v91
v_mfma_f32_32x32x16_bf16 a[16:31], v[56:59], v[68:71], a[16:31]
ds_read_b64_tr_b16 v[32:33], v234 offset:10808
ds_read_b64_tr_b16 v[34:35], v234 offset:12152
v_cvt_pk_bf16_f32 v66, v92, v93
v_cvt_pk_bf16_f32 v67, v94, v95
ds_read_b128 v[240:243], v238 offset:1984
ds_read_b128 v[244:247], v238 offset:2000
v_mfma_f32_32x32x16_bf16 a[32:47], v[60:63], v[68:71], a[32:47]
ds_read_b64_tr_b16 v[36:37], v234 offset:10864
ds_read_b64_tr_b16 v[38:39], v234 offset:12208
ds_read_b128 v[248:251], v238 offset:192
ds_read_b128 v[252:255], v238 offset:208
buffer_load_dwordx4 a[56:59], v15, s[12:15], s92 offen
s_mov_b32 exec_hi, 0
buffer_load_dwordx4 a[60:63], v8, s[12:15], s92 offen
s_mov_b32 exec_hi, -1
s_waitcnt lgkmcnt(2)
v_mfma_f32_32x32x16_bf16 v[184:199], v[16:19], v[64:67], v[184:199]
ds_read_b64_tr_b16 v[40:41], v232 offset:16128
ds_read_b64_tr_b16 v[42:43], v232 offset:17472
s_waitcnt lgkmcnt(2)
v_fma_f32 v96, v96, v240, v248
v_fma_f32 v97, v97, v241, v249
v_mfma_f32_32x32x16_bf16 v[200:215], v[20:23], v[64:67], v[200:215]
ds_read_b64_tr_b16 v[44:45], v232 offset:16184
ds_read_b64_tr_b16 v[46:47], v232 offset:17528
v_fma_f32 v98, v98, v242, v250
v_fma_f32 v99, v99, v243, v251
v_fma_f32 v100, v100, v244, v252
v_mfma_f32_32x32x16_bf16 v[216:231], v[24:27], v[64:67], v[216:231]
ds_read_b64_tr_b16 v[48:49], v232 offset:16240
ds_read_b64_tr_b16 v[50:51], v232 offset:17584
v_fma_f32 v101, v101, v245, v253
v_fma_f32 v102, v102, v246, v254
v_fma_f32 v103, v103, v247, v255
v_mfma_f32_32x32x16_bf16 a[0:15], v[28:31], v[64:67], a[0:15]
ds_read_b64_tr_b16 v[52:53], v234 offset:16128
ds_read_b64_tr_b16 v[54:55], v234 offset:17472
v_cvt_pk_bf16_f32 v68, v96, v97
v_cvt_pk_bf16_f32 v69, v98, v99
v_mfma_f32_32x32x16_bf16 a[16:31], v[32:35], v[64:67], a[16:31]
ds_read_b64_tr_b16 v[56:57], v234 offset:16184
ds_read_b64_tr_b16 v[58:59], v234 offset:17528
v_cvt_pk_bf16_f32 v70, v100, v101
v_cvt_pk_bf16_f32 v71, v102, v103
ds_read_b128 v[240:243], v238 offset:2048
ds_read_b128 v[244:247], v238 offset:2064
v_mfma_f32_32x32x16_bf16 a[32:47], v[36:39], v[64:67], a[32:47]
ds_read_b64_tr_b16 v[60:61], v234 offset:16240
ds_read_b64_tr_b16 v[62:63], v234 offset:17584
ds_read_b128 v[248:251], v238 offset:256
ds_read_b128 v[252:255], v238 offset:272
buffer_load_dwordx4 a[64:67], v9, s[40:43], s93 offen
buffer_load_dwordx4 a[68:71], v11, s[40:43], s93 offen
s_waitcnt lgkmcnt(2)
v_mfma_f32_32x32x16_bf16 v[184:199], v[40:43], v[68:71], v[184:199]
ds_read_b64_tr_b16 v[16:17], v232 offset:21504
ds_read_b64_tr_b16 v[18:19], v232 offset:22848
s_waitcnt lgkmcnt(2)
v_fma_f32 v104, v104, v240, v248
v_fma_f32 v105, v105, v241, v249
v_mfma_f32_32x32x16_bf16 v[200:215], v[44:47], v[68:71], v[200:215]
ds_read_b64_tr_b16 v[20:21], v232 offset:21560
ds_read_b64_tr_b16 v[22:23], v232 offset:22904
v_fma_f32 v106, v106, v242, v250
v_fma_f32 v107, v107, v243, v251
v_fma_f32 v108, v108, v244, v252
v_mfma_f32_32x32x16_bf16 v[216:231], v[48:51], v[68:71], v[216:231]
ds_read_b64_tr_b16 v[24:25], v232 offset:21616
ds_read_b64_tr_b16 v[26:27], v232 offset:22960
v_fma_f32 v109, v109, v245, v253
v_fma_f32 v110, v110, v246, v254
v_fma_f32 v111, v111, v247, v255
v_mfma_f32_32x32x16_bf16 a[0:15], v[52:55], v[68:71], a[0:15]
ds_read_b64_tr_b16 v[28:29], v234 offset:21504
ds_read_b64_tr_b16 v[30:31], v234 offset:22848
v_cvt_pk_bf16_f32 v64, v104, v105
v_cvt_pk_bf16_f32 v65, v106, v107
v_mfma_f32_32x32x16_bf16 a[16:31], v[56:59], v[68:71], a[16:31]
ds_read_b64_tr_b16 v[32:33], v234 offset:21560
ds_read_b64_tr_b16 v[34:35], v234 offset:22904
v_cvt_pk_bf16_f32 v66, v108, v109
v_cvt_pk_bf16_f32 v67, v110, v111
ds_read_b128 v[240:243], v238 offset:2112
ds_read_b128 v[244:247], v238 offset:2128
v_mfma_f32_32x32x16_bf16 a[32:47], v[60:63], v[68:71], a[32:47]
ds_read_b64_tr_b16 v[36:37], v234 offset:21616
ds_read_b64_tr_b16 v[38:39], v234 offset:22960
ds_read_b128 v[248:251], v238 offset:320
ds_read_b128 v[252:255], v238 offset:336
buffer_load_dwordx4 a[72:75], v15, s[40:43], s93 offen
s_mov_b32 exec_hi, 0
buffer_load_dwordx4 a[76:79], v8, s[40:43], s93 offen
s_mov_b32 exec_hi, -1
s_waitcnt lgkmcnt(2)
v_mfma_f32_32x32x16_bf16 v[184:199], v[16:19], v[64:67], v[184:199]
ds_read_b64_tr_b16 v[40:41], v232 offset:26880
ds_read_b64_tr_b16 v[42:43], v232 offset:28224
s_waitcnt lgkmcnt(2)
v_fma_f32 v112, v112, v240, v248
v_fma_f32 v113, v113, v241, v249
v_mfma_f32_32x32x16_bf16 v[200:215], v[20:23], v[64:67], v[200:215]
ds_read_b64_tr_b16 v[44:45], v232 offset:26936
ds_read_b64_tr_b16 v[46:47], v232 offset:28280
v_fma_f32 v114, v114, v242, v250
v_fma_f32 v115, v115, v243, v251
v_fma_f32 v116, v116, v244, v252
v_mfma_f32_32x32x16_bf16 v[216:231], v[24:27], v[64:67], v[216:231]
ds_read_b64_tr_b16 v[48:49], v232 offset:26992
ds_read_b64_tr_b16 v[50:51], v232 offset:28336
v_fma_f32 v117, v117, v245, v253
v_fma_f32 v118, v118, v246, v254
v_fma_f32 v119, v119, v247, v255
v_mfma_f32_32x32x16_bf16 a[0:15], v[28:31], v[64:67], a[0:15]
ds_read_b64_tr_b16 v[52:53], v234 offset:26880
ds_read_b64_tr_b16 v[54:55], v234 offset:28224
v_cvt_pk_bf16_f32 v68, v112, v113
v_cvt_pk_bf16_f32 v69, v114, v115
v_mfma_f32_32x32x16_bf16 a[16:31], v[32:35], v[64:67], a[16:31]
ds_read_b64_tr_b16 v[56:57], v234 offset:26936
ds_read_b64_tr_b16 v[58:59], v234 offset:28280
v_cvt_pk_bf16_f32 v70, v116, v117
v_cvt_pk_bf16_f32 v71, v118, v119
ds_read_b128 v[240:243], v238 offset:2176
ds_read_b128 v[244:247], v238 offset:2192
v_mfma_f32_32x32x16_bf16 a[32:47], v[36:39], v[64:67], a[32:47]
ds_read_b64_tr_b16 v[60:61], v234 offset:26992
ds_read_b64_tr_b16 v[62:63], v234 offset:28336
ds_read_b128 v[248:251], v238 offset:384
ds_read_b128 v[252:255], v238 offset:400
s_waitcnt vmcnt(8)
s_barrier
s_waitcnt lgkmcnt(2)
v_mfma_f32_32x32x16_bf16 v[184:199], v[40:43], v[68:71], v[184:199]
ds_read_b64_tr_b16 v[16:17], v232 offset:32256
ds_read_b64_tr_b16 v[18:19], v232 offset:33600
s_waitcnt lgkmcnt(2)
v_fma_f32 v120, v120, v240, v248
v_fma_f32 v121, v121, v241, v249
v_mfma_f32_32x32x16_bf16 v[200:215], v[44:47], v[68:71], v[200:215]
ds_read_b64_tr_b16 v[20:21], v232 offset:32312
ds_read_b64_tr_b16 v[22:23], v232 offset:33656
v_fma_f32 v122, v122, v242, v250
v_fma_f32 v123, v123, v243, v251
v_fma_f32 v124, v124, v244, v252
v_mfma_f32_32x32x16_bf16 v[216:231], v[48:51], v[68:71], v[216:231]
ds_read_b64_tr_b16 v[24:25], v232 offset:32368
ds_read_b64_tr_b16 v[26:27], v232 offset:33712
v_fma_f32 v125, v125, v245, v253
v_fma_f32 v126, v126, v246, v254
v_fma_f32 v127, v127, v247, v255
v_mfma_f32_32x32x16_bf16 a[0:15], v[52:55], v[68:71], a[0:15]
ds_read_b64_tr_b16 v[28:29], v234 offset:32256
ds_read_b64_tr_b16 v[30:31], v234 offset:33600
v_cvt_pk_bf16_f32 v64, v120, v121
v_cvt_pk_bf16_f32 v65, v122, v123
v_mfma_f32_32x32x16_bf16 a[16:31], v[56:59], v[68:71], a[16:31]
ds_read_b64_tr_b16 v[32:33], v234 offset:32312
ds_read_b64_tr_b16 v[34:35], v234 offset:33656
v_cvt_pk_bf16_f32 v66, v124, v125
v_cvt_pk_bf16_f32 v67, v126, v127
ds_read_b128 v[240:243], v238 offset:2240
ds_read_b128 v[244:247], v238 offset:2256
v_mfma_f32_32x32x16_bf16 a[32:47], v[60:63], v[68:71], a[32:47]
ds_read_b64_tr_b16 v[36:37], v234 offset:32368
ds_read_b64_tr_b16 v[38:39], v234 offset:33712
ds_read_b128 v[248:251], v238 offset:448
ds_read_b128 v[252:255], v238 offset:464
s_cmp_ge_u32 s45, 84
s_cbranch_scc1 mri_27
buffer_load_dword a108, v237, s[20:23], 0 offen offset:0
mri_27:
s_cmp_ge_u32 s45, 84
s_cbranch_scc1 mri_28
buffer_load_dword a109, v237, s[20:23], 0 offen offset:128
mri_28:
s_waitcnt lgkmcnt(2)
v_mfma_f32_32x32x16_bf16 v[184:199], v[16:19], v[64:67], v[184:199]
ds_read_b64_tr_b16 v[40:41], v232 offset:37632
ds_read_b64_tr_b16 v[42:43], v232 offset:38976
s_waitcnt lgkmcnt(2)
v_fma_f32 v128, v128, v240, v248
v_fma_f32 v129, v129, v241, v249
v_mfma_f32_32x32x16_bf16 v[200:215], v[20:23], v[64:67], v[200:215]
ds_read_b64_tr_b16 v[44:45], v232 offset:37688
ds_read_b64_tr_b16 v[46:47], v232 offset:39032
v_fma_f32 v130, v130, v242, v250
v_fma_f32 v131, v131, v243, v251
v_fma_f32 v132, v132, v244, v252
v_mfma_f32_32x32x16_bf16 v[216:231], v[24:27], v[64:67], v[216:231]
ds_read_b64_tr_b16 v[48:49], v232 offset:37744
ds_read_b64_tr_b16 v[50:51], v232 offset:39088
v_fma_f32 v133, v133, v245, v253
v_fma_f32 v134, v134, v246, v254
v_fma_f32 v135, v135, v247, v255
v_mfma_f32_32x32x16_bf16 a[0:15], v[28:31], v[64:67], a[0:15]
ds_read_b64_tr_b16 v[52:53], v234 offset:37632
ds_read_b64_tr_b16 v[54:55], v234 offset:38976
v_cvt_pk_bf16_f32 v68, v128, v129
v_cvt_pk_bf16_f32 v69, v130, v131
v_mfma_f32_32x32x16_bf16 a[16:31], v[32:35], v[64:67], a[16:31]
ds_read_b64_tr_b16 v[56:57], v234 offset:37688
ds_read_b64_tr_b16 v[58:59], v234 offset:39032
v_cvt_pk_bf16_f32 v70, v132, v133
v_cvt_pk_bf16_f32 v71, v134, v135
ds_read_b128 v[240:243], v238 offset:2304
ds_read_b128 v[244:247], v238 offset:2320
v_mfma_f32_32x32x16_bf16 a[32:47], v[36:39], v[64:67], a[32:47]
ds_read_b64_tr_b16 v[60:61], v234 offset:37744
ds_read_b64_tr_b16 v[62:63], v234 offset:39088
ds_read_b128 v[248:251], v238 offset:512
ds_read_b128 v[252:255], v238 offset:528
s_cmp_ge_u32 s45, 84
s_cbranch_scc1 mri_29
buffer_load_dword a110, v237, s[20:23], 0 offen offset:256
mri_29:
s_cmp_ge_u32 s45, 84
s_cbranch_scc1 mri_30
buffer_load_dword a111, v237, s[20:23], 0 offen offset:384
mri_30:
s_waitcnt lgkmcnt(2)
v_mfma_f32_32x32x16_bf16 v[184:199], v[40:43], v[68:71], v[184:199]
ds_read_b64_tr_b16 v[16:17], v233 offset:0
ds_read_b64_tr_b16 v[18:19], v233 offset:1344
s_waitcnt lgkmcnt(2)
v_fma_f32 v136, v136, v240, v248
v_fma_f32 v137, v137, v241, v249
v_mfma_f32_32x32x16_bf16 v[200:215], v[44:47], v[68:71], v[200:215]
ds_read_b64_tr_b16 v[20:21], v233 offset:56
ds_read_b64_tr_b16 v[22:23], v233 offset:1400
v_fma_f32 v138, v138, v242, v250
v_fma_f32 v139, v139, v243, v251
v_fma_f32 v140, v140, v244, v252
v_mfma_f32_32x32x16_bf16 v[216:231], v[48:51], v[68:71], v[216:231]
ds_read_b64_tr_b16 v[24:25], v233 offset:112
ds_read_b64_tr_b16 v[26:27], v233 offset:1456
v_fma_f32 v141, v141, v245, v253
v_fma_f32 v142, v142, v246, v254
v_fma_f32 v143, v143, v247, v255
v_mfma_f32_32x32x16_bf16 a[0:15], v[52:55], v[68:71], a[0:15]
ds_read_b64_tr_b16 v[28:29], v235 offset:0
ds_read_b64_tr_b16 v[30:31], v235 offset:1344
v_cvt_pk_bf16_f32 v64, v136, v137
v_cvt_pk_bf16_f32 v65, v138, v139
v_mfma_f32_32x32x16_bf16 a[16:31], v[56:59], v[68:71], a[16:31]
ds_read_b64_tr_b16 v[32:33], v235 offset:56
ds_read_b64_tr_b16 v[34:35], v235 offset:1400
v_cvt_pk_bf16_f32 v66, v140, v141
v_cvt_pk_bf16_f32 v67, v142, v143
ds_read_b128 v[240:243], v238 offset:2368
ds_read_b128 v[244:247], v238 offset:2384
v_mfma_f32_32x32x16_bf16 a[32:47], v[60:63], v[68:71], a[32:47]
ds_read_b64_tr_b16 v[36:37], v235 offset:112
ds_read_b64_tr_b16 v[38:39], v235 offset:1456
ds_read_b128 v[248:251], v238 offset:576
ds_read_b128 v[252:255], v238 offset:592
s_cmp_ge_u32 s45, 84
s_cbranch_scc1 mri_31
buffer_load_dword a112, v237, s[20:23], 0 offen offset:512
mri_31:
s_cmp_ge_u32 s45, 84
s_cbranch_scc1 mri_32
buffer_load_dword a113, v237, s[20:23], 0 offen offset:640
mri_32:
s_waitcnt lgkmcnt(2)
v_mfma_f32_32x32x16_bf16 v[184:199], v[16:19], v[64:67], v[184:199]
ds_read_b64_tr_b16 v[40:41], v233 offset:5376
ds_read_b64_tr_b16 v[42:43], v233 offset:6720
s_waitcnt lgkmcnt(2)
v_fma_f32 v144, v144, v240, v248
v_fma_f32 v145, v145, v241, v249
v_mfma_f32_32x32x16_bf16 v[200:215], v[20:23], v[64:67], v[200:215]
ds_read_b64_tr_b16 v[44:45], v233 offset:5432
ds_read_b64_tr_b16 v[46:47], v233 offset:6776
v_fma_f32 v146, v146, v242, v250
v_fma_f32 v147, v147, v243, v251
v_fma_f32 v148, v148, v244, v252
v_mfma_f32_32x32x16_bf16 v[216:231], v[24:27], v[64:67], v[216:231]
ds_read_b64_tr_b16 v[48:49], v233 offset:5488
ds_read_b64_tr_b16 v[50:51], v233 offset:6832
v_fma_f32 v149, v149, v245, v253
v_fma_f32 v150, v150, v246, v254
v_fma_f32 v151, v151, v247, v255
v_mfma_f32_32x32x16_bf16 a[0:15], v[28:31], v[64:67], a[0:15]
ds_read_b64_tr_b16 v[52:53], v235 offset:5376
ds_read_b64_tr_b16 v[54:55], v235 offset:6720
v_cvt_pk_bf16_f32 v68, v144, v145
v_cvt_pk_bf16_f32 v69, v146, v147
v_mfma_f32_32x32x16_bf16 a[16:31], v[32:35], v[64:67], a[16:31]
ds_read_b64_tr_b16 v[56:57], v235 offset:5432
ds_read_b64_tr_b16 v[58:59], v235 offset:6776
v_cvt_pk_bf16_f32 v70, v148, v149
v_cvt_pk_bf16_f32 v71, v150, v151
ds_read_b128 v[240:243], v238 offset:2432
ds_read_b128 v[244:247], v238 offset:2448
v_mfma_f32_32x32x16_bf16 a[32:47], v[36:39], v[64:67], a[32:47]
ds_read_b64_tr_b16 v[60:61], v235 offset:5488
ds_read_b64_tr_b16 v[62:63], v235 offset:6832
ds_read_b128 v[248:251], v238 offset:640
ds_read_b128 v[252:255], v238 offset:656
s_cmp_ge_u32 s45, 84
s_cbranch_scc1 mri_33
buffer_load_dword a114, v237, s[20:23], 0 offen offset:768
mri_33:
s_cmp_ge_u32 s45, 84
s_cbranch_scc1 mri_34
s_add_u32 s30, s91, 0
buffer_load_dwordx4 a[80:83], v236, s[24:27], s30 offen
mri_34:
s_waitcnt lgkmcnt(2)
v_mfma_f32_32x32x16_bf16 v[184:199], v[40:43], v[68:71], v[184:199]
ds_read_b64_tr_b16 v[16:17], v233 offset:10752
ds_read_b64_tr_b16 v[18:19], v233 offset:12096
s_waitcnt lgkmcnt(2)
v_fma_f32 v152, v152, v240, v248
v_fma_f32 v153, v153, v241, v249
v_mfma_f32_32x32x16_bf16 v[200:215], v[44:47], v[68:71], v[200:215]
ds_read_b64_tr_b16 v[20:21], v233 offset:10808
ds_read_b64_tr_b16 v[22:23], v233 offset:12152
v_fma_f32 v154, v154, v242, v250
v_fma_f32 v155, v155, v243, v251
v_fma_f32 v156, v156, v244, v252
v_mfma_f32_32x32x16_bf16 v[216:231], v[48:51], v[68:71], v[216:231]
ds_read_b64_tr_b16 v[24:25], v233 offset:10864
ds_read_b64_tr_b16 v[26:27], v233 offset:12208
v_fma_f32 v157, v157, v245, v253
v_fma_f32 v158, v158, v246, v254
v_fma_f32 v159, v159, v247, v255
v_mfma_f32_32x32x16_bf16 a[0:15], v[52:55], v[68:71], a[0:15]
ds_read_b64_tr_b16 v[28:29], v235 offset:10752
ds_read_b64_tr_b16 v[30:31], v235 offset:12096
v_cvt_pk_bf16_f32 v64, v152, v153
v_cvt_pk_bf16_f32 v65, v154, v155
v_mfma_f32_32x32x16_bf16 a[16:31], v[56:59], v[68:71], a[16:31]
ds_read_b64_tr_b16 v[32:33], v235 offset:10808
ds_read_b64_tr_b16 v[34:35], v235 offset:12152
v_cvt_pk_bf16_f32 v66, v156, v157
v_cvt_pk_bf16_f32 v67, v158, v159
ds_read_b128 v[240:243], v238 offset:2496
ds_read_b128 v[244:247], v238 offset:2512
v_mfma_f32_32x32x16_bf16 a[32:47], v[60:63], v[68:71], a[32:47]
ds_read_b64_tr_b16 v[36:37], v235 offset:10864
ds_read_b64_tr_b16 v[38:39], v235 offset:12208
ds_read_b128 v[248:251], v238 offset:704
ds_read_b128 v[252:255], v238 offset:720
s_cmp_ge_u32 s45, 84
s_cbranch_scc1 mri_35
s_add_u32 s30, s91, 344064
buffer_load_dwordx4 a[84:87], v236, s[24:27], s30 offen
mri_35:
s_cmp_ge_u32 s45, 84
s_cbranch_scc1 mri_36
s_add_u32 s30, s91, 688128
buffer_load_dwordx4 a[88:91], v236, s[24:27], s30 offen
mri_36:
s_waitcnt lgkmcnt(2)
v_mfma_f32_32x32x16_bf16 v[184:199], v[16:19], v[64:67], v[184:199]
ds_read_b64_tr_b16 v[40:41], v233 offset:16128
ds_read_b64_tr_b16 v[42:43], v233 offset:17472
s_waitcnt lgkmcnt(2)
v_fma_f32 v160, v160, v240, v248
v_fma_f32 v161, v161, v241, v249
v_mfma_f32_32x32x16_bf16 v[200:215], v[20:23], v[64:67], v[200:215]
ds_read_b64_tr_b16 v[44:45], v233 offset:16184
ds_read_b64_tr_b16 v[46:47], v233 offset:17528
v_fma_f32 v162, v162, v242, v250
v_fma_f32 v163, v163, v243, v251
v_fma_f32 v164, v164, v244, v252
v_mfma_f32_32x32x16_bf16 v[216:231], v[24:27], v[64:67], v[216:231]
ds_read_b64_tr_b16 v[48:49], v233 offset:16240
ds_read_b64_tr_b16 v[50:51], v233 offset:17584
v_fma_f32 v165, v165, v245, v253
v_fma_f32 v166, v166, v246, v254
v_fma_f32 v167, v167, v247, v255
v_mfma_f32_32x32x16_bf16 a[0:15], v[28:31], v[64:67], a[0:15]
ds_read_b64_tr_b16 v[52:53], v235 offset:16128
ds_read_b64_tr_b16 v[54:55], v235 offset:17472
v_cvt_pk_bf16_f32 v68, v160, v161
v_cvt_pk_bf16_f32 v69, v162, v163
v_mfma_f32_32x32x16_bf16 a[16:31], v[32:35], v[64:67], a[16:31]
ds_read_b64_tr_b16 v[56:57], v235 offset:16184
ds_read_b64_tr_b16 v[58:59], v235 offset:17528
v_cvt_pk_bf16_f32 v70, v164, v165
v_cvt_pk_bf16_f32 v71, v166, v167
ds_read_b128 v[240:243], v238 offset:2560
ds_read_b128 v[244:247], v238 offset:2576
v_mfma_f32_32x32x16_bf16 a[32:47], v[36:39], v[64:67], a[32:47]
ds_read_b64_tr_b16 v[60:61], v235 offset:16240
ds_read_b64_tr_b16 v[62:63], v235 offset:17584
ds_read_b128 v[248:251], v238 offset:768
ds_read_b128 v[252:255], v238 offset:784
s_cmp_ge_u32 s45, 84
s_cbranch_scc1 mri_37
s_add_u32 s30, s91, 1032192
buffer_load_dwordx4 a[92:95], v236, s[24:27], s30 offen
mri_37:
s_cmp_ge_u32 s45, 84
s_cbranch_scc1 mri_38
s_add_u32 s30, s91, 1376256
buffer_load_dwordx4 a[96:99], v236, s[24:27], s30 offen
mri_38:
s_waitcnt lgkmcnt(2)
v_mfma_f32_32x32x16_bf16 v[184:199], v[40:43], v[68:71], v[184:199]
ds_read_b64_tr_b16 v[16:17], v233 offset:21504
ds_read_b64_tr_b16 v[18:19], v233 offset:22848
s_waitcnt lgkmcnt(2)
v_fma_f32 v168, v168, v240, v248
v_fma_f32 v169, v169, v241, v249
v_mfma_f32_32x32x16_bf16 v[200:215], v[44:47], v[68:71], v[200:215]
ds_read_b64_tr_b16 v[20:21], v233 offset:21560
ds_read_b64_tr_b16 v[22:23], v233 offset:22904
v_fma_f32 v170, v170, v242, v250
v_fma_f32 v171, v171, v243, v251
v_fma_f32 v172, v172, v244, v252
v_mfma_f32_32x32x16_bf16 v[216:231], v[48:51], v[68:71], v[216:231]
ds_read_b64_tr_b16 v[24:25], v233 offset:21616
ds_read_b64_tr_b16 v[26:27], v233 offset:22960
v_fma_f32 v173, v173, v245, v253
v_fma_f32 v174, v174, v246, v254
v_fma_f32 v175, v175, v247, v255
v_mfma_f32_32x32x16_bf16 a[0:15], v[52:55], v[68:71], a[0:15]
ds_read_b64_tr_b16 v[28:29], v235 offset:21504
ds_read_b64_tr_b16 v[30:31], v235 offset:22848
v_cvt_pk_bf16_f32 v64, v168, v169
v_cvt_pk_bf16_f32 v65, v170, v171
v_mfma_f32_32x32x16_bf16 a[16:31], v[56:59], v[68:71], a[16:31]
ds_read_b64_tr_b16 v[32:33], v235 offset:21560
ds_read_b64_tr_b16 v[34:35], v235 offset:22904
v_cvt_pk_bf16_f32 v66, v172, v173
v_cvt_pk_bf16_f32 v67, v174, v175
ds_read_b128 v[240:243], v238 offset:2624
ds_read_b128 v[244:247], v238 offset:2640
v_mfma_f32_32x32x16_bf16 a[32:47], v[60:63], v[68:71], a[32:47]
ds_read_b64_tr_b16 v[36:37], v235 offset:21616
ds_read_b64_tr_b16 v[38:39], v235 offset:22960
ds_read_b128 v[248:251], v238 offset:832
ds_read_b128 v[252:255], v238 offset:848
s_cmp_ge_u32 s45, 84
s_cbranch_scc1 mri_39
s_add_u32 s30, s91, 1720320
buffer_load_dwordx4 a[100:103], v236, s[24:27], s30 offen
mri_39:
s_cmp_ge_u32 s45, 84
s_cbranch_scc1 mri_40
s_add_u32 s30, s91, 2064384
buffer_load_dwordx4 a[104:107], v236, s[24:27], s30 offen
mri_40:
s_waitcnt lgkmcnt(2)
v_mfma_f32_32x32x16_bf16 v[184:199], v[16:19], v[64:67], v[184:199]
ds_read_b64_tr_b16 v[40:41], v233 offset:26880
ds_read_b64_tr_b16 v[42:43], v233 offset:28224
s_waitcnt lgkmcnt(2)
v_fma_f32 v176, v176, v240, v248
v_fma_f32 v177, v177, v241, v249
v_mfma_f32_32x32x16_bf16 v[200:215], v[20:23], v[64:67], v[200:215]
ds_read_b64_tr_b16 v[44:45], v233 offset:26936
ds_read_b64_tr_b16 v[46:47], v233 offset:28280
v_fma_f32 v178, v178, v242, v250
v_fma_f32 v179, v179, v243, v251
v_fma_f32 v180, v180, v244, v252
v_mfma_f32_32x32x16_bf16 v[216:231], v[24:27], v[64:67], v[216:231]
ds_read_b64_tr_b16 v[48:49], v233 offset:26992
ds_read_b64_tr_b16 v[50:51], v233 offset:28336
v_fma_f32 v181, v181, v245, v253
v_fma_f32 v182, v182, v246, v254
v_fma_f32 v183, v183, v247, v255
v_mfma_f32_32x32x16_bf16 a[0:15], v[28:31], v[64:67], a[0:15]
ds_read_b64_tr_b16 v[52:53], v235 offset:26880
ds_read_b64_tr_b16 v[54:55], v235 offset:28224
v_cvt_pk_bf16_f32 v68, v176, v177
v_cvt_pk_bf16_f32 v69, v178, v179
v_mfma_f32_32x32x16_bf16 a[16:31], v[32:35], v[64:67], a[16:31]
ds_read_b64_tr_b16 v[56:57], v235 offset:26936
ds_read_b64_tr_b16 v[58:59], v235 offset:28280
v_cvt_pk_bf16_f32 v70, v180, v181
v_cvt_pk_bf16_f32 v71, v182, v183
v_mfma_f32_32x32x16_bf16 a[32:47], v[36:39], v[64:67], a[32:47]
ds_read_b64_tr_b16 v[60:61], v235 offset:26992
ds_read_b64_tr_b16 v[62:63], v235 offset:28336
s_waitcnt lgkmcnt(0)
v_mfma_f32_32x32x16_bf16 v[184:199], v[40:43], v[68:71], v[184:199]
v_mfma_f32_32x32x16_bf16 v[200:215], v[44:47], v[68:71], v[200:215]
v_mfma_f32_32x32x16_bf16 v[216:231], v[48:51], v[68:71], v[216:231]
v_mfma_f32_32x32x16_bf16 a[0:15], v[52:55], v[68:71], a[0:15]
v_mfma_f32_32x32x16_bf16 a[16:31], v[56:59], v[68:71], a[16:31]
v_mfma_f32_32x32x16_bf16 a[32:47], v[60:63], v[68:71], a[32:47]
s_barrier
v_lshlrev_b32 v2, 4, v1
s_mul_i32 s28, s3, 12288
v_add_u32 v3, s28, v2
s_nop 5
ds_write_b128 v3, a[0:3] offset:0
ds_write_b128 v3, a[4:7] offset:1024
ds_write_b128 v3, a[8:11] offset:2048
ds_write_b128 v3, a[12:15] offset:3072
ds_write_b128 v3, a[16:19] offset:4096
ds_write_b128 v3, a[20:23] offset:5120
ds_write_b128 v3, a[24:27] offset:6144
ds_write_b128 v3, a[28:31] offset:7168
ds_write_b128 v3, a[32:35] offset:8192
ds_write_b128 v3, a[36:39] offset:9216
ds_write_b128 v3, a[40:43] offset:10240
ds_write_b128 v3, a[44:47] offset:11264
s_xor_b32 s28, s3, 2
s_mul_i32 s28, s28, 12288
v_add_u32 v3, s28, v2
s_waitcnt lgkmcnt(0)
s_barrier
ds_read_b128 v[16:19], v3 offset:0
ds_read_b128 v[20:23], v3 offset:1024
ds_read_b128 v[24:27], v3 offset:2048
ds_read_b128 v[28:31], v3 offset:3072
ds_read_b128 v[32:35], v3 offset:4096
ds_read_b128 v[36:39], v3 offset:5120
ds_read_b128 v[40:43], v3 offset:6144
ds_read_b128 v[44:47], v3 offset:7168
ds_read_b128 v[48:51], v3 offset:8192
ds_read_b128 v[52:55], v3 offset:9216
ds_read_b128 v[56:59], v3 offset:10240
ds_read_b128 v[60:63], v3 offset:11264
s_waitcnt lgkmcnt(0)
v_add_f32 v184, v184, v16
v_add_f32 v185, v185, v17
v_add_f32 v186, v186, v18
v_add_f32 v187, v187, v19
v_add_f32 v188, v188, v20
v_add_f32 v189, v189, v21
v_add_f32 v190, v190, v22
v_add_f32 v191, v191, v23
v_add_f32 v192, v192, v24
v_add_f32 v193, v193, v25
v_add_f32 v194, v194, v26
v_add_f32 v195, v195, v27
v_add_f32 v196, v196, v28
v_add_f32 v197, v197, v29
v_add_f32 v198, v198, v30
v_add_f32 v199, v199, v31
v_add_f32 v200, v200, v32
v_add_f32 v201, v201, v33
v_add_f32 v202, v202, v34
v_add_f32 v203, v203, v35
v_add_f32 v204, v204, v36
v_add_f32 v205, v205, v37
v_add_f32 v206, v206, v38
v_add_f32 v207, v207, v39
v_add_f32 v208, v208, v40
v_add_f32 v209, v209, v41
v_add_f32 v210, v210, v42
v_add_f32 v211, v211, v43
v_add_f32 v212, v212, v44
v_add_f32 v213, v213, v45
v_add_f32 v214, v214, v46
v_add_f32 v215, v215, v47
v_add_f32 v216, v216, v48
v_add_f32 v217, v217, v49
v_add_f32 v218, v218, v50
v_add_f32 v219, v219, v51
v_add_f32 v220, v220, v52
v_add_f32 v221, v221, v53
v_add_f32 v222, v222, v54
v_add_f32 v223, v223, v55
v_add_f32 v224, v224, v56
v_add_f32 v225, v225, v57
v_add_f32 v226, v226, v58
v_add_f32 v227, v227, v59
v_add_f32 v228, v228, v60
v_add_f32 v229, v229, v61
v_add_f32 v230, v230, v62
v_add_f32 v231, v231, v63
v_lshlrev_b32 v2, 4, v1
s_lshr_b32 s29, s89, 5
s_add_u32 s29, s29, s6
v_cmp_lt_u32 vcc, 31, v1
v_mov_b32 v4, 0
s_mul_i32 s33, s3, 7168
s_add_u32 s33, s33, 65536
v_and_b32 v8, 31, v1
v_mul_u32_u24 v8, 72, v8
v_lshrrev_b32 v9, 5, v1
v_lshl_add_u32 v8, v9, 3, v8
v_add_u32 v8, s33, v8
v_bfe_u32 v10, v1, 2, 2
v_lshl_add_u32 v10, v9, 2, v10
v_mul_u32_u24 v10, 72, v10
v_bfe_u32 v11, v1, 4, 1
v_lshl_add_u32 v10, v11, 5, v10
v_and_b32 v11, 3, v1
v_lshl_add_u32 v10, v11, 3, v10
v_add_u32 v10, s33, v10
s_mul_i32 s28, s90, 6
s_mul_i32 s30, s7, 3
s_add_u32 s28, s28, s30
s_cmp_ge_u32 s28, 32
s_cbranch_scc1 qa_v_41
s_sub_u32 s30, s28, 16
s_cmp_lt_u32 s30, 14
s_cbranch_scc1 qa_k_42
s_branch qa_g_43
qa_v_41:
v_mov_b32 v6, 1.0
v_cndmask_b32 v196, v196, v6, vcc
v_cndmask_b32 v197, v197, v4, vcc
v_cndmask_b32 v198, v198, v4, vcc
v_cndmask_b32 v199, v199, v4, vcc
v_cndmask_b32 v212, v212, v6, vcc
v_cndmask_b32 v213, v213, v4, vcc
v_cndmask_b32 v214, v214, v4, vcc
v_cndmask_b32 v215, v215, v4, vcc
v_cndmask_b32 v228, v228, v6, vcc
v_cndmask_b32 v229, v229, v4, vcc
v_cndmask_b32 v230, v230, v4, vcc
v_cndmask_b32 v231, v231, v4, vcc
v_cvt_pk_bf16_f32 v16, v184, v185
v_cvt_pk_bf16_f32 v17, v186, v187
v_cvt_pk_bf16_f32 v18, v188, v189
v_cvt_pk_bf16_f32 v19, v190, v191
v_cvt_pk_bf16_f32 v20, v192, v193
v_cvt_pk_bf16_f32 v21, v194, v195
v_cvt_pk_bf16_f32 v22, v196, v197
v_cvt_pk_bf16_f32 v23, v198, v199
ds_write_b64 v8, v[16:17] offset:0
ds_write_b64 v8, v[18:19] offset:16
ds_write_b64 v8, v[20:21] offset:32
ds_write_b64 v8, v[22:23] offset:48
v_cvt_pk_bf16_f32 v24, v200, v201
v_cvt_pk_bf16_f32 v25, v202, v203
v_cvt_pk_bf16_f32 v26, v204, v205
v_cvt_pk_bf16_f32 v27, v206, v207
v_cvt_pk_bf16_f32 v28, v208, v209
v_cvt_pk_bf16_f32 v29, v210, v211
v_cvt_pk_bf16_f32 v30, v212, v213
v_cvt_pk_bf16_f32 v31, v214, v215
ds_write_b64 v8, v[24:25] offset:2304
ds_write_b64 v8, v[26:27] offset:2320
ds_write_b64 v8, v[28:29] offset:2336
ds_write_b64 v8, v[30:31] offset:2352
v_cvt_pk_bf16_f32 v32, v216, v217
v_cvt_pk_bf16_f32 v33, v218, v219
v_cvt_pk_bf16_f32 v34, v220, v221
v_cvt_pk_bf16_f32 v35, v222, v223
v_cvt_pk_bf16_f32 v36, v224, v225
v_cvt_pk_bf16_f32 v37, v226, v227
v_cvt_pk_bf16_f32 v38, v228, v229
v_cvt_pk_bf16_f32 v39, v230, v231
ds_write_b64 v8, v[32:33] offset:4608
ds_write_b64 v8, v[34:35] offset:4624
ds_write_b64 v8, v[36:37] offset:4640
ds_write_b64 v8, v[38:39] offset:4656
s_waitcnt lgkmcnt(0)
ds_read_b64_tr_b16 v[16:17], v10 offset:0
ds_read_b64_tr_b16 v[18:19], v10 offset:576
ds_read_b64_tr_b16 v[20:21], v10 offset:1152
ds_read_b64_tr_b16 v[22:23], v10 offset:1728
ds_read_b64_tr_b16 v[24:25], v10 offset:2304
ds_read_b64_tr_b16 v[26:27], v10 offset:2880
ds_read_b64_tr_b16 v[28:29], v10 offset:3456
ds_read_b64_tr_b16 v[30:31], v10 offset:4032
ds_read_b64_tr_b16 v[32:33], v10 offset:4608
ds_read_b64_tr_b16 v[34:35], v10 offset:5184
ds_read_b64_tr_b16 v[36:37], v10 offset:5760
ds_read_b64_tr_b16 v[38:39], v10 offset:6336
s_add_u32 s30, s28, 0
s_and_b32 s30, s30, 15
s_lshl_b32 s30, s30, 6
s_add_u32 s30, s30, s29
s_lshl_b32 s31, s30, 11
s_add_u32 s32, s31, 5242880
s_waitcnt lgkmcnt(8)
buffer_store_dwordx4 v[16:19], v2, s[8:11], s32 offen sc1
buffer_store_dwordx4 v[20:23], v2, s[8:11], s32 offen offset:1024 sc1
s_add_u32 s30, s28, 1
s_and_b32 s30, s30, 15
s_lshl_b32 s30, s30, 6
s_add_u32 s30, s30, s29
s_lshl_b32 s31, s30, 11
s_add_u32 s32, s31, 5242880
s_waitcnt lgkmcnt(4)
buffer_store_dwordx4 v[24:27], v2, s[8:11], s32 offen sc1
buffer_store_dwordx4 v[28:31], v2, s[8:11], s32 offen offset:1024 sc1
s_add_u32 s30, s28, 2
s_and_b32 s30, s30, 15
s_lshl_b32 s30, s30, 6
s_add_u32 s30, s30, s29
s_lshl_b32 s31, s30, 11
s_add_u32 s32, s31, 5242880
s_waitcnt lgkmcnt(0)
buffer_store_dwordx4 v[32:35], v2, s[8:11], s32 offen sc1
buffer_store_dwordx4 v[36:39], v2, s[8:11], s32 offen offset:1024 sc1
s_branch qa_e_44
qa_k_42:
v_cndmask_b32 v196, v196, v4, vcc
v_cndmask_b32 v197, v197, v4, vcc
v_cndmask_b32 v198, v198, v4, vcc
v_cndmask_b32 v199, v199, v4, vcc
v_cndmask_b32 v212, v212, v4, vcc
v_cndmask_b32 v213, v213, v4, vcc
v_cndmask_b32 v214, v214, v4, vcc
v_cndmask_b32 v215, v215, v4, vcc
v_cndmask_b32 v228, v228, v4, vcc
v_cndmask_b32 v229, v229, v4, vcc
v_cndmask_b32 v230, v230, v4, vcc
v_cndmask_b32 v231, v231, v4, vcc
v_mul_f32 v12, v184, v184
v_mul_f32 v13, v200, v200
v_mul_f32 v14, v216, v216
v_fmac_f32 v12, v185, v185
v_fmac_f32 v13, v201, v201
v_fmac_f32 v14, v217, v217
v_fmac_f32 v12, v186, v186
v_fmac_f32 v13, v202, v202
v_fmac_f32 v14, v218, v218
v_fmac_f32 v12, v187, v187
v_fmac_f32 v13, v203, v203
v_fmac_f32 v14, v219, v219
v_fmac_f32 v12, v188, v188
v_fmac_f32 v13, v204, v204
v_fmac_f32 v14, v220, v220
v_fmac_f32 v12, v189, v189
v_fmac_f32 v13, v205, v205
v_fmac_f32 v14, v221, v221
v_fmac_f32 v12, v190, v190
v_fmac_f32 v13, v206, v206
v_fmac_f32 v14, v222, v222
v_fmac_f32 v12, v191, v191
v_fmac_f32 v13, v207, v207
v_fmac_f32 v14, v223, v223
v_fmac_f32 v12, v192, v192
v_fmac_f32 v13, v208, v208
v_fmac_f32 v14, v224, v224
v_fmac_f32 v12, v193, v193
v_fmac_f32 v13, v209, v209
v_fmac_f32 v14, v225, v225
v_fmac_f32 v12, v194, v194
v_fmac_f32 v13, v210, v210
v_fmac_f32 v14, v226, v226
v_fmac_f32 v12, v195, v195
v_fmac_f32 v13, v211, v211
v_fmac_f32 v14, v227, v227
v_fmac_f32 v12, v196, v196
v_fmac_f32 v13, v212, v212
v_fmac_f32 v14, v228, v228
v_fmac_f32 v12, v197, v197
v_fmac_f32 v13, v213, v213
v_fmac_f32 v14, v229, v229
v_fmac_f32 v12, v198, v198
v_fmac_f32 v13, v214, v214
v_fmac_f32 v14, v230, v230
v_fmac_f32 v12, v199, v199
v_fmac_f32 v13, v215, v215
v_fmac_f32 v14, v231, v231
v_mov_b32 v6, 0x3f803f80
v_cvt_pk_bf16_f32 v16, v184, v185
v_cvt_pk_bf16_f32 v17, v186, v187
v_cvt_pk_bf16_f32 v18, v188, v189
v_cvt_pk_bf16_f32 v19, v190, v191
v_cvt_pk_bf16_f32 v20, v192, v193
v_cvt_pk_bf16_f32 v21, v194, v195
v_cvt_pk_bf16_f32 v22, v196, v197
v_cvt_pk_bf16_f32 v23, v198, v199
v_cndmask_b32 v22, v22, v6, vcc
s_add_u32 s30, s28, 0
s_and_b32 s30, s30, 15
s_lshl_b32 s30, s30, 6
s_add_u32 s30, s30, s29
s_lshl_b32 s31, s30, 11
s_add_u32 s32, s31, 3145728
buffer_store_dwordx4 v[16:19], v2, s[8:11], s32 offen sc1
buffer_store_dwordx4 v[20:23], v2, s[8:11], s32 offen offset:1024 sc1
v_cvt_pk_bf16_f32 v24, v200, v201
v_cvt_pk_bf16_f32 v25, v202, v203
v_cvt_pk_bf16_f32 v26, v204, v205
v_cvt_pk_bf16_f32 v27, v206, v207
v_cvt_pk_bf16_f32 v28, v208, v209
v_cvt_pk_bf16_f32 v29, v210, v211
v_cvt_pk_bf16_f32 v30, v212, v213
v_cvt_pk_bf16_f32 v31, v214, v215
v_cndmask_b32 v30, v30, v6, vcc
s_add_u32 s30, s28, 1
s_and_b32 s30, s30, 15
s_lshl_b32 s30, s30, 6
s_add_u32 s30, s30, s29
s_lshl_b32 s31, s30, 11
s_add_u32 s32, s31, 3145728
buffer_store_dwordx4 v[24:27], v2, s[8:11], s32 offen sc1
buffer_store_dwordx4 v[28:31], v2, s[8:11], s32 offen offset:1024 sc1
v_cvt_pk_bf16_f32 v32, v216, v217
v_cvt_pk_bf16_f32 v33, v218, v219
v_cvt_pk_bf16_f32 v34, v220, v221
v_cvt_pk_bf16_f32 v35, v222, v223
v_cvt_pk_bf16_f32 v36, v224, v225
v_cvt_pk_bf16_f32 v37, v226, v227
v_cvt_pk_bf16_f32 v38, v228, v229
v_cvt_pk_bf16_f32 v39, v230, v231
v_cndmask_b32 v38, v38, v6, vcc
s_add_u32 s30, s28, 2
s_and_b32 s30, s30, 15
s_lshl_b32 s30, s30, 6
s_add_u32 s30, s30, s29
s_lshl_b32 s31, s30, 11
s_add_u32 s32, s31, 3145728
buffer_store_dwordx4 v[32:35], v2, s[8:11], s32 offen sc1
buffer_store_dwordx4 v[36:39], v2, s[8:11], s32 offen offset:1024 sc1
v_mov_b32 v44, v12
v_mov_b32 v45, v13
v_mov_b32 v46, v14
v_permlane32_swap_b32 v12, v44
v_permlane32_swap_b32 v13, v45
v_permlane32_swap_b32 v14, v46
v_add_f32 v12, v12, v44
v_add_f32 v13, v13, v45
v_add_f32 v14, v14, v46
v_max_f32_dpp v12, v12, v12 row_ror:1 row_mask:0xf bank_mask:0xf
v_max_f32_dpp v13, v13, v13 row_ror:1 row_mask:0xf bank_mask:0xf
v_max_f32_dpp v14, v14, v14 row_ror:1 row_mask:0xf bank_mask:0xf
v_max_f32_dpp v12, v12, v12 row_ror:2 row_mask:0xf bank_mask:0xf
v_max_f32_dpp v13, v13, v13 row_ror:2 row_mask:0xf bank_mask:0xf
v_max_f32_dpp v14, v14, v14 row_ror:2 row_mask:0xf bank_mask:0xf
v_max_f32_dpp v12, v12, v12 row_ror:4 row_mask:0xf bank_mask:0xf
v_max_f32_dpp v13, v13, v13 row_ror:4 row_mask:0xf bank_mask:0xf
v_max_f32_dpp v14, v14, v14 row_ror:4 row_mask:0xf bank_mask:0xf
v_max_f32_dpp v12, v12, v12 row_ror:8 row_mask:0xf bank_mask:0xf
v_max_f32_dpp v13, v13, v13 row_ror:8 row_mask:0xf bank_mask:0xf
v_max_f32_dpp v14, v14, v14 row_ror:8 row_mask:0xf bank_mask:0xf
v_readlane_b32 s33, v12, 0
v_readlane_b32 s36, v12, 16
v_readlane_b32 s34, v13, 0
v_readlane_b32 s37, v13, 16
v_readlane_b32 s35, v14, 0
v_readlane_b32 s38, v14, 16
v_lshlrev_b32 v6, 2, v1
s_mov_b32 exec_hi, 0
s_max_u32 s33, s33, s36
v_mov_b32 v12, s33
s_max_u32 s34, s34, s37
v_mov_b32 v13, s34
s_max_u32 s35, s35, s38
v_mov_b32 v14, s35
s_add_u32 s30, s28, 0
s_and_b32 s30, s30, 15
s_lshl_b32 s30, s30, 6
s_add_u32 s30, s30, s29
s_lshl_b32 s31, s30, 11
s_lshl_b32 s32, s30, 7
s_add_u32 s32, s32, 31981568
buffer_store_dword v12, v6, s[8:11], s32 offen sc1
s_add_u32 s30, s28, 1
s_and_b32 s30, s30, 15
s_lshl_b32 s30, s30, 6
s_add_u32 s30, s30, s29
s_lshl_b32 s31, s30, 11
s_lshl_b32 s32, s30, 7
s_add_u32 s32, s32, 31981568
buffer_store_dword v13, v6, s[8:11], s32 offen sc1
s_add_u32 s30, s28, 2
s_and_b32 s30, s30, 15
s_lshl_b32 s30, s30, 6
s_add_u32 s30, s30, s29
s_lshl_b32 s31, s30, 11
s_lshl_b32 s32, s30, 7
s_add_u32 s32, s32, 31981568
buffer_store_dword v14, v6, s[8:11], s32 offen sc1
s_mov_b32 exec_hi, -1
s_branch qa_e_44
qa_g_43:
s_mul_i32 s28, s90, 6
s_mul_i32 s30, s7, 3
s_add_u32 s28, s28, s30
s_add_u32 s28, s28, 0
s_and_b32 s30, s28, 15
s_lshl_b32 s30, s30, 6
s_add_u32 s30, s30, s29
s_lshl_b32 s31, s30, 11
s_cmp_ge_u32 s28, 32
s_cbranch_scc1 qs_v_46
s_cmp_ge_u32 s28, 16
s_cbranch_scc1 qs_k_45
s_mov_b32 s34, 0x3e8b97f6
v_mul_f32 v184, s34, v184
v_mul_f32 v185, s34, v185
v_mul_f32 v186, s34, v186
v_mul_f32 v187, s34, v187
v_mul_f32 v188, s34, v188
v_mul_f32 v189, s34, v189
v_mul_f32 v190, s34, v190
v_mul_f32 v191, s34, v191
v_mul_f32 v192, s34, v192
v_mul_f32 v193, s34, v193
v_mul_f32 v194, s34, v194
v_mul_f32 v195, s34, v195
v_mul_f32 v196, s34, v196
v_mul_f32 v197, s34, v197
v_mul_f32 v198, s34, v198
v_mul_f32 v199, s34, v199
v_cvt_pk_bf16_f32 v16, v184, v185
v_cvt_pk_bf16_f32 v17, v186, v187
v_cvt_pk_bf16_f32 v18, v188, v189
v_cvt_pk_bf16_f32 v19, v190, v191
v_cvt_pk_bf16_f32 v20, v192, v193
v_cvt_pk_bf16_f32 v21, v194, v195
v_cvt_pk_bf16_f32 v22, v196, v197
v_cvt_pk_bf16_f32 v23, v198, v199
v_cndmask_b32 v22, v22, v4, vcc
v_cndmask_b32 v23, v23, v4, vcc
s_add_u32 s32, s31, 1048576
buffer_store_dwordx4 v[16:19], v2, s[8:11], s32 offen sc1
buffer_store_dwordx4 v[20:23], v2, s[8:11], s32 offen offset:1024 sc1
s_branch qs_e_47
qs_k_45:
v_cndmask_b32 v196, v196, v4, vcc
v_cndmask_b32 v197, v197, v4, vcc
v_cndmask_b32 v198, v198, v4, vcc
v_cndmask_b32 v199, v199, v4, vcc
v_mul_f32 v5, v184, v184
v_fmac_f32 v5, v185, v185
v_fmac_f32 v5, v186, v186
v_fmac_f32 v5, v187, v187
v_fmac_f32 v5, v188, v188
v_fmac_f32 v5, v189, v189
v_fmac_f32 v5, v190, v190
v_fmac_f32 v5, v191, v191
v_fmac_f32 v5, v192, v192
v_fmac_f32 v5, v193, v193
v_fmac_f32 v5, v194, v194
v_fmac_f32 v5, v195, v195
v_fmac_f32 v5, v196, v196
v_fmac_f32 v5, v197, v197
v_fmac_f32 v5, v198, v198
v_fmac_f32 v5, v199, v199
v_cvt_pk_bf16_f32 v16, v184, v185
v_cvt_pk_bf16_f32 v17, v186, v187
v_cvt_pk_bf16_f32 v18, v188, v189
v_cvt_pk_bf16_f32 v19, v190, v191
v_cvt_pk_bf16_f32 v20, v192, v193
v_cvt_pk_bf16_f32 v21, v194, v195
v_cvt_pk_bf16_f32 v22, v196, v197
v_cvt_pk_bf16_f32 v23, v198, v199
v_mov_b32 v6, 0x3f803f80
v_cndmask_b32 v22, v22, v6, vcc
s_add_u32 s32, s31, 3145728
buffer_store_dwordx4 v[16:19], v2, s[8:11], s32 offen sc1
buffer_store_dwordx4 v[20:23], v2, s[8:11], s32 offen offset:1024 sc1
v_mov_b32 v6, v5
s_nop 1
v_permlane32_swap_b32 v5, v6
v_add_f32 v5, v5, v6
s_nop 1
v_max_f32_dpp v5, v5, v5 row_ror:1 row_mask:0xf bank_mask:0xf
s_nop 1
v_max_f32_dpp v5, v5, v5 row_ror:2 row_mask:0xf bank_mask:0xf
s_nop 1
v_max_f32_dpp v5, v5, v5 row_ror:4 row_mask:0xf bank_mask:0xf
s_nop 1
v_max_f32_dpp v5, v5, v5 row_ror:8 row_mask:0xf bank_mask:0xf
s_nop 0
v_readlane_b32 s34, v5, 0
v_readlane_b32 s36, v5, 16
s_max_u32 s34, s34, s36
v_mov_b32 v5, s34
s_lshl_b32 s32, s30, 7
s_add_u32 s32, s32, 31981568
v_lshlrev_b32 v6, 2, v1
s_mov_b32 exec_hi, 0
buffer_store_dword v5, v6, s[8:11], s32 offen sc1
s_mov_b32 exec_hi, -1
s_branch qs_e_47
qs_v_46:
v_mov_b32 v6, 1.0
v_cndmask_b32 v196, v196, v6, vcc
v_cndmask_b32 v197, v197, v4, vcc
v_cndmask_b32 v198, v198, v4, vcc
v_cndmask_b32 v199, v199, v4, vcc
v_cvt_pk_bf16_f32 v16, v184, v185
v_cvt_pk_bf16_f32 v17, v186, v187
v_cvt_pk_bf16_f32 v18, v188, v189
v_cvt_pk_bf16_f32 v19, v190, v191
v_cvt_pk_bf16_f32 v20, v192, v193
v_cvt_pk_bf16_f32 v21, v194, v195
v_cvt_pk_bf16_f32 v22, v196, v197
v_cvt_pk_bf16_f32 v23, v198, v199
ds_write_b64 v8, v[16:17] offset:0
ds_write_b64 v8, v[18:19] offset:16
ds_write_b64 v8, v[20:21] offset:32
ds_write_b64 v8, v[22:23] offset:48
s_waitcnt lgkmcnt(0)
ds_read_b64_tr_b16 v[16:17], v10 offset:0
ds_read_b64_tr_b16 v[18:19], v10 offset:576
ds_read_b64_tr_b16 v[20:21], v10 offset:1152
ds_read_b64_tr_b16 v[22:23], v10 offset:1728
s_add_u32 s32, s31, 5242880
s_waitcnt lgkmcnt(0)
buffer_store_dwordx4 v[16:19], v2, s[8:11], s32 offen sc1
buffer_store_dwordx4 v[20:23], v2, s[8:11], s32 offen offset:1024 sc1
qs_e_47:
s_mul_i32 s28, s90, 6
s_mul_i32 s30, s7, 3
s_add_u32 s28, s28, s30
s_add_u32 s28, s28, 1
s_and_b32 s30, s28, 15
s_lshl_b32 s30, s30, 6
s_add_u32 s30, s30, s29
s_lshl_b32 s31, s30, 11
s_cmp_ge_u32 s28, 32
s_cbranch_scc1 qs_v_49
s_cmp_ge_u32 s28, 16
s_cbranch_scc1 qs_k_48
s_mov_b32 s34, 0x3e8b97f6
v_mul_f32 v200, s34, v200
v_mul_f32 v201, s34, v201
v_mul_f32 v202, s34, v202
v_mul_f32 v203, s34, v203
v_mul_f32 v204, s34, v204
v_mul_f32 v205, s34, v205
v_mul_f32 v206, s34, v206
v_mul_f32 v207, s34, v207
v_mul_f32 v208, s34, v208
v_mul_f32 v209, s34, v209
v_mul_f32 v210, s34, v210
v_mul_f32 v211, s34, v211
v_mul_f32 v212, s34, v212
v_mul_f32 v213, s34, v213
v_mul_f32 v214, s34, v214
v_mul_f32 v215, s34, v215
v_cvt_pk_bf16_f32 v24, v200, v201
v_cvt_pk_bf16_f32 v25, v202, v203
v_cvt_pk_bf16_f32 v26, v204, v205
v_cvt_pk_bf16_f32 v27, v206, v207
v_cvt_pk_bf16_f32 v28, v208, v209
v_cvt_pk_bf16_f32 v29, v210, v211
v_cvt_pk_bf16_f32 v30, v212, v213
v_cvt_pk_bf16_f32 v31, v214, v215
v_cndmask_b32 v30, v30, v4, vcc
v_cndmask_b32 v31, v31, v4, vcc
s_add_u32 s32, s31, 1048576
buffer_store_dwordx4 v[24:27], v2, s[8:11], s32 offen sc1
buffer_store_dwordx4 v[28:31], v2, s[8:11], s32 offen offset:1024 sc1
s_branch qs_e_50
qs_k_48:
v_cndmask_b32 v212, v212, v4, vcc
v_cndmask_b32 v213, v213, v4, vcc
v_cndmask_b32 v214, v214, v4, vcc
v_cndmask_b32 v215, v215, v4, vcc
v_mul_f32 v5, v200, v200
v_fmac_f32 v5, v201, v201
v_fmac_f32 v5, v202, v202
v_fmac_f32 v5, v203, v203
v_fmac_f32 v5, v204, v204
v_fmac_f32 v5, v205, v205
v_fmac_f32 v5, v206, v206
v_fmac_f32 v5, v207, v207
v_fmac_f32 v5, v208, v208
v_fmac_f32 v5, v209, v209
v_fmac_f32 v5, v210, v210
v_fmac_f32 v5, v211, v211
v_fmac_f32 v5, v212, v212
v_fmac_f32 v5, v213, v213
v_fmac_f32 v5, v214, v214
v_fmac_f32 v5, v215, v215
v_cvt_pk_bf16_f32 v24, v200, v201
v_cvt_pk_bf16_f32 v25, v202, v203
v_cvt_pk_bf16_f32 v26, v204, v205
v_cvt_pk_bf16_f32 v27, v206, v207
v_cvt_pk_bf16_f32 v28, v208, v209
v_cvt_pk_bf16_f32 v29, v210, v211
v_cvt_pk_bf16_f32 v30, v212, v213
v_cvt_pk_bf16_f32 v31, v214, v215
v_mov_b32 v6, 0x3f803f80
v_cndmask_b32 v30, v30, v6, vcc
s_add_u32 s32, s31, 3145728
buffer_store_dwordx4 v[24:27], v2, s[8:11], s32 offen sc1
buffer_store_dwordx4 v[28:31], v2, s[8:11], s32 offen offset:1024 sc1
v_mov_b32 v6, v5
s_nop 1
v_permlane32_swap_b32 v5, v6
v_add_f32 v5, v5, v6
s_nop 1
v_max_f32_dpp v5, v5, v5 row_ror:1 row_mask:0xf bank_mask:0xf
s_nop 1
v_max_f32_dpp v5, v5, v5 row_ror:2 row_mask:0xf bank_mask:0xf
s_nop 1
v_max_f32_dpp v5, v5, v5 row_ror:4 row_mask:0xf bank_mask:0xf
s_nop 1
v_max_f32_dpp v5, v5, v5 row_ror:8 row_mask:0xf bank_mask:0xf
s_nop 0
v_readlane_b32 s34, v5, 0
v_readlane_b32 s36, v5, 16
s_max_u32 s34, s34, s36
v_mov_b32 v5, s34
s_lshl_b32 s32, s30, 7
s_add_u32 s32, s32, 31981568
v_lshlrev_b32 v6, 2, v1
s_mov_b32 exec_hi, 0
buffer_store_dword v5, v6, s[8:11], s32 offen sc1
s_mov_b32 exec_hi, -1
s_branch qs_e_50
qs_v_49:
v_mov_b32 v6, 1.0
v_cndmask_b32 v212, v212, v6, vcc
v_cndmask_b32 v213, v213, v4, vcc
v_cndmask_b32 v214, v214, v4, vcc
v_cndmask_b32 v215, v215, v4, vcc
v_cvt_pk_bf16_f32 v24, v200, v201
v_cvt_pk_bf16_f32 v25, v202, v203
v_cvt_pk_bf16_f32 v26, v204, v205
v_cvt_pk_bf16_f32 v27, v206, v207
v_cvt_pk_bf16_f32 v28, v208, v209
v_cvt_pk_bf16_f32 v29, v210, v211
v_cvt_pk_bf16_f32 v30, v212, v213
v_cvt_pk_bf16_f32 v31, v214, v215
ds_write_b64 v8, v[24:25] offset:0
ds_write_b64 v8, v[26:27] offset:16
ds_write_b64 v8, v[28:29] offset:32
ds_write_b64 v8, v[30:31] offset:48
s_waitcnt lgkmcnt(0)
ds_read_b64_tr_b16 v[24:25], v10 offset:0
ds_read_b64_tr_b16 v[26:27], v10 offset:576
ds_read_b64_tr_b16 v[28:29], v10 offset:1152
ds_read_b64_tr_b16 v[30:31], v10 offset:1728
s_add_u32 s32, s31, 5242880
s_waitcnt lgkmcnt(0)
buffer_store_dwordx4 v[24:27], v2, s[8:11], s32 offen sc1
buffer_store_dwordx4 v[28:31], v2, s[8:11], s32 offen offset:1024 sc1
qs_e_50:
s_mul_i32 s28, s90, 6
s_mul_i32 s30, s7, 3
s_add_u32 s28, s28, s30
s_add_u32 s28, s28, 2
s_and_b32 s30, s28, 15
s_lshl_b32 s30, s30, 6
s_add_u32 s30, s30, s29
s_lshl_b32 s31, s30, 11
s_cmp_ge_u32 s28, 32
s_cbranch_scc1 qs_v_52
s_cmp_ge_u32 s28, 16
s_cbranch_scc1 qs_k_51
s_mov_b32 s34, 0x3e8b97f6
v_mul_f32 v216, s34, v216
v_mul_f32 v217, s34, v217
v_mul_f32 v218, s34, v218
v_mul_f32 v219, s34, v219
v_mul_f32 v220, s34, v220
v_mul_f32 v221, s34, v221
v_mul_f32 v222, s34, v222
v_mul_f32 v223, s34, v223
v_mul_f32 v224, s34, v224
v_mul_f32 v225, s34, v225
v_mul_f32 v226, s34, v226
v_mul_f32 v227, s34, v227
v_mul_f32 v228, s34, v228
v_mul_f32 v229, s34, v229
v_mul_f32 v230, s34, v230
v_mul_f32 v231, s34, v231
v_cvt_pk_bf16_f32 v32, v216, v217
v_cvt_pk_bf16_f32 v33, v218, v219
v_cvt_pk_bf16_f32 v34, v220, v221
v_cvt_pk_bf16_f32 v35, v222, v223
v_cvt_pk_bf16_f32 v36, v224, v225
v_cvt_pk_bf16_f32 v37, v226, v227
v_cvt_pk_bf16_f32 v38, v228, v229
v_cvt_pk_bf16_f32 v39, v230, v231
v_cndmask_b32 v38, v38, v4, vcc
v_cndmask_b32 v39, v39, v4, vcc
s_add_u32 s32, s31, 1048576
buffer_store_dwordx4 v[32:35], v2, s[8:11], s32 offen sc1
buffer_store_dwordx4 v[36:39], v2, s[8:11], s32 offen offset:1024 sc1
s_branch qs_e_53
qs_k_51:
v_cndmask_b32 v228, v228, v4, vcc
v_cndmask_b32 v229, v229, v4, vcc
v_cndmask_b32 v230, v230, v4, vcc
v_cndmask_b32 v231, v231, v4, vcc
v_mul_f32 v5, v216, v216
v_fmac_f32 v5, v217, v217
v_fmac_f32 v5, v218, v218
v_fmac_f32 v5, v219, v219
v_fmac_f32 v5, v220, v220
v_fmac_f32 v5, v221, v221
v_fmac_f32 v5, v222, v222
v_fmac_f32 v5, v223, v223
v_fmac_f32 v5, v224, v224
v_fmac_f32 v5, v225, v225
v_fmac_f32 v5, v226, v226
v_fmac_f32 v5, v227, v227
v_fmac_f32 v5, v228, v228
v_fmac_f32 v5, v229, v229
v_fmac_f32 v5, v230, v230
v_fmac_f32 v5, v231, v231
v_cvt_pk_bf16_f32 v32, v216, v217
v_cvt_pk_bf16_f32 v33, v218, v219
v_cvt_pk_bf16_f32 v34, v220, v221
v_cvt_pk_bf16_f32 v35, v222, v223
v_cvt_pk_bf16_f32 v36, v224, v225
v_cvt_pk_bf16_f32 v37, v226, v227
v_cvt_pk_bf16_f32 v38, v228, v229
v_cvt_pk_bf16_f32 v39, v230, v231
v_mov_b32 v6, 0x3f803f80
v_cndmask_b32 v38, v38, v6, vcc
s_add_u32 s32, s31, 3145728
buffer_store_dwordx4 v[32:35], v2, s[8:11], s32 offen sc1
buffer_store_dwordx4 v[36:39], v2, s[8:11], s32 offen offset:1024 sc1
v_mov_b32 v6, v5
s_nop 1
v_permlane32_swap_b32 v5, v6
v_add_f32 v5, v5, v6
s_nop 1
v_max_f32_dpp v5, v5, v5 row_ror:1 row_mask:0xf bank_mask:0xf
s_nop 1
v_max_f32_dpp v5, v5, v5 row_ror:2 row_mask:0xf bank_mask:0xf
s_nop 1
v_max_f32_dpp v5, v5, v5 row_ror:4 row_mask:0xf bank_mask:0xf
s_nop 1
v_max_f32_dpp v5, v5, v5 row_ror:8 row_mask:0xf bank_mask:0xf
s_nop 0
v_readlane_b32 s34, v5, 0
v_readlane_b32 s36, v5, 16
s_max_u32 s34, s34, s36
v_mov_b32 v5, s34
s_lshl_b32 s32, s30, 7
s_add_u32 s32, s32, 31981568
v_lshlrev_b32 v6, 2, v1
s_mov_b32 exec_hi, 0
buffer_store_dword v5, v6, s[8:11], s32 offen sc1
s_mov_b32 exec_hi, -1
s_branch qs_e_53
qs_v_52:
v_mov_b32 v6, 1.0
v_cndmask_b32 v228, v228, v6, vcc
v_cndmask_b32 v229, v229, v4, vcc
v_cndmask_b32 v230, v230, v4, vcc
v_cndmask_b32 v231, v231, v4, vcc
v_cvt_pk_bf16_f32 v32, v216, v217
v_cvt_pk_bf16_f32 v33, v218, v219
v_cvt_pk_bf16_f32 v34, v220, v221
v_cvt_pk_bf16_f32 v35, v222, v223
v_cvt_pk_bf16_f32 v36, v224, v225
v_cvt_pk_bf16_f32 v37, v226, v227
v_cvt_pk_bf16_f32 v38, v228, v229
v_cvt_pk_bf16_f32 v39, v230, v231
ds_write_b64 v8, v[32:33] offset:0
ds_write_b64 v8, v[34:35] offset:16
ds_write_b64 v8, v[36:37] offset:32
ds_write_b64 v8, v[38:39] offset:48
s_waitcnt lgkmcnt(0)
ds_read_b64_tr_b16 v[32:33], v10 offset:0
ds_read_b64_tr_b16 v[34:35], v10 offset:576
ds_read_b64_tr_b16 v[36:37], v10 offset:1152
ds_read_b64_tr_b16 v[38:39], v10 offset:1728
s_add_u32 s32, s31, 5242880
s_waitcnt lgkmcnt(0)
buffer_store_dwordx4 v[32:35], v2, s[8:11], s32 offen sc1
buffer_store_dwordx4 v[36:39], v2, s[8:11], s32 offen offset:1024 sc1
qs_e_53:
qa_e_44:
s_waitcnt vmcnt(0)
s_barrier
s_cmp_lg_u32 s3, 0
s_cbranch_scc1 gf_skip_54
s_lshl_b32 s28, s4, 5
s_add_u32 s28, s28, s5
s_lshl_b32 s28, s28, 7
s_add_u32 s28, s28, 32112640
v_lshlrev_b32 v2, 2, v1
v_mov_b32 v3, s88
s_mov_b32 exec_hi, 0
buffer_store_dword v3, v2, s[8:11], s28 offen sc1
s_mov_b32 exec_hi, -1
gf_skip_54:
v_and_b32 v146, 31, v1
v_lshlrev_b32 v146, 2, v146
s_lshl_b32 s28, s4, 7
s_add_u32 s91, s28, 360448
buffer_load_dword v144, v146, s[8:11], s91 offen sc1
s_cmp_lt_u32 s2, 224
s_cselect_b32 s28, 1, 0
s_cmp_ge_u32 s2, 192
s_cselect_b32 s29, 1, 0
s_cmp_eq_u32 s3, 3
s_cselect_b32 s28, s29, s28
s_cmp_eq_u32 s28, 0
s_cbranch_scc1 pf_skip_55
s_lshl_b32 s28, s3, 13
s_add_u32 s28, s28, 65536
v_lshlrev_b32 v2, 4, v1
v_add_u32 v3, s28, v2
ds_write_b128 v3, a[48:51] offset:0
ds_write_b128 v3, a[52:55] offset:1024
ds_write_b128 v3, a[56:59] offset:2048
s_mov_b32 exec_hi, 0
ds_write_b128 v3, a[60:63] offset:3072
s_mov_b32 exec_hi, -1
ds_write_b128 v3, a[64:67] offset:3584
ds_write_b128 v3, a[68:71] offset:4608
ds_write_b128 v3, a[72:75] offset:5632
s_mov_b32 exec_hi, 0
ds_write_b128 v3, a[76:79] offset:6656
s_mov_b32 exec_hi, -1
v_lshrrev_b32 v4, 5, v1
v_bfe_u32 v5, v1, 2, 2
v_lshl_add_u32 v5, v4, 2, v5
v_mul_u32_u24 v5, 224, v5
v_and_b32 v6, 3, v1
v_lshl_add_u32 v5, v6, 3, v5
v_add_u32 v5, s28, v5
v_bfe_u32 v6, v1, 4, 1
v_mul_u32_u24 v7, 3584, v6
v_add_u32 v7, v7, v5
v_lshl_add_u32 v8, v6, 5, v5
v_mul_u32_u24 v9, 3392, v6
v_add_u32 v9, v9, v5
s_waitcnt lgkmcnt(0)
s_cmp_ge_u32 s3, 2
s_cbranch_scc1 pf_plain_56
ds_read_b64_tr_b16 v[64:65], v7 offset:0
ds_read_b64_tr_b16 v[66:67], v7 offset:1792
ds_read_b64_tr_b16 v[68:69], v7 offset:32
ds_read_b64_tr_b16 v[70:71], v7 offset:1824
ds_read_b64_tr_b16 v[72:73], v7 offset:64
ds_read_b64_tr_b16 v[74:75], v7 offset:1856
ds_read_b64_tr_b16 v[76:77], v7 offset:96
ds_read_b64_tr_b16 v[78:79], v7 offset:1888
ds_read_b64_tr_b16 v[80:81], v7 offset:128
ds_read_b64_tr_b16 v[82:83], v7 offset:1920
ds_read_b64_tr_b16 v[84:85], v7 offset:160
ds_read_b64_tr_b16 v[86:87], v7 offset:1952
ds_read_b64_tr_b16 v[88:89], v7 offset:192
ds_read_b64_tr_b16 v[90:91], v7 offset:1984
s_branch pf_rd_57
pf_plain_56:
ds_read_b64_tr_b16 v[64:65], v8 offset:0
ds_read_b64_tr_b16 v[66:67], v8 offset:1792
ds_read_b64_tr_b16 v[68:69], v8 offset:64
ds_read_b64_tr_b16 v[70:71], v8 offset:1856
ds_read_b64_tr_b16 v[72:73], v8 offset:128
ds_read_b64_tr_b16 v[74:75], v8 offset:1920
ds_read_b64_tr_b16 v[76:77], v9 offset:192
ds_read_b64_tr_b16 v[78:79], v9 offset:1984
ds_read_b64_tr_b16 v[80:81], v8 offset:3616
ds_read_b64_tr_b16 v[82:83], v8 offset:5408
ds_read_b64_tr_b16 v[84:85], v8 offset:3680
ds_read_b64_tr_b16 v[86:87], v8 offset:5472
ds_read_b64_tr_b16 v[88:89], v8 offset:3744
ds_read_b64_tr_b16 v[90:91], v8 offset:5536
pf_rd_57:
s_cmp_eq_u32 s3, 2
s_cbranch_scc1 pd2_58
s_cmp_eq_u32 s3, 3
s_cbranch_scc1 pd3_59
s_mul_hi_u32 s29, s2, 153391690
s_mul_i32 s30, s29, 28
s_sub_u32 s30, s2, s30
s_mul_i32 s29, s29, 14
s_mul_i32 s31, s3, 7
s_add_u32 s29, s29, s31
s_mul_i32 s29, s29, 28
s_add_u32 s29, s29, s30
s_lshl_b32 s33, s29, 10
s_add_u32 s33, s33, 22020096
s_mov_b32 s34, 28672
s_waitcnt lgkmcnt(0)
s_branch pdd_60
pd2_58:
s_cmp_ge_u32 s2, 112
s_cselect_b32 s29, 1, 0
s_mul_i32 s30, s29, 112
s_sub_u32 s30, s2, s30
s_mul_i32 s29, s29, 784
s_add_u32 s29, s29, s30
s_lshl_b32 s33, s29, 10
s_add_u32 s33, s33, 26214400
s_mov_b32 s34, 114688
s_waitcnt lgkmcnt(0)
s_branch pdd_60
pd3_59:
s_sub_u32 s28, s2, 192
s_and_b32 s29, s28, 1
s_mul_i32 s29, s29, 224
s_lshr_b32 s30, s28, 1
s_add_u32 s29, s29, s30
s_lshl_b32 s33, s29, 10
s_add_u32 s33, s33, 20971520
s_mov_b32 s34, 32768
s_waitcnt lgkmcnt(0)
s_bitcmp1_b32 s28, 1
s_cbranch_scc0 pz_61
s_mov_b32 exec_lo, 0
v_mov_b32 v66, 0
v_mov_b32 v67, 0
v_mov_b32 v70, 0
v_mov_b32 v71, 0
v_mov_b32 v74, 0
v_mov_b32 v75, 0
v_mov_b32 v78, 0
v_mov_b32 v79, 0
v_mov_b32 v82, 0
v_mov_b32 v83, 0
v_mov_b32 v86, 0
v_mov_b32 v87, 0
v_mov_b32 v90, 0
v_mov_b32 v91, 0
s_mov_b32 exec_lo, -1
pz_61:
pdd_60:
buffer_store_dwordx4 v[64:67], v2, s[8:11], s33 offen sc1
s_add_u32 s33, s33, s34
buffer_store_dwordx4 v[68:71], v2, s[8:11], s33 offen sc1
s_add_u32 s33, s33, s34
buffer_store_dwordx4 v[72:75], v2, s[8:11], s33 offen sc1
s_add_u32 s33, s33, s34
buffer_store_dwordx4 v[76:79], v2, s[8:11], s33 offen sc1
s_add_u32 s33, s33, s34
buffer_store_dwordx4 v[80:83], v2, s[8:11], s33 offen sc1
s_add_u32 s33, s33, s34
buffer_store_dwordx4 v[84:87], v2, s[8:11], s33 offen sc1
s_add_u32 s33, s33, s34
buffer_store_dwordx4 v[88:91], v2, s[8:11], s33 offen sc1
pf_skip_55:
s_and_b32 s28, s5, 7
s_sub_u32 s28, s28, 1
s_lshr_b32 s29, s5, 3
s_lshl_b32 s29, s29, 1
s_add_u32 s29, s29, s28
s_lshl_b32 s45, s4, 3
s_add_u32 s45, s45, s29
s_add_u32 s45, s45, 28
s_cmp_lt_u32 s28, 2
s_cselect_b32 s45, s45, 99
s_cmp_ge_u32 s45, 84
s_cbranch_scc1 mrf_62
v_accvgpr_read_b32 v80, a80
v_accvgpr_read_b32 v81, a81
v_accvgpr_read_b32 v82, a82
v_accvgpr_read_b32 v83, a83
v_accvgpr_read_b32 v84, a84
v_accvgpr_read_b32 v85, a85
v_accvgpr_read_b32 v86, a86
v_accvgpr_read_b32 v87, a87
v_accvgpr_read_b32 v88, a88
v_accvgpr_read_b32 v89, a89
v_accvgpr_read_b32 v90, a90
v_accvgpr_read_b32 v91, a91
v_accvgpr_read_b32 v92, a92
v_accvgpr_read_b32 v93, a93
v_accvgpr_read_b32 v94, a94
v_accvgpr_read_b32 v95, a95
v_accvgpr_read_b32 v96, a96
v_accvgpr_read_b32 v97, a97
v_accvgpr_read_b32 v98, a98
v_accvgpr_read_b32 v99, a99
v_accvgpr_read_b32 v100, a100
v_accvgpr_read_b32 v101, a101
v_accvgpr_read_b32 v102, a102
v_accvgpr_read_b32 v103, a103
v_accvgpr_read_b32 v104, a104
v_accvgpr_read_b32 v105, a105
v_accvgpr_read_b32 v106, a106
v_accvgpr_read_b32 v107, a107
v_accvgpr_read_b32 v72, a108
v_accvgpr_read_b32 v73, a109
v_accvgpr_read_b32 v74, a110
v_accvgpr_read_b32 v75, a111
v_accvgpr_read_b32 v76, a112
v_accvgpr_read_b32 v77, a113
v_accvgpr_read_b32 v78, a114
s_waitcnt vmcnt(63)
v_mov_b32 v112, 0
v_mov_b32 v113, 0
v_mov_b32 v114, 0
v_mov_b32 v115, 0
v_mov_b32 v116, 0
v_mov_b32 v117, 0
v_mov_b32 v118, 0
v_mov_b32 v119, 0
v_bfe_u32 v3, v0, 2, 1
v_cmp_eq_u32 vcc, 1, v3
v_lshlrev_b32 v108, 16, v72
v_and_b32 v72, 0xffff0000, v72
v_cndmask_b32 v72, v108, v72, vcc
v_mul_f32 v108, 0xbfb8aa3b, v72
v_exp_f32 v108, v108
s_nop 0
v_add_f32 v108, 1.0, v108
v_rcp_f32 v108, v108
s_nop 0
v_mul_f32 v72, v72, v108
v_cvt_pk_bf16_f32 v72, v72, v72
v_and_b32 v72, 0xffff0000, v72
v_lshlrev_b32 v108, 16, v73
v_and_b32 v73, 0xffff0000, v73
v_cndmask_b32 v73, v108, v73, vcc
v_mul_f32 v108, 0xbfb8aa3b, v73
v_exp_f32 v108, v108
s_nop 0
v_add_f32 v108, 1.0, v108
v_rcp_f32 v108, v108
s_nop 0
v_mul_f32 v73, v73, v108
v_cvt_pk_bf16_f32 v73, v73, v73
v_and_b32 v73, 0xffff0000, v73
v_lshlrev_b32 v108, 16, v74
v_and_b32 v74, 0xffff0000, v74
v_cndmask_b32 v74, v108, v74, vcc
v_mul_f32 v108, 0xbfb8aa3b, v74
v_exp_f32 v108, v108
s_nop 0
v_add_f32 v108, 1.0, v108
v_rcp_f32 v108, v108
s_nop 0
v_mul_f32 v74, v74, v108
v_cvt_pk_bf16_f32 v74, v74, v74
v_and_b32 v74, 0xffff0000, v74
v_lshlrev_b32 v108, 16, v75
v_and_b32 v75, 0xffff0000, v75
v_cndmask_b32 v75, v108, v75, vcc
v_mul_f32 v108, 0xbfb8aa3b, v75
v_exp_f32 v108, v108
s_nop 0
v_add_f32 v108, 1.0, v108
v_rcp_f32 v108, v108
s_nop 0
v_mul_f32 v75, v75, v108
v_cvt_pk_bf16_f32 v75, v75, v75
v_and_b32 v75, 0xffff0000, v75
v_lshlrev_b32 v108, 16, v76
v_and_b32 v76, 0xffff0000, v76
v_cndmask_b32 v76, v108, v76, vcc
v_mul_f32 v108, 0xbfb8aa3b, v76
v_exp_f32 v108, v108
s_nop 0
v_add_f32 v108, 1.0, v108
v_rcp_f32 v108, v108
s_nop 0
v_mul_f32 v76, v76, v108
v_cvt_pk_bf16_f32 v76, v76, v76
v_and_b32 v76, 0xffff0000, v76
v_lshlrev_b32 v108, 16, v77
v_and_b32 v77, 0xffff0000, v77
v_cndmask_b32 v77, v108, v77, vcc
v_mul_f32 v108, 0xbfb8aa3b, v77
v_exp_f32 v108, v108
s_nop 0
v_add_f32 v108, 1.0, v108
v_rcp_f32 v108, v108
s_nop 0
v_mul_f32 v77, v77, v108
v_cvt_pk_bf16_f32 v77, v77, v77
v_and_b32 v77, 0xffff0000, v77
v_lshlrev_b32 v108, 16, v78
v_and_b32 v78, 0xffff0000, v78
v_cndmask_b32 v78, v108, v78, vcc
v_mul_f32 v108, 0xbfb8aa3b, v78
v_exp_f32 v108, v108
s_nop 0
v_add_f32 v108, 1.0, v108
v_rcp_f32 v108, v108
s_nop 0
v_mul_f32 v78, v78, v108
v_cvt_pk_bf16_f32 v78, v78, v78
v_and_b32 v78, 0xffff0000, v78
v_lshlrev_b32 v108, 16, v80
v_and_b32 v109, 0xffff0000, v80
v_fmac_f32 v112, v72, v108
v_fmac_f32 v113, v72, v109
v_lshlrev_b32 v108, 16, v81
v_and_b32 v109, 0xffff0000, v81
v_fmac_f32 v114, v72, v108
v_fmac_f32 v115, v72, v109
v_lshlrev_b32 v108, 16, v82
v_and_b32 v109, 0xffff0000, v82
v_fmac_f32 v116, v72, v108
v_fmac_f32 v117, v72, v109
v_lshlrev_b32 v108, 16, v83
v_and_b32 v109, 0xffff0000, v83
v_fmac_f32 v118, v72, v108
v_fmac_f32 v119, v72, v109
v_lshlrev_b32 v108, 16, v84
v_and_b32 v109, 0xffff0000, v84
v_fmac_f32 v112, v73, v108
v_fmac_f32 v113, v73, v109
v_lshlrev_b32 v108, 16, v85
v_and_b32 v109, 0xffff0000, v85
v_fmac_f32 v114, v73, v108
v_fmac_f32 v115, v73, v109
v_lshlrev_b32 v108, 16, v86
v_and_b32 v109, 0xffff0000, v86
v_fmac_f32 v116, v73, v108
v_fmac_f32 v117, v73, v109
v_lshlrev_b32 v108, 16, v87
v_and_b32 v109, 0xffff0000, v87
v_fmac_f32 v118, v73, v108
v_fmac_f32 v119, v73, v109
v_lshlrev_b32 v108, 16, v88
v_and_b32 v109, 0xffff0000, v88
v_fmac_f32 v112, v74, v108
v_fmac_f32 v113, v74, v109
v_lshlrev_b32 v108, 16, v89
v_and_b32 v109, 0xffff0000, v89
v_fmac_f32 v114, v74, v108
v_fmac_f32 v115, v74, v109
v_lshlrev_b32 v108, 16, v90
v_and_b32 v109, 0xffff0000, v90
v_fmac_f32 v116, v74, v108
v_fmac_f32 v117, v74, v109
v_lshlrev_b32 v108, 16, v91
v_and_b32 v109, 0xffff0000, v91
v_fmac_f32 v118, v74, v108
v_fmac_f32 v119, v74, v109
v_lshlrev_b32 v108, 16, v92
v_and_b32 v109, 0xffff0000, v92
v_fmac_f32 v112, v75, v108
v_fmac_f32 v113, v75, v109
v_lshlrev_b32 v108, 16, v93
v_and_b32 v109, 0xffff0000, v93
v_fmac_f32 v114, v75, v108
v_fmac_f32 v115, v75, v109
v_lshlrev_b32 v108, 16, v94
v_and_b32 v109, 0xffff0000, v94
v_fmac_f32 v116, v75, v108
v_fmac_f32 v117, v75, v109
v_lshlrev_b32 v108, 16, v95
v_and_b32 v109, 0xffff0000, v95
v_fmac_f32 v118, v75, v108
v_fmac_f32 v119, v75, v109
v_lshlrev_b32 v108, 16, v96
v_and_b32 v109, 0xffff0000, v96
v_fmac_f32 v112, v76, v108
v_fmac_f32 v113, v76, v109
v_lshlrev_b32 v108, 16, v97
v_and_b32 v109, 0xffff0000, v97
v_fmac_f32 v114, v76, v108
v_fmac_f32 v115, v76, v109
v_lshlrev_b32 v108, 16, v98
v_and_b32 v109, 0xffff0000, v98
v_fmac_f32 v116, v76, v108
v_fmac_f32 v117, v76, v109
v_lshlrev_b32 v108, 16, v99
v_and_b32 v109, 0xffff0000, v99
v_fmac_f32 v118, v76, v108
v_fmac_f32 v119, v76, v109
v_lshlrev_b32 v108, 16, v100
v_and_b32 v109, 0xffff0000, v100
v_fmac_f32 v112, v77, v108
v_fmac_f32 v113, v77, v109
v_lshlrev_b32 v108, 16, v101
v_and_b32 v109, 0xffff0000, v101
v_fmac_f32 v114, v77, v108
v_fmac_f32 v115, v77, v109
v_lshlrev_b32 v108, 16, v102
v_and_b32 v109, 0xffff0000, v102
v_fmac_f32 v116, v77, v108
v_fmac_f32 v117, v77, v109
v_lshlrev_b32 v108, 16, v103
v_and_b32 v109, 0xffff0000, v103
v_fmac_f32 v118, v77, v108
v_fmac_f32 v119, v77, v109
v_lshlrev_b32 v108, 16, v104
v_and_b32 v109, 0xffff0000, v104
v_fmac_f32 v112, v78, v108
v_fmac_f32 v113, v78, v109
v_lshlrev_b32 v108, 16, v105
v_and_b32 v109, 0xffff0000, v105
v_fmac_f32 v114, v78, v108
v_fmac_f32 v115, v78, v109
v_lshlrev_b32 v108, 16, v106
v_and_b32 v109, 0xffff0000, v106
v_fmac_f32 v116, v78, v108
v_fmac_f32 v117, v78, v109
v_lshlrev_b32 v108, 16, v107
v_and_b32 v109, 0xffff0000, v107
v_fmac_f32 v118, v78, v108
v_fmac_f32 v119, v78, v109
v_add_f32_dpp v112, v112, v112 row_ror:4 row_mask:0xf bank_mask:0xf
v_add_f32_dpp v113, v113, v113 row_ror:4 row_mask:0xf bank_mask:0xf
v_add_f32_dpp v114, v114, v114 row_ror:4 row_mask:0xf bank_mask:0xf
v_add_f32_dpp v115, v115, v115 row_ror:4 row_mask:0xf bank_mask:0xf
v_add_f32_dpp v116, v116, v116 row_ror:4 row_mask:0xf bank_mask:0xf
v_add_f32_dpp v117, v117, v117 row_ror:4 row_mask:0xf bank_mask:0xf
v_add_f32_dpp v118, v118, v118 row_ror:4 row_mask:0xf bank_mask:0xf
v_add_f32_dpp v119, v119, v119 row_ror:4 row_mask:0xf bank_mask:0xf
v_add_f32_dpp v112, v112, v112 row_ror:8 row_mask:0xf bank_mask:0xf
v_add_f32_dpp v113, v113, v113 row_ror:8 row_mask:0xf bank_mask:0xf
v_add_f32_dpp v114, v114, v114 row_ror:8 row_mask:0xf bank_mask:0xf
v_add_f32_dpp v115, v115, v115 row_ror:8 row_mask:0xf bank_mask:0xf
v_add_f32_dpp v116, v116, v116 row_ror:8 row_mask:0xf bank_mask:0xf
v_add_f32_dpp v117, v117, v117 row_ror:8 row_mask:0xf bank_mask:0xf
v_add_f32_dpp v118, v118, v118 row_ror:8 row_mask:0xf bank_mask:0xf
v_add_f32_dpp v119, v119, v119 row_ror:8 row_mask:0xf bank_mask:0xf
v_and_b32 v3, 3, v0
v_lshrrev_b32 v6, 4, v0
v_lshlrev_b32 v6, 7, v6
v_lshl_add_u32 v6, v3, 5, v6
v_add_u32 v6, 155136, v6
v_and_b32 v7, 12, v0
v_cmp_eq_u32 vcc, 0, v7
s_and_saveexec_b64 s[32:33], vcc
ds_write_b128 v6, v[112:115]
ds_write_b128 v6, v[116:119] offset:16
s_mov_b64 exec, s[32:33]
s_waitcnt lgkmcnt(0)
s_barrier
s_cmp_lg_u32 s3, 0
s_cbranch_scc1 mod_skip_63
s_mov_b32 exec_hi, 0
v_lshlrev_b32 v6, 2, v1
v_add_u32 v7, 155136, v6
ds_read_b32 v80, v7 offset:0
ds_read_b32 v81, v7 offset:128
ds_read_b32 v82, v7 offset:256
ds_read_b32 v83, v7 offset:384
ds_read_b32 v84, v7 offset:512
ds_read_b32 v85, v7 offset:640
ds_read_b32 v86, v7 offset:768
ds_read_b32 v87, v7 offset:896
ds_read_b32 v88, v7 offset:1024
ds_read_b32 v89, v7 offset:1152
ds_read_b32 v90, v7 offset:1280
ds_read_b32 v91, v7 offset:1408
ds_read_b32 v92, v7 offset:1536
ds_read_b32 v93, v7 offset:1664
ds_read_b32 v94, v7 offset:1792
ds_read_b32 v95, v7 offset:1920
s_waitcnt lgkmcnt(0)
v_add_f32 v80, v80, v88
v_add_f32 v81, v81, v89
v_add_f32 v82, v82, v90
v_add_f32 v83, v83, v91
v_add_f32 v84, v84, v92
v_add_f32 v85, v85, v93
v_add_f32 v86, v86, v94
v_add_f32 v87, v87, v95
v_add_f32 v80, v80, v84
v_add_f32 v81, v81, v85
v_add_f32 v82, v82, v86
v_add_f32 v83, v83, v87
v_add_f32 v80, v80, v82
v_add_f32 v81, v81, v83
v_add_f32 v80, v80, v81
v_cvt_pk_bf16_f32 v80, v80, v80
v_and_b32 v80, 0xffff0000, v80
s_mul_hi_u32 s30, s45, 306783379
s_cmp_eq_u32 s30, 1
s_cselect_b32 s31, 1, 0
s_cmp_eq_u32 s30, 4
s_cselect_b32 s31, 1, s31
s_cmp_eq_u32 s31, 1
s_cbranch_scc0 mod_noadd_64
v_add_f32 v80, 1.0, v80
v_cvt_pk_bf16_f32 v80, v80, v80
v_and_b32 v80, 0xffff0000, v80
mod_noadd_64:
s_lshl_b32 s30, s45, 7
s_add_u32 s30, s30, 0
buffer_store_dword v80, v6, s[8:11], s30 offen sc1
s_mov_b64 exec, -1
mod_skip_63:
mrf_62:
s_load_dwordx2 s[20:21], s[0:1], 0
s_mov_b32 s22, 1835008
s_mov_b32 s23, 131072
s_load_dwordx2 s[24:25], s[0:1], 72
s_mov_b32 s26, 1835008
s_mov_b32 s27, 131072
s_and_b32 s6, s5, 1
s_lshl_b32 s28, s4, 1
s_add_u32 s6, s6, s28
s_lshr_b32 s7, s5, 1
s_lshl_b32 s28, s6, 6
s_lshl_b32 s29, s3, 4
s_add_u32 s29, s29, s28
s_lshl_b32 s29, s29, 11
s_add_u32 s40, s29, 3145728
s_add_u32 s41, s29, 5242880
s_lshl_b32 s19, s7, 2
s_add_u32 s19, s19, s28
s_min_u32 s39, s5, 27
s_mul_hi_u32 s28, s39, 613566757
s_mul_i32 s28, s28, 7
s_sub_u32 s28, s39, s28
s_lshl_b32 s28, s28, 1
s_and_b32 s29, s3, 1
s_add_u32 s12, s28, s29
s_xor_b32 s29, s29, 1
s_add_u32 s13, s28, s29
s_mul_i32 s28, s3, 28672
s_mul_i32 s12, s12, 114688
s_add_u32 s12, s12, s28
s_add_u32 s12, s12, 26214400
s_mul_i32 s13, s13, 114688
s_add_u32 s13, s13, s28
s_add_u32 s13, s13, 26214400
s_lshr_b32 s28, s5, 1
s_mul_i32 s15, s28, 200704
s_add_u32 s15, s15, 22020096
s_mul_i32 s16, s3, 7168
s_add_u32 s15, s15, s16
s_add_u32 s16, s16, 49152
s_min_u32 s39, s5, 27
s_mul_hi_u32 s28, s39, 613566757
s_mul_i32 s29, s28, 7
s_sub_u32 s29, s39, s29
s_lshl_b32 s30, s4, 3
s_lshl_b32 s28, s28, 1
s_add_u32 s28, s28, s30
s_lshr_b32 s30, s3, 1
s_add_u32 s28, s28, s30
s_mul_i32 s17, s28, 7168
s_add_u32 s17, s17, 31457280
s_lshl_b32 s29, s29, 1
s_and_b32 s30, s3, 1
s_add_u32 s29, s29, s30
s_mul_i32 s28, s28, 28
s_lshl_b32 s29, s29, 1
s_add_u32 s28, s28, s29
s_lshl_b32 s18, s28, 10
s_add_u32 s18, s18, 11534336
v_min_u32 v244, 55, v1
v_lshlrev_b32 v244, 7, v244
v_min_u32 v245, 15, v1
v_lshlrev_b32 v245, 7, v245
s_waitcnt lgkmcnt(0)
s_mov_b32 s38, 0
s_waitcnt vmcnt(0)
mc_65:
v_and_b32 v2, 0xfffffff0, v144
v_cmp_ne_u32 vcc, s88, v2
s_cbranch_vccz mc_66
s_add_u32 s38, s38, 1
s_cmp_ge_u32 s38, 131072
s_cbranch_scc1 mc_66
buffer_load_dword v144, v146, s[8:11], s91 offen sc1
s_waitcnt vmcnt(0)
s_branch mc_65
mc_66:
s_or_b32 s29, s88, s44
v_cmp_ne_u32 vcc, s29, v144
s_cmp_eq_u64 vcc, 0
s_cselect_b32 s47, 1, 0
s_add_u32 s29, s6, 16
s_mul_hi_u32 s29, s29, 715827883
s_add_u32 s30, s6, 32
s_mul_hi_u32 s30, s30, 715827883
s_mul_hi_u32 s31, s6, 715827883
v_and_b32 v4, 31, v1
v_lshrrev_b32 v5, 2, v4
v_lshlrev_b32 v5, 5, v5
v_and_b32 v4, 3, v4
v_lshl_add_u32 v4, v4, 3, v5
v_mov_b32 v5, s29
v_mov_b32 v6, s30
v_cmp_lt_u32 vcc, 31, v1
s_nop 1
v_cndmask_b32 v5, v5, v6, vcc
v_add_u32 v4, v5, v4
v_lshlrev_b32 v4, 7, v4
s_lshr_b32 s28, s5, 2
s_lshl_b32 s28, s28, 5
s_bfe_u32 s29, s5, 0x10001
s_lshl_b32 s29, s29, 4
s_add_u32 s28, s28, s29
s_add_u32 s28, s28, s31
v_and_b32 v7, 1, v1
v_lshlrev_b32 v7, 3, v7
v_add_u32 v7, s28, v7
v_lshlrev_b32 v7, 7, v7
s_waitcnt vmcnt(0)
s_cmp_lg_u32 s3, 0
s_cbranch_scc1 gw_end_69
s_mov_b32 s38, 0
s_mov_b32 s39, 32112640
gw_poll_67:
buffer_load_dword v3, v4, s[8:11], s39 offen sc1
buffer_load_dword v8, v7, s[8:11], s39 offen sc1
s_waitcnt vmcnt(0)
v_cmp_ne_u32 vcc, s88, v3
v_cmp_ne_u32 s[30:31], s88, v8
s_or_b64 vcc, vcc, s[30:31]
s_cbranch_vccz gw_done_68
s_mov_b64 exec, vcc
s_sleep 2
s_add_u32 s38, s38, 1
s_cmp_lt_u32 s38, 131072
s_cbranch_scc1 gw_poll_67
gw_done_68:
s_mov_b64 exec, -1
gw_end_69:
s_barrier
s_cmp_lg_u32 s3, 0
s_cbranch_scc1 rf_skip_70
s_lshl_b32 s28, s4, 7
s_lshl_b32 s29, s5, 2
s_add_u32 s28, s28, s29
s_add_u32 s28, s28, 299008
v_mov_b32 v2, 0
v_mov_b32 v3, s88
s_mov_b64 exec, 1
buffer_store_dword v3, v2, s[8:11], s28 offen sc1
s_mov_b64 exec, -1
rf_skip_70:
v_lshlrev_b32 v2, 4, v1
s_add_u32 s42, s40, 0
buffer_load_dwordx4 v[152:155], v2, s[8:11], s42 offen offset:0 sc1
buffer_load_dwordx4 v[156:159], v2, s[8:11], s42 offen offset:1024 sc1
s_add_u32 s43, s41, 0
buffer_load_dwordx4 v[160:163], v2, s[8:11], s43 offen offset:0 sc1
buffer_load_dwordx4 v[164:167], v2, s[8:11], s43 offen offset:1024 sc1
s_xor_b32 s31, s3, 0
s_add_u32 s31, s31, s19
s_lshl_b32 s31, s31, 11
s_add_u32 s31, s31, 1048576
buffer_load_dwordx4 v[16:19], v2, s[8:11], s31 offen sc1
buffer_load_dwordx4 v[20:23], v2, s[8:11], s31 offen offset:1024 sc1
s_xor_b32 s31, s3, 1
s_add_u32 s31, s31, s19
s_lshl_b32 s31, s31, 11
s_add_u32 s31, s31, 1048576
buffer_load_dwordx4 v[24:27], v2, s[8:11], s31 offen sc1
buffer_load_dwordx4 v[28:31], v2, s[8:11], s31 offen offset:1024 sc1
s_xor_b32 s31, s3, 2
s_add_u32 s31, s31, s19
s_lshl_b32 s31, s31, 11
s_add_u32 s31, s31, 1048576
buffer_load_dwordx4 v[32:35], v2, s[8:11], s31 offen sc1
buffer_load_dwordx4 v[36:39], v2, s[8:11], s31 offen offset:1024 sc1
s_xor_b32 s31, s3, 3
s_add_u32 s31, s31, s19
s_lshl_b32 s31, s31, 11
s_add_u32 s31, s31, 1048576
buffer_load_dwordx4 v[40:43], v2, s[8:11], s31 offen sc1
buffer_load_dwordx4 v[44:47], v2, s[8:11], s31 offen offset:1024 sc1
v_lshlrev_b32 v3, 7, v1
s_lshl_b32 s31, s6, 13
s_add_u32 s31, s31, 31981568
buffer_load_dword v15, v3, s[8:11], s31 offen sc1
s_add_u32 s42, s40, 2048
buffer_load_dwordx4 v[168:171], v2, s[8:11], s42 offen offset:0 sc1
buffer_load_dwordx4 v[172:175], v2, s[8:11], s42 offen offset:1024 sc1
s_add_u32 s43, s41, 2048
buffer_load_dwordx4 v[176:179], v2, s[8:11], s43 offen offset:0 sc1
buffer_load_dwordx4 v[180:183], v2, s[8:11], s43 offen offset:1024 sc1
s_add_u32 s42, s40, 4096
buffer_load_dwordx4 v[184:187], v2, s[8:11], s42 offen offset:0 sc1
buffer_load_dwordx4 v[188:191], v2, s[8:11], s42 offen offset:1024 sc1
s_add_u32 s43, s41, 4096
buffer_load_dwordx4 v[192:195], v2, s[8:11], s43 offen offset:0 sc1
buffer_load_dwordx4 v[196:199], v2, s[8:11], s43 offen offset:1024 sc1
s_add_u32 s42, s40, 6144
buffer_load_dwordx4 v[200:203], v2, s[8:11], s42 offen offset:0 sc1
buffer_load_dwordx4 v[204:207], v2, s[8:11], s42 offen offset:1024 sc1
s_add_u32 s43, s41, 6144
buffer_load_dwordx4 v[208:211], v2, s[8:11], s43 offen offset:0 sc1
buffer_load_dwordx4 v[212:215], v2, s[8:11], s43 offen offset:1024 sc1
s_waitcnt vmcnt(12)
v_mov_b32 v4, v15
s_nop 1
v_max_f32_dpp v4, v4, v4 row_ror:1 row_mask:0xf bank_mask:0xf
s_nop 1
v_max_f32_dpp v4, v4, v4 row_ror:2 row_mask:0xf bank_mask:0xf
s_nop 1
v_max_f32_dpp v4, v4, v4 row_ror:4 row_mask:0xf bank_mask:0xf
s_nop 1
v_max_f32_dpp v4, v4, v4 row_ror:8 row_mask:0xf bank_mask:0xf
s_nop 0
v_readlane_b32 s32, v4, 0
v_readlane_b32 s33, v4, 16
v_readlane_b32 s34, v4, 32
v_readlane_b32 s35, v4, 48
s_max_u32 s32, s32, s33
s_max_u32 s34, s34, s35
s_max_u32 s32, s32, s34
v_cmp_lt_u32 vcc, 31, v1
v_mov_b32 v8, 0
v_mov_b32 v9, 0
v_mov_b32 v10, 0
v_mov_b32 v11, 0
v_dot2c_f32_bf16 v8, v16, v16
v_dot2c_f32_bf16 v9, v24, v24
v_dot2c_f32_bf16 v10, v32, v32
v_dot2c_f32_bf16 v11, v40, v40
v_dot2c_f32_bf16 v8, v17, v17
v_dot2c_f32_bf16 v9, v25, v25
v_dot2c_f32_bf16 v10, v33, v33
v_dot2c_f32_bf16 v11, v41, v41
v_dot2c_f32_bf16 v8, v18, v18
v_dot2c_f32_bf16 v9, v26, v26
v_dot2c_f32_bf16 v10, v34, v34
v_dot2c_f32_bf16 v11, v42, v42
v_dot2c_f32_bf16 v8, v19, v19
v_dot2c_f32_bf16 v9, v27, v27
v_dot2c_f32_bf16 v10, v35, v35
v_dot2c_f32_bf16 v11, v43, v43
v_dot2c_f32_bf16 v8, v20, v20
v_dot2c_f32_bf16 v9, v28, v28
v_dot2c_f32_bf16 v10, v36, v36
v_dot2c_f32_bf16 v11, v44, v44
v_dot2c_f32_bf16 v8, v21, v21
v_dot2c_f32_bf16 v9, v29, v29
v_dot2c_f32_bf16 v10, v37, v37
v_dot2c_f32_bf16 v11, v45, v45
v_dot2c_f32_bf16 v8, v22, v22
v_dot2c_f32_bf16 v9, v30, v30
v_dot2c_f32_bf16 v10, v38, v38
v_dot2c_f32_bf16 v11, v46, v46
v_dot2c_f32_bf16 v8, v23, v23
v_dot2c_f32_bf16 v9, v31, v31
v_dot2c_f32_bf16 v10, v39, v39
v_dot2c_f32_bf16 v11, v47, v47
v_mov_b32 v12, v8
v_mov_b32 v13, v9
v_mov_b32 v14, v10
v_mov_b32 v15, v11
v_permlane32_swap_b32 v8, v12
v_permlane32_swap_b32 v9, v13
v_permlane32_swap_b32 v10, v14
v_permlane32_swap_b32 v11, v15
v_add_f32 v8, v8, v12
v_add_f32 v9, v9, v13
v_add_f32 v10, v10, v14
v_add_f32 v11, v11, v15
v_mul_f32 v8, s32, v8
v_mul_f32 v9, s32, v9
v_mul_f32 v10, s32, v10
v_mul_f32 v11, s32, v11
v_sqrt_f32 v8, v8
v_sqrt_f32 v9, v9
v_sqrt_f32 v10, v10
v_sqrt_f32 v11, v11
v_mov_b32 v6, 0
v_mul_f32 v8, 0xbf828f5c, v8
v_mul_f32 v9, 0xbf828f5c, v9
v_mul_f32 v10, 0xbf828f5c, v10
v_mul_f32 v11, 0xbf828f5c, v11
v_cvt_pk_bf16_f32 v8, v8, v6
v_cvt_pk_bf16_f32 v9, v9, v6
v_cvt_pk_bf16_f32 v10, v10, v6
v_cvt_pk_bf16_f32 v11, v11, v6
v_cndmask_b32 v22, v22, v8, vcc
v_cndmask_b32 v30, v30, v9, vcc
v_cndmask_b32 v38, v38, v10, vcc
v_cndmask_b32 v46, v46, v11, vcc
v_lshlrev_b32 v2, 4, v1
s_xor_b32 s28, s3, 1
s_mul_i32 s28, s28, 12288
s_add_u32 s28, s28, 0
v_add_u32 v8, s28, v2
s_xor_b32 s28, s3, 2
s_mul_i32 s28, s28, 12288
s_add_u32 s28, s28, 4096
v_add_u32 v9, s28, v2
s_xor_b32 s28, s3, 3
s_mul_i32 s28, s28, 12288
s_add_u32 s28, s28, 8192
v_add_u32 v10, s28, v2
s_mul_i32 s28, s3, 12288
s_add_u32 s28, s28, 0
v_add_u32 v11, s28, v2
s_waitcnt vmcnt(21)
v_mfma_f32_32x32x16_bf16 v[112:127], v[152:155], v[16:19], 0
v_mfma_f32_32x32x16_bf16 v[112:127], v[156:159], v[20:23], v[112:127]
s_nop 11
v_exp_f32 v112, v112
v_exp_f32 v113, v113
s_add_u32 s42, s40, 8192
buffer_load_dwordx4 v[216:219], v2, s[8:11], s42 offen offset:0 sc1
v_exp_f32 v114, v114
v_exp_f32 v115, v115
v_cvt_pk_bf16_f32 v144, v112, v113
v_cvt_pk_bf16_f32 v145, v114, v115
v_mfma_f32_32x32x16_bf16 v[128:143], v[152:155], v[24:27], 0
buffer_load_dwordx4 v[220:223], v2, s[8:11], s42 offen offset:1024 sc1
v_exp_f32 v116, v116
v_exp_f32 v117, v117
v_exp_f32 v118, v118
v_exp_f32 v119, v119
v_cvt_pk_bf16_f32 v146, v116, v117
v_cvt_pk_bf16_f32 v147, v118, v119
v_mfma_f32_32x32x16_bf16 v[128:143], v[156:159], v[28:31], v[128:143]
s_add_u32 s43, s41, 8192
buffer_load_dwordx4 v[224:227], v2, s[8:11], s43 offen offset:0 sc1
v_exp_f32 v120, v120
v_exp_f32 v121, v121
v_exp_f32 v122, v122
v_exp_f32 v123, v123
v_cvt_pk_bf16_f32 v148, v120, v121
v_cvt_pk_bf16_f32 v149, v122, v123
v_mfma_f32_32x32x16_bf16 v[48:63], v[160:163], v[144:147], 0
buffer_load_dwordx4 v[228:231], v2, s[8:11], s43 offen offset:1024 sc1
v_exp_f32 v124, v124
v_exp_f32 v125, v125
v_exp_f32 v126, v126
v_exp_f32 v127, v127
v_cvt_pk_bf16_f32 v150, v124, v125
v_cvt_pk_bf16_f32 v151, v126, v127
v_exp_f32 v128, v128
v_exp_f32 v129, v129
v_mfma_f32_32x32x16_bf16 v[48:63], v[164:167], v[148:151], v[48:63]
v_exp_f32 v130, v130
v_exp_f32 v131, v131
v_cvt_pk_bf16_f32 v144, v128, v129
v_cvt_pk_bf16_f32 v145, v130, v131
v_mfma_f32_32x32x16_bf16 v[112:127], v[152:155], v[32:35], 0
v_exp_f32 v132, v132
v_exp_f32 v133, v133
v_exp_f32 v134, v134
v_exp_f32 v135, v135
v_cvt_pk_bf16_f32 v146, v132, v133
v_cvt_pk_bf16_f32 v147, v134, v135
v_mfma_f32_32x32x16_bf16 v[112:127], v[156:159], v[36:39], v[112:127]
v_exp_f32 v136, v136
v_exp_f32 v137, v137
v_exp_f32 v138, v138
v_exp_f32 v139, v139
v_cvt_pk_bf16_f32 v148, v136, v137
v_cvt_pk_bf16_f32 v149, v138, v139
v_mfma_f32_32x32x16_bf16 v[64:79], v[160:163], v[144:147], 0
v_exp_f32 v140, v140
v_exp_f32 v141, v141
v_exp_f32 v142, v142
v_exp_f32 v143, v143
v_cvt_pk_bf16_f32 v150, v140, v141
v_cvt_pk_bf16_f32 v151, v142, v143
v_exp_f32 v112, v112
v_exp_f32 v113, v113
v_mfma_f32_32x32x16_bf16 v[64:79], v[164:167], v[148:151], v[64:79]
v_exp_f32 v114, v114
v_exp_f32 v115, v115
v_cvt_pk_bf16_f32 v144, v112, v113
v_cvt_pk_bf16_f32 v145, v114, v115
v_mfma_f32_32x32x16_bf16 v[128:143], v[152:155], v[40:43], 0
v_exp_f32 v116, v116
v_exp_f32 v117, v117
v_exp_f32 v118, v118
v_exp_f32 v119, v119
v_cvt_pk_bf16_f32 v146, v116, v117
v_cvt_pk_bf16_f32 v147, v118, v119
v_mfma_f32_32x32x16_bf16 v[128:143], v[156:159], v[44:47], v[128:143]
v_exp_f32 v120, v120
v_exp_f32 v121, v121
v_exp_f32 v122, v122
v_exp_f32 v123, v123
v_cvt_pk_bf16_f32 v148, v120, v121
v_cvt_pk_bf16_f32 v149, v122, v123
v_mfma_f32_32x32x16_bf16 v[80:95], v[160:163], v[144:147], 0
v_exp_f32 v124, v124
v_exp_f32 v125, v125
v_exp_f32 v126, v126
v_exp_f32 v127, v127
v_cvt_pk_bf16_f32 v150, v124, v125
v_cvt_pk_bf16_f32 v151, v126, v127
v_exp_f32 v128, v128
v_exp_f32 v129, v129
s_waitcnt vmcnt(12)
v_mfma_f32_32x32x16_bf16 v[80:95], v[164:167], v[148:151], v[80:95]
v_exp_f32 v130, v130
v_exp_f32 v131, v131
v_cvt_pk_bf16_f32 v144, v128, v129
v_cvt_pk_bf16_f32 v145, v130, v131
v_mfma_f32_32x32x16_bf16 v[112:127], v[168:171], v[16:19], 0
v_exp_f32 v132, v132
v_exp_f32 v133, v133
v_exp_f32 v134, v134
v_exp_f32 v135, v135
v_cvt_pk_bf16_f32 v146, v132, v133
v_cvt_pk_bf16_f32 v147, v134, v135
v_mfma_f32_32x32x16_bf16 v[112:127], v[172:175], v[20:23], v[112:127]
v_exp_f32 v136, v136
v_exp_f32 v137, v137
v_exp_f32 v138, v138
v_exp_f32 v139, v139
v_cvt_pk_bf16_f32 v148, v136, v137
v_cvt_pk_bf16_f32 v149, v138, v139
v_mfma_f32_32x32x16_bf16 v[96:111], v[160:163], v[144:147], 0
v_exp_f32 v140, v140
v_exp_f32 v141, v141
v_exp_f32 v142, v142
v_exp_f32 v143, v143
v_cvt_pk_bf16_f32 v150, v140, v141
v_cvt_pk_bf16_f32 v151, v142, v143
v_exp_f32 v112, v112
v_exp_f32 v113, v113
v_mfma_f32_32x32x16_bf16 v[96:111], v[164:167], v[148:151], v[96:111]
s_add_u32 s42, s40, 10240
buffer_load_dwordx4 v[152:155], v2, s[8:11], s42 offen offset:0 sc1
v_exp_f32 v114, v114
v_exp_f32 v115, v115
v_cvt_pk_bf16_f32 v144, v112, v113
v_cvt_pk_bf16_f32 v145, v114, v115
v_mfma_f32_32x32x16_bf16 v[128:143], v[168:171], v[24:27], 0
buffer_load_dwordx4 v[156:159], v2, s[8:11], s42 offen offset:1024 sc1
v_exp_f32 v116, v116
v_exp_f32 v117, v117
v_exp_f32 v118, v118
v_exp_f32 v119, v119
v_cvt_pk_bf16_f32 v146, v116, v117
v_cvt_pk_bf16_f32 v147, v118, v119
v_mfma_f32_32x32x16_bf16 v[128:143], v[172:175], v[28:31], v[128:143]
s_add_u32 s43, s41, 10240
buffer_load_dwordx4 v[160:163], v2, s[8:11], s43 offen offset:0 sc1
v_exp_f32 v120, v120
v_exp_f32 v121, v121
v_exp_f32 v122, v122
v_exp_f32 v123, v123
v_cvt_pk_bf16_f32 v148, v120, v121
v_cvt_pk_bf16_f32 v149, v122, v123
v_mfma_f32_32x32x16_bf16 v[48:63], v[176:179], v[144:147], v[48:63]
buffer_load_dwordx4 v[164:167], v2, s[8:11], s43 offen offset:1024 sc1
v_exp_f32 v124, v124
v_exp_f32 v125, v125
v_exp_f32 v126, v126
v_exp_f32 v127, v127
v_cvt_pk_bf16_f32 v150, v124, v125
v_cvt_pk_bf16_f32 v151, v126, v127
v_exp_f32 v128, v128
v_exp_f32 v129, v129
v_mfma_f32_32x32x16_bf16 v[48:63], v[180:183], v[148:151], v[48:63]
buffer_load_dword v246, v244, s[8:11], s17 offen sc1
v_exp_f32 v130, v130
v_exp_f32 v131, v131
v_cvt_pk_bf16_f32 v144, v128, v129
v_cvt_pk_bf16_f32 v145, v130, v131
v_mfma_f32_32x32x16_bf16 v[112:127], v[168:171], v[32:35], 0
buffer_load_dword v246, v245, s[8:11], s18 offen sc1
v_exp_f32 v132, v132
v_exp_f32 v133, v133
v_exp_f32 v134, v134
v_exp_f32 v135, v135
v_cvt_pk_bf16_f32 v146, v132, v133
v_cvt_pk_bf16_f32 v147, v134, v135
v_mfma_f32_32x32x16_bf16 v[112:127], v[172:175], v[36:39], v[112:127]
v_exp_f32 v136, v136
v_exp_f32 v137, v137
v_exp_f32 v138, v138
v_exp_f32 v139, v139
v_cvt_pk_bf16_f32 v148, v136, v137
v_cvt_pk_bf16_f32 v149, v138, v139
v_mfma_f32_32x32x16_bf16 v[64:79], v[176:179], v[144:147], v[64:79]
v_exp_f32 v140, v140
v_exp_f32 v141, v141
v_exp_f32 v142, v142
v_exp_f32 v143, v143
v_cvt_pk_bf16_f32 v150, v140, v141
v_cvt_pk_bf16_f32 v151, v142, v143
v_exp_f32 v112, v112
v_exp_f32 v113, v113
v_mfma_f32_32x32x16_bf16 v[64:79], v[180:183], v[148:151], v[64:79]
v_exp_f32 v114, v114
v_exp_f32 v115, v115
v_cvt_pk_bf16_f32 v144, v112, v113
v_cvt_pk_bf16_f32 v145, v114, v115
v_mfma_f32_32x32x16_bf16 v[128:143], v[168:171], v[40:43], 0
v_exp_f32 v116, v116
v_exp_f32 v117, v117
v_exp_f32 v118, v118
v_exp_f32 v119, v119
v_cvt_pk_bf16_f32 v146, v116, v117
v_cvt_pk_bf16_f32 v147, v118, v119
v_mfma_f32_32x32x16_bf16 v[128:143], v[172:175], v[44:47], v[128:143]
v_exp_f32 v120, v120
v_exp_f32 v121, v121
v_exp_f32 v122, v122
v_exp_f32 v123, v123
v_cvt_pk_bf16_f32 v148, v120, v121
v_cvt_pk_bf16_f32 v149, v122, v123
v_mfma_f32_32x32x16_bf16 v[80:95], v[176:179], v[144:147], v[80:95]
v_exp_f32 v124, v124
v_exp_f32 v125, v125
v_exp_f32 v126, v126
v_exp_f32 v127, v127
v_cvt_pk_bf16_f32 v150, v124, v125
v_cvt_pk_bf16_f32 v151, v126, v127
v_exp_f32 v128, v128
v_exp_f32 v129, v129
s_waitcnt vmcnt(14)
v_mfma_f32_32x32x16_bf16 v[80:95], v[180:183], v[148:151], v[80:95]
v_exp_f32 v130, v130
v_exp_f32 v131, v131
v_cvt_pk_bf16_f32 v144, v128, v129
v_cvt_pk_bf16_f32 v145, v130, v131
v_mfma_f32_32x32x16_bf16 v[112:127], v[184:187], v[16:19], 0
v_exp_f32 v132, v132
v_exp_f32 v133, v133
v_exp_f32 v134, v134
v_exp_f32 v135, v135
v_cvt_pk_bf16_f32 v146, v132, v133
v_cvt_pk_bf16_f32 v147, v134, v135
v_mfma_f32_32x32x16_bf16 v[112:127], v[188:191], v[20:23], v[112:127]
v_exp_f32 v136, v136
v_exp_f32 v137, v137
v_exp_f32 v138, v138
v_exp_f32 v139, v139
v_cvt_pk_bf16_f32 v148, v136, v137
v_cvt_pk_bf16_f32 v149, v138, v139
v_mfma_f32_32x32x16_bf16 v[96:111], v[176:179], v[144:147], v[96:111]
v_exp_f32 v140, v140
v_exp_f32 v141, v141
v_exp_f32 v142, v142
v_exp_f32 v143, v143
v_cvt_pk_bf16_f32 v150, v140, v141
v_cvt_pk_bf16_f32 v151, v142, v143
v_exp_f32 v112, v112
v_exp_f32 v113, v113
v_mfma_f32_32x32x16_bf16 v[96:111], v[180:183], v[148:151], v[96:111]
s_cmp_lg_u32 s3, 0
s_cbranch_scc1 pfl_71
v_lshlrev_b32 v232, 4, v1
s_mov_b32 s14, 299008
buffer_load_dwordx4 v[240:243], v232, s[8:11], s14 offen sc1
pfl_71:
s_add_u32 s42, s40, 12288
buffer_load_dwordx4 v[168:171], v2, s[8:11], s42 offen offset:0 sc1
v_exp_f32 v114, v114
v_exp_f32 v115, v115
v_cvt_pk_bf16_f32 v144, v112, v113
v_cvt_pk_bf16_f32 v145, v114, v115
v_mfma_f32_32x32x16_bf16 v[128:143], v[184:187], v[24:27], 0
buffer_load_dwordx4 v[172:175], v2, s[8:11], s42 offen offset:1024 sc1
v_exp_f32 v116, v116
v_exp_f32 v117, v117
v_exp_f32 v118, v118
v_exp_f32 v119, v119
v_cvt_pk_bf16_f32 v146, v116, v117
v_cvt_pk_bf16_f32 v147, v118, v119
v_mfma_f32_32x32x16_bf16 v[128:143], v[188:191], v[28:31], v[128:143]
s_add_u32 s43, s41, 12288
buffer_load_dwordx4 v[176:179], v2, s[8:11], s43 offen offset:0 sc1
v_exp_f32 v120, v120
v_exp_f32 v121, v121
v_exp_f32 v122, v122
v_exp_f32 v123, v123
v_cvt_pk_bf16_f32 v148, v120, v121
v_cvt_pk_bf16_f32 v149, v122, v123
v_mfma_f32_32x32x16_bf16 v[48:63], v[192:195], v[144:147], v[48:63]
buffer_load_dwordx4 v[180:183], v2, s[8:11], s43 offen offset:1024 sc1
v_exp_f32 v124, v124
v_exp_f32 v125, v125
v_exp_f32 v126, v126
v_exp_f32 v127, v127
v_cvt_pk_bf16_f32 v150, v124, v125
v_cvt_pk_bf16_f32 v151, v126, v127
v_exp_f32 v128, v128
v_exp_f32 v129, v129
v_mfma_f32_32x32x16_bf16 v[48:63], v[196:199], v[148:151], v[48:63]
v_exp_f32 v130, v130
v_exp_f32 v131, v131
v_cvt_pk_bf16_f32 v144, v128, v129
v_cvt_pk_bf16_f32 v145, v130, v131
v_mfma_f32_32x32x16_bf16 v[112:127], v[184:187], v[32:35], 0
v_exp_f32 v132, v132
v_exp_f32 v133, v133
v_exp_f32 v134, v134
v_exp_f32 v135, v135
v_cvt_pk_bf16_f32 v146, v132, v133
v_cvt_pk_bf16_f32 v147, v134, v135
v_mfma_f32_32x32x16_bf16 v[112:127], v[188:191], v[36:39], v[112:127]
v_exp_f32 v136, v136
v_exp_f32 v137, v137
v_exp_f32 v138, v138
v_exp_f32 v139, v139
v_cvt_pk_bf16_f32 v148, v136, v137
v_cvt_pk_bf16_f32 v149, v138, v139
v_mfma_f32_32x32x16_bf16 v[64:79], v[192:195], v[144:147], v[64:79]
v_exp_f32 v140, v140
v_exp_f32 v141, v141
v_exp_f32 v142, v142
v_exp_f32 v143, v143
v_cvt_pk_bf16_f32 v150, v140, v141
v_cvt_pk_bf16_f32 v151, v142, v143
v_exp_f32 v112, v112
v_exp_f32 v113, v113
v_mfma_f32_32x32x16_bf16 v[64:79], v[196:199], v[148:151], v[64:79]
v_exp_f32 v114, v114
v_exp_f32 v115, v115
v_cvt_pk_bf16_f32 v144, v112, v113
v_cvt_pk_bf16_f32 v145, v114, v115
v_mfma_f32_32x32x16_bf16 v[128:143], v[184:187], v[40:43], 0
v_exp_f32 v116, v116
v_exp_f32 v117, v117
v_exp_f32 v118, v118
v_exp_f32 v119, v119
v_cvt_pk_bf16_f32 v146, v116, v117
v_cvt_pk_bf16_f32 v147, v118, v119
v_mfma_f32_32x32x16_bf16 v[128:143], v[188:191], v[44:47], v[128:143]
v_exp_f32 v120, v120
v_exp_f32 v121, v121
v_exp_f32 v122, v122
v_exp_f32 v123, v123
v_cvt_pk_bf16_f32 v148, v120, v121
v_cvt_pk_bf16_f32 v149, v122, v123
v_mfma_f32_32x32x16_bf16 v[80:95], v[192:195], v[144:147], v[80:95]
v_exp_f32 v124, v124
v_exp_f32 v125, v125
v_exp_f32 v126, v126
v_exp_f32 v127, v127
v_cvt_pk_bf16_f32 v150, v124, v125
v_cvt_pk_bf16_f32 v151, v126, v127
v_exp_f32 v128, v128
v_exp_f32 v129, v129
s_waitcnt vmcnt(14)
v_mfma_f32_32x32x16_bf16 v[80:95], v[196:199], v[148:151], v[80:95]
v_exp_f32 v130, v130
v_exp_f32 v131, v131
v_cvt_pk_bf16_f32 v144, v128, v129
v_cvt_pk_bf16_f32 v145, v130, v131
v_mfma_f32_32x32x16_bf16 v[112:127], v[200:203], v[16:19], 0
v_exp_f32 v132, v132
v_exp_f32 v133, v133
v_exp_f32 v134, v134
v_exp_f32 v135, v135
v_cvt_pk_bf16_f32 v146, v132, v133
v_cvt_pk_bf16_f32 v147, v134, v135
v_mfma_f32_32x32x16_bf16 v[112:127], v[204:207], v[20:23], v[112:127]
v_exp_f32 v136, v136
v_exp_f32 v137, v137
v_exp_f32 v138, v138
v_exp_f32 v139, v139
v_cvt_pk_bf16_f32 v148, v136, v137
v_cvt_pk_bf16_f32 v149, v138, v139
v_mfma_f32_32x32x16_bf16 v[96:111], v[192:195], v[144:147], v[96:111]
v_exp_f32 v140, v140
v_exp_f32 v141, v141
v_exp_f32 v142, v142
v_exp_f32 v143, v143
v_cvt_pk_bf16_f32 v150, v140, v141
v_cvt_pk_bf16_f32 v151, v142, v143
v_exp_f32 v112, v112
v_exp_f32 v113, v113
v_mfma_f32_32x32x16_bf16 v[96:111], v[196:199], v[148:151], v[96:111]
s_add_u32 s42, s40, 14336
buffer_load_dwordx4 v[184:187], v2, s[8:11], s42 offen offset:0 sc1
v_exp_f32 v114, v114
v_exp_f32 v115, v115
v_cvt_pk_bf16_f32 v144, v112, v113
v_cvt_pk_bf16_f32 v145, v114, v115
v_mfma_f32_32x32x16_bf16 v[128:143], v[200:203], v[24:27], 0
buffer_load_dwordx4 v[188:191], v2, s[8:11], s42 offen offset:1024 sc1
v_exp_f32 v116, v116
v_exp_f32 v117, v117
v_exp_f32 v118, v118
v_exp_f32 v119, v119
v_cvt_pk_bf16_f32 v146, v116, v117
v_cvt_pk_bf16_f32 v147, v118, v119
v_mfma_f32_32x32x16_bf16 v[128:143], v[204:207], v[28:31], v[128:143]
s_add_u32 s43, s41, 14336
buffer_load_dwordx4 v[192:195], v2, s[8:11], s43 offen offset:0 sc1
v_exp_f32 v120, v120
v_exp_f32 v121, v121
v_exp_f32 v122, v122
v_exp_f32 v123, v123
v_cvt_pk_bf16_f32 v148, v120, v121
v_cvt_pk_bf16_f32 v149, v122, v123
v_mfma_f32_32x32x16_bf16 v[48:63], v[208:211], v[144:147], v[48:63]
buffer_load_dwordx4 v[196:199], v2, s[8:11], s43 offen offset:1024 sc1
v_exp_f32 v124, v124
v_exp_f32 v125, v125
v_exp_f32 v126, v126
v_exp_f32 v127, v127
v_cvt_pk_bf16_f32 v150, v124, v125
v_cvt_pk_bf16_f32 v151, v126, v127
v_exp_f32 v128, v128
v_exp_f32 v129, v129
v_mfma_f32_32x32x16_bf16 v[48:63], v[212:215], v[148:151], v[48:63]
v_exp_f32 v130, v130
v_exp_f32 v131, v131
v_cvt_pk_bf16_f32 v144, v128, v129
v_cvt_pk_bf16_f32 v145, v130, v131
v_mfma_f32_32x32x16_bf16 v[112:127], v[200:203], v[32:35], 0
v_exp_f32 v132, v132
v_exp_f32 v133, v133
v_exp_f32 v134, v134
v_exp_f32 v135, v135
v_cvt_pk_bf16_f32 v146, v132, v133
v_cvt_pk_bf16_f32 v147, v134, v135
v_mfma_f32_32x32x16_bf16 v[112:127], v[204:207], v[36:39], v[112:127]
v_exp_f32 v136, v136
v_exp_f32 v137, v137
v_exp_f32 v138, v138
v_exp_f32 v139, v139
v_cvt_pk_bf16_f32 v148, v136, v137
v_cvt_pk_bf16_f32 v149, v138, v139
v_mfma_f32_32x32x16_bf16 v[64:79], v[208:211], v[144:147], v[64:79]
v_exp_f32 v140, v140
v_exp_f32 v141, v141
v_exp_f32 v142, v142
v_exp_f32 v143, v143
v_cvt_pk_bf16_f32 v150, v140, v141
v_cvt_pk_bf16_f32 v151, v142, v143
v_exp_f32 v112, v112
v_exp_f32 v113, v113
v_mfma_f32_32x32x16_bf16 v[64:79], v[212:215], v[148:151], v[64:79]
v_exp_f32 v114, v114
v_exp_f32 v115, v115
v_cvt_pk_bf16_f32 v144, v112, v113
v_cvt_pk_bf16_f32 v145, v114, v115
v_mfma_f32_32x32x16_bf16 v[128:143], v[200:203], v[40:43], 0
v_exp_f32 v116, v116
v_exp_f32 v117, v117
v_exp_f32 v118, v118
v_exp_f32 v119, v119
v_cvt_pk_bf16_f32 v146, v116, v117
v_cvt_pk_bf16_f32 v147, v118, v119
v_mfma_f32_32x32x16_bf16 v[128:143], v[204:207], v[44:47], v[128:143]
v_exp_f32 v120, v120
v_exp_f32 v121, v121
v_exp_f32 v122, v122
v_exp_f32 v123, v123
v_cvt_pk_bf16_f32 v148, v120, v121
v_cvt_pk_bf16_f32 v149, v122, v123
v_mfma_f32_32x32x16_bf16 v[80:95], v[208:211], v[144:147], v[80:95]
v_exp_f32 v124, v124
v_exp_f32 v125, v125
v_exp_f32 v126, v126
v_exp_f32 v127, v127
v_cvt_pk_bf16_f32 v150, v124, v125
v_cvt_pk_bf16_f32 v151, v126, v127
v_exp_f32 v128, v128
v_exp_f32 v129, v129
s_waitcnt vmcnt(14)
v_mfma_f32_32x32x16_bf16 v[80:95], v[212:215], v[148:151], v[80:95]
v_exp_f32 v130, v130
v_exp_f32 v131, v131
v_cvt_pk_bf16_f32 v144, v128, v129
v_cvt_pk_bf16_f32 v145, v130, v131
v_mfma_f32_32x32x16_bf16 v[112:127], v[216:219], v[16:19], 0
v_exp_f32 v132, v132
v_exp_f32 v133, v133
v_exp_f32 v134, v134
v_exp_f32 v135, v135
v_cvt_pk_bf16_f32 v146, v132, v133
v_cvt_pk_bf16_f32 v147, v134, v135
v_mfma_f32_32x32x16_bf16 v[112:127], v[220:223], v[20:23], v[112:127]
v_exp_f32 v136, v136
v_exp_f32 v137, v137
v_exp_f32 v138, v138
v_exp_f32 v139, v139
v_cvt_pk_bf16_f32 v148, v136, v137
v_cvt_pk_bf16_f32 v149, v138, v139
v_mfma_f32_32x32x16_bf16 v[96:111], v[208:211], v[144:147], v[96:111]
v_exp_f32 v140, v140
v_exp_f32 v141, v141
v_exp_f32 v142, v142
v_exp_f32 v143, v143
v_cvt_pk_bf16_f32 v150, v140, v141
v_cvt_pk_bf16_f32 v151, v142, v143
v_exp_f32 v112, v112
v_exp_f32 v113, v113
v_mfma_f32_32x32x16_bf16 v[96:111], v[212:215], v[148:151], v[96:111]
s_cmp_lg_u32 s3, 0
s_cbranch_scc1 pfc_74
s_waitcnt vmcnt(8)
s_mov_b32 s38, 0
pfc_72:
v_cmp_ne_u32 vcc, s88, v240
v_cmp_ne_u32 s[30:31], s88, v241
s_or_b64 vcc, vcc, s[30:31]
v_cmp_ne_u32 s[30:31], s88, v242
s_or_b64 vcc, vcc, s[30:31]
v_cmp_ne_u32 s[30:31], s88, v243
s_or_b64 vcc, vcc, s[30:31]
s_cbranch_vccz pfc_73
s_add_u32 s38, s38, 1
s_cmp_ge_u32 s38, 131072
s_cbranch_scc1 pfc_73
s_sleep 4
s_mov_b32 s14, 299008
buffer_load_dwordx4 v[240:243], v232, s[8:11], s14 offen sc1
s_waitcnt vmcnt(0)
s_branch pfc_72
pfc_73:
pfc_74:
s_barrier
s_add_u32 s42, s40, 16384
buffer_load_dwordx4 v[200:203], v2, s[8:11], s42 offen offset:0 sc1
v_exp_f32 v114, v114
v_exp_f32 v115, v115
v_cvt_pk_bf16_f32 v144, v112, v113
v_cvt_pk_bf16_f32 v145, v114, v115
v_mfma_f32_32x32x16_bf16 v[128:143], v[216:219], v[24:27], 0
buffer_load_dwordx4 v[204:207], v2, s[8:11], s42 offen offset:1024 sc1
v_exp_f32 v116, v116
v_exp_f32 v117, v117
v_exp_f32 v118, v118
v_exp_f32 v119, v119
v_cvt_pk_bf16_f32 v146, v116, v117
v_cvt_pk_bf16_f32 v147, v118, v119
v_mfma_f32_32x32x16_bf16 v[128:143], v[220:223], v[28:31], v[128:143]
s_add_u32 s43, s41, 16384
buffer_load_dwordx4 v[208:211], v2, s[8:11], s43 offen offset:0 sc1
v_exp_f32 v120, v120
v_exp_f32 v121, v121
v_exp_f32 v122, v122
v_exp_f32 v123, v123
v_cvt_pk_bf16_f32 v148, v120, v121
v_cvt_pk_bf16_f32 v149, v122, v123
v_mfma_f32_32x32x16_bf16 v[48:63], v[224:227], v[144:147], v[48:63]
buffer_load_dwordx4 v[212:215], v2, s[8:11], s43 offen offset:1024 sc1
v_exp_f32 v124, v124
v_exp_f32 v125, v125
v_exp_f32 v126, v126
v_exp_f32 v127, v127
v_cvt_pk_bf16_f32 v150, v124, v125
v_cvt_pk_bf16_f32 v151, v126, v127
v_exp_f32 v128, v128
v_exp_f32 v129, v129
v_mfma_f32_32x32x16_bf16 v[48:63], v[228:231], v[148:151], v[48:63]
buffer_load_dwordx4 a[0:3], v2, s[8:11], s12 offen offset:0 sc1
v_exp_f32 v130, v130
v_exp_f32 v131, v131
v_cvt_pk_bf16_f32 v144, v128, v129
v_cvt_pk_bf16_f32 v145, v130, v131
v_mfma_f32_32x32x16_bf16 v[112:127], v[216:219], v[32:35], 0
buffer_load_dwordx4 a[112:115], v2, s[8:11], s13 offen offset:0 sc1
v_exp_f32 v132, v132
v_exp_f32 v133, v133
v_exp_f32 v134, v134
v_exp_f32 v135, v135
v_cvt_pk_bf16_f32 v146, v132, v133
v_cvt_pk_bf16_f32 v147, v134, v135
v_mfma_f32_32x32x16_bf16 v[112:127], v[220:223], v[36:39], v[112:127]
s_mov_b32 m0, s16
s_nop 0
buffer_load_dwordx4 v2, s[8:11], s15 offen offset:0 sc1 lds
v_exp_f32 v136, v136
v_exp_f32 v137, v137
v_exp_f32 v138, v138
v_exp_f32 v139, v139
v_cvt_pk_bf16_f32 v148, v136, v137
v_cvt_pk_bf16_f32 v149, v138, v139
v_mfma_f32_32x32x16_bf16 v[64:79], v[224:227], v[144:147], v[64:79]
buffer_load_dwordx4 a[4:7], v2, s[8:11], s12 offen offset:1024 sc1
v_exp_f32 v140, v140
v_exp_f32 v141, v141
v_exp_f32 v142, v142
v_exp_f32 v143, v143
v_cvt_pk_bf16_f32 v150, v140, v141
v_cvt_pk_bf16_f32 v151, v142, v143
v_exp_f32 v112, v112
v_exp_f32 v113, v113
v_mfma_f32_32x32x16_bf16 v[64:79], v[228:231], v[148:151], v[64:79]
buffer_load_dwordx4 a[116:119], v2, s[8:11], s13 offen offset:1024 sc1
v_exp_f32 v114, v114
v_exp_f32 v115, v115
v_cvt_pk_bf16_f32 v144, v112, v113
v_cvt_pk_bf16_f32 v145, v114, v115
v_mfma_f32_32x32x16_bf16 v[128:143], v[216:219], v[40:43], 0
buffer_load_dwordx4 v2, s[8:11], s15 offen offset:1024 sc1 lds
v_exp_f32 v116, v116
v_exp_f32 v117, v117
v_exp_f32 v118, v118
v_exp_f32 v119, v119
v_cvt_pk_bf16_f32 v146, v116, v117
v_cvt_pk_bf16_f32 v147, v118, v119
v_mfma_f32_32x32x16_bf16 v[128:143], v[220:223], v[44:47], v[128:143]
buffer_load_dwordx4 a[8:11], v2, s[8:11], s12 offen offset:2048 sc1
v_exp_f32 v120, v120
v_exp_f32 v121, v121
v_exp_f32 v122, v122
v_exp_f32 v123, v123
v_cvt_pk_bf16_f32 v148, v120, v121
v_cvt_pk_bf16_f32 v149, v122, v123
v_mfma_f32_32x32x16_bf16 v[80:95], v[224:227], v[144:147], v[80:95]
v_exp_f32 v124, v124
v_exp_f32 v125, v125
v_exp_f32 v126, v126
v_exp_f32 v127, v127
v_cvt_pk_bf16_f32 v150, v124, v125
v_cvt_pk_bf16_f32 v151, v126, v127
v_exp_f32 v128, v128
v_exp_f32 v129, v129
s_waitcnt vmcnt(21)
v_mfma_f32_32x32x16_bf16 v[80:95], v[228:231], v[148:151], v[80:95]
v_exp_f32 v130, v130
v_exp_f32 v131, v131
v_cvt_pk_bf16_f32 v144, v128, v129
v_cvt_pk_bf16_f32 v145, v130, v131
v_mfma_f32_32x32x16_bf16 v[112:127], v[152:155], v[16:19], 0
v_exp_f32 v132, v132
v_exp_f32 v133, v133
v_exp_f32 v134, v134
v_exp_f32 v135, v135
v_cvt_pk_bf16_f32 v146, v132, v133
v_cvt_pk_bf16_f32 v147, v134, v135
v_mfma_f32_32x32x16_bf16 v[112:127], v[156:159], v[20:23], v[112:127]
v_exp_f32 v136, v136
v_exp_f32 v137, v137
v_exp_f32 v138, v138
v_exp_f32 v139, v139
v_cvt_pk_bf16_f32 v148, v136, v137
v_cvt_pk_bf16_f32 v149, v138, v139
v_mfma_f32_32x32x16_bf16 v[96:111], v[224:227], v[144:147], v[96:111]
v_exp_f32 v140, v140
v_exp_f32 v141, v141
v_exp_f32 v142, v142
v_exp_f32 v143, v143
v_cvt_pk_bf16_f32 v150, v140, v141
v_cvt_pk_bf16_f32 v151, v142, v143
v_exp_f32 v112, v112
v_exp_f32 v113, v113
v_mfma_f32_32x32x16_bf16 v[96:111], v[228:231], v[148:151], v[96:111]
s_add_u32 s42, s40, 18432
buffer_load_dwordx4 v[216:219], v2, s[8:11], s42 offen offset:0 sc1
v_exp_f32 v114, v114
v_exp_f32 v115, v115
v_cvt_pk_bf16_f32 v144, v112, v113
v_cvt_pk_bf16_f32 v145, v114, v115
v_mfma_f32_32x32x16_bf16 v[128:143], v[152:155], v[24:27], 0
buffer_load_dwordx4 v[220:223], v2, s[8:11], s42 offen offset:1024 sc1
v_exp_f32 v116, v116
v_exp_f32 v117, v117
v_exp_f32 v118, v118
v_exp_f32 v119, v119
v_cvt_pk_bf16_f32 v146, v116, v117
v_cvt_pk_bf16_f32 v147, v118, v119
v_mfma_f32_32x32x16_bf16 v[128:143], v[156:159], v[28:31], v[128:143]
s_add_u32 s43, s41, 18432
buffer_load_dwordx4 v[224:227], v2, s[8:11], s43 offen offset:0 sc1
v_exp_f32 v120, v120
v_exp_f32 v121, v121
v_exp_f32 v122, v122
v_exp_f32 v123, v123
v_cvt_pk_bf16_f32 v148, v120, v121
v_cvt_pk_bf16_f32 v149, v122, v123
v_mfma_f32_32x32x16_bf16 v[48:63], v[160:163], v[144:147], v[48:63]
buffer_load_dwordx4 v[228:231], v2, s[8:11], s43 offen offset:1024 sc1
v_exp_f32 v124, v124
v_exp_f32 v125, v125
v_exp_f32 v126, v126
v_exp_f32 v127, v127
v_cvt_pk_bf16_f32 v150, v124, v125
v_cvt_pk_bf16_f32 v151, v126, v127
v_exp_f32 v128, v128
v_exp_f32 v129, v129
v_mfma_f32_32x32x16_bf16 v[48:63], v[164:167], v[148:151], v[48:63]
buffer_load_dwordx4 a[120:123], v2, s[8:11], s13 offen offset:2048 sc1
v_exp_f32 v130, v130
v_exp_f32 v131, v131
v_cvt_pk_bf16_f32 v144, v128, v129
v_cvt_pk_bf16_f32 v145, v130, v131
v_mfma_f32_32x32x16_bf16 v[112:127], v[152:155], v[32:35], 0
buffer_load_dwordx4 v2, s[8:11], s15 offen offset:2048 sc1 lds
v_exp_f32 v132, v132
v_exp_f32 v133, v133
v_exp_f32 v134, v134
v_exp_f32 v135, v135
v_cvt_pk_bf16_f32 v146, v132, v133
v_cvt_pk_bf16_f32 v147, v134, v135
v_mfma_f32_32x32x16_bf16 v[112:127], v[156:159], v[36:39], v[112:127]
buffer_load_dwordx4 a[12:15], v2, s[8:11], s12 offen offset:3072 sc1
v_exp_f32 v136, v136
v_exp_f32 v137, v137
v_exp_f32 v138, v138
v_exp_f32 v139, v139
v_cvt_pk_bf16_f32 v148, v136, v137
v_cvt_pk_bf16_f32 v149, v138, v139
v_mfma_f32_32x32x16_bf16 v[64:79], v[160:163], v[144:147], v[64:79]
buffer_load_dwordx4 a[124:127], v2, s[8:11], s13 offen offset:3072 sc1
v_exp_f32 v140, v140
v_exp_f32 v141, v141
v_exp_f32 v142, v142
v_exp_f32 v143, v143
v_cvt_pk_bf16_f32 v150, v140, v141
v_cvt_pk_bf16_f32 v151, v142, v143
v_exp_f32 v112, v112
v_exp_f32 v113, v113
v_mfma_f32_32x32x16_bf16 v[64:79], v[164:167], v[148:151], v[64:79]
buffer_load_dwordx4 v2, s[8:11], s15 offen offset:3072 sc1 lds
v_exp_f32 v114, v114
v_exp_f32 v115, v115
v_cvt_pk_bf16_f32 v144, v112, v113
v_cvt_pk_bf16_f32 v145, v114, v115
v_mfma_f32_32x32x16_bf16 v[128:143], v[152:155], v[40:43], 0
s_add_u32 s12, s12, 4096
buffer_load_dwordx4 a[16:19], v2, s[8:11], s12 offen offset:0 sc1
v_exp_f32 v116, v116
v_exp_f32 v117, v117
v_exp_f32 v118, v118
v_exp_f32 v119, v119
v_cvt_pk_bf16_f32 v146, v116, v117
v_cvt_pk_bf16_f32 v147, v118, v119
v_mfma_f32_32x32x16_bf16 v[128:143], v[156:159], v[44:47], v[128:143]
s_add_u32 s13, s13, 4096
buffer_load_dwordx4 a[128:131], v2, s[8:11], s13 offen offset:0 sc1
v_exp_f32 v120, v120
v_exp_f32 v121, v121
v_exp_f32 v122, v122
v_exp_f32 v123, v123
v_cvt_pk_bf16_f32 v148, v120, v121
v_cvt_pk_bf16_f32 v149, v122, v123
v_mfma_f32_32x32x16_bf16 v[80:95], v[160:163], v[144:147], v[80:95]
v_exp_f32 v124, v124
v_exp_f32 v125, v125
v_exp_f32 v126, v126
v_exp_f32 v127, v127
v_cvt_pk_bf16_f32 v150, v124, v125
v_cvt_pk_bf16_f32 v151, v126, v127
v_exp_f32 v128, v128
v_exp_f32 v129, v129
s_waitcnt vmcnt(26)
v_mfma_f32_32x32x16_bf16 v[80:95], v[164:167], v[148:151], v[80:95]
v_exp_f32 v130, v130
v_exp_f32 v131, v131
v_cvt_pk_bf16_f32 v144, v128, v129
v_cvt_pk_bf16_f32 v145, v130, v131
v_mfma_f32_32x32x16_bf16 v[112:127], v[168:171], v[16:19], 0
v_exp_f32 v132, v132
v_exp_f32 v133, v133
v_exp_f32 v134, v134
v_exp_f32 v135, v135
v_cvt_pk_bf16_f32 v146, v132, v133
v_cvt_pk_bf16_f32 v147, v134, v135
v_mfma_f32_32x32x16_bf16 v[112:127], v[172:175], v[20:23], v[112:127]
v_exp_f32 v136, v136
v_exp_f32 v137, v137
v_exp_f32 v138, v138
v_exp_f32 v139, v139
v_cvt_pk_bf16_f32 v148, v136, v137
v_cvt_pk_bf16_f32 v149, v138, v139
v_mfma_f32_32x32x16_bf16 v[96:111], v[160:163], v[144:147], v[96:111]
v_exp_f32 v140, v140
v_exp_f32 v141, v141
v_exp_f32 v142, v142
v_exp_f32 v143, v143
v_cvt_pk_bf16_f32 v150, v140, v141
v_cvt_pk_bf16_f32 v151, v142, v143
v_exp_f32 v112, v112
v_exp_f32 v113, v113
v_mfma_f32_32x32x16_bf16 v[96:111], v[164:167], v[148:151], v[96:111]
s_add_u32 s42, s40, 20480
buffer_load_dwordx4 v[152:155], v2, s[8:11], s42 offen offset:0 sc1
v_exp_f32 v114, v114
v_exp_f32 v115, v115
v_cvt_pk_bf16_f32 v144, v112, v113
v_cvt_pk_bf16_f32 v145, v114, v115
v_mfma_f32_32x32x16_bf16 v[128:143], v[168:171], v[24:27], 0
buffer_load_dwordx4 v[156:159], v2, s[8:11], s42 offen offset:1024 sc1
v_exp_f32 v116, v116
v_exp_f32 v117, v117
v_exp_f32 v118, v118
v_exp_f32 v119, v119
v_cvt_pk_bf16_f32 v146, v116, v117
v_cvt_pk_bf16_f32 v147, v118, v119
v_mfma_f32_32x32x16_bf16 v[128:143], v[172:175], v[28:31], v[128:143]
s_add_u32 s43, s41, 20480
buffer_load_dwordx4 v[160:163], v2, s[8:11], s43 offen offset:0 sc1
v_exp_f32 v120, v120
v_exp_f32 v121, v121
v_exp_f32 v122, v122
v_exp_f32 v123, v123
v_cvt_pk_bf16_f32 v148, v120, v121
v_cvt_pk_bf16_f32 v149, v122, v123
v_mfma_f32_32x32x16_bf16 v[48:63], v[176:179], v[144:147], v[48:63]
buffer_load_dwordx4 v[164:167], v2, s[8:11], s43 offen offset:1024 sc1
v_exp_f32 v124, v124
v_exp_f32 v125, v125
v_exp_f32 v126, v126
v_exp_f32 v127, v127
v_cvt_pk_bf16_f32 v150, v124, v125
v_cvt_pk_bf16_f32 v151, v126, v127
v_exp_f32 v128, v128
v_exp_f32 v129, v129
v_mfma_f32_32x32x16_bf16 v[48:63], v[180:183], v[148:151], v[48:63]
s_add_u32 s15, s15, 4096
s_add_u32 s16, s16, 4096
s_mov_b32 m0, s16
s_nop 0
buffer_load_dwordx4 v2, s[8:11], s15 offen offset:0 sc1 lds
v_exp_f32 v130, v130
v_exp_f32 v131, v131
v_cvt_pk_bf16_f32 v144, v128, v129
v_cvt_pk_bf16_f32 v145, v130, v131
v_mfma_f32_32x32x16_bf16 v[112:127], v[168:171], v[32:35], 0
buffer_load_dwordx4 a[20:23], v2, s[8:11], s12 offen offset:1024 sc1
v_exp_f32 v132, v132
v_exp_f32 v133, v133
v_exp_f32 v134, v134
v_exp_f32 v135, v135
v_cvt_pk_bf16_f32 v146, v132, v133
v_cvt_pk_bf16_f32 v147, v134, v135
v_mfma_f32_32x32x16_bf16 v[112:127], v[172:175], v[36:39], v[112:127]
buffer_load_dwordx4 a[132:135], v2, s[8:11], s13 offen offset:1024 sc1
v_exp_f32 v136, v136
v_exp_f32 v137, v137
v_exp_f32 v138, v138
v_exp_f32 v139, v139
v_cvt_pk_bf16_f32 v148, v136, v137
v_cvt_pk_bf16_f32 v149, v138, v139
v_mfma_f32_32x32x16_bf16 v[64:79], v[176:179], v[144:147], v[64:79]
buffer_load_dwordx4 v2, s[8:11], s15 offen offset:1024 sc1 lds
v_exp_f32 v140, v140
v_exp_f32 v141, v141
v_exp_f32 v142, v142
v_exp_f32 v143, v143
v_cvt_pk_bf16_f32 v150, v140, v141
v_cvt_pk_bf16_f32 v151, v142, v143
v_exp_f32 v112, v112
v_exp_f32 v113, v113
v_mfma_f32_32x32x16_bf16 v[64:79], v[180:183], v[148:151], v[64:79]
buffer_load_dwordx4 a[24:27], v2, s[8:11], s12 offen offset:2048 sc1
v_exp_f32 v114, v114
v_exp_f32 v115, v115
v_cvt_pk_bf16_f32 v144, v112, v113
v_cvt_pk_bf16_f32 v145, v114, v115
v_mfma_f32_32x32x16_bf16 v[128:143], v[168:171], v[40:43], 0
buffer_load_dwordx4 a[136:139], v2, s[8:11], s13 offen offset:2048 sc1
v_exp_f32 v116, v116
v_exp_f32 v117, v117
v_exp_f32 v118, v118
v_exp_f32 v119, v119
v_cvt_pk_bf16_f32 v146, v116, v117
v_cvt_pk_bf16_f32 v147, v118, v119
v_mfma_f32_32x32x16_bf16 v[128:143], v[172:175], v[44:47], v[128:143]
buffer_load_dwordx4 v2, s[8:11], s15 offen offset:2048 sc1 lds
v_exp_f32 v120, v120
v_exp_f32 v121, v121
v_exp_f32 v122, v122
v_exp_f32 v123, v123
v_cvt_pk_bf16_f32 v148, v120, v121
v_cvt_pk_bf16_f32 v149, v122, v123
v_mfma_f32_32x32x16_bf16 v[80:95], v[176:179], v[144:147], v[80:95]
v_exp_f32 v124, v124
v_exp_f32 v125, v125
v_exp_f32 v126, v126
v_exp_f32 v127, v127
v_cvt_pk_bf16_f32 v150, v124, v125
v_cvt_pk_bf16_f32 v151, v126, v127
v_exp_f32 v128, v128
v_exp_f32 v129, v129
s_waitcnt vmcnt(33)
v_mfma_f32_32x32x16_bf16 v[80:95], v[180:183], v[148:151], v[80:95]
v_exp_f32 v130, v130
v_exp_f32 v131, v131
v_cvt_pk_bf16_f32 v144, v128, v129
v_cvt_pk_bf16_f32 v145, v130, v131
v_mfma_f32_32x32x16_bf16 v[112:127], v[184:187], v[16:19], 0
v_exp_f32 v132, v132
v_exp_f32 v133, v133
v_exp_f32 v134, v134
v_exp_f32 v135, v135
v_cvt_pk_bf16_f32 v146, v132, v133
v_cvt_pk_bf16_f32 v147, v134, v135
v_mfma_f32_32x32x16_bf16 v[112:127], v[188:191], v[20:23], v[112:127]
v_exp_f32 v136, v136
v_exp_f32 v137, v137
v_exp_f32 v138, v138
v_exp_f32 v139, v139
v_cvt_pk_bf16_f32 v148, v136, v137
v_cvt_pk_bf16_f32 v149, v138, v139
v_mfma_f32_32x32x16_bf16 v[96:111], v[176:179], v[144:147], v[96:111]
v_exp_f32 v140, v140
v_exp_f32 v141, v141
v_exp_f32 v142, v142
v_exp_f32 v143, v143
v_cvt_pk_bf16_f32 v150, v140, v141
v_cvt_pk_bf16_f32 v151, v142, v143
v_exp_f32 v112, v112
v_exp_f32 v113, v113
v_mfma_f32_32x32x16_bf16 v[96:111], v[180:183], v[148:151], v[96:111]
s_add_u32 s42, s40, 22528
buffer_load_dwordx4 v[168:171], v2, s[8:11], s42 offen offset:0 sc1
v_exp_f32 v114, v114
v_exp_f32 v115, v115
v_cvt_pk_bf16_f32 v144, v112, v113
v_cvt_pk_bf16_f32 v145, v114, v115
v_mfma_f32_32x32x16_bf16 v[128:143], v[184:187], v[24:27], 0
buffer_load_dwordx4 v[172:175], v2, s[8:11], s42 offen offset:1024 sc1
v_exp_f32 v116, v116
v_exp_f32 v117, v117
v_exp_f32 v118, v118
v_exp_f32 v119, v119
v_cvt_pk_bf16_f32 v146, v116, v117
v_cvt_pk_bf16_f32 v147, v118, v119
v_mfma_f32_32x32x16_bf16 v[128:143], v[188:191], v[28:31], v[128:143]
s_add_u32 s43, s41, 22528
buffer_load_dwordx4 v[176:179], v2, s[8:11], s43 offen offset:0 sc1
v_exp_f32 v120, v120
v_exp_f32 v121, v121
v_exp_f32 v122, v122
v_exp_f32 v123, v123
v_cvt_pk_bf16_f32 v148, v120, v121
v_cvt_pk_bf16_f32 v149, v122, v123
v_mfma_f32_32x32x16_bf16 v[48:63], v[192:195], v[144:147], v[48:63]
buffer_load_dwordx4 v[180:183], v2, s[8:11], s43 offen offset:1024 sc1
v_exp_f32 v124, v124
v_exp_f32 v125, v125
v_exp_f32 v126, v126
v_exp_f32 v127, v127
v_cvt_pk_bf16_f32 v150, v124, v125
v_cvt_pk_bf16_f32 v151, v126, v127
v_exp_f32 v128, v128
v_exp_f32 v129, v129
v_mfma_f32_32x32x16_bf16 v[48:63], v[196:199], v[148:151], v[48:63]
buffer_load_dwordx4 a[28:31], v2, s[8:11], s12 offen offset:3072 sc1
v_exp_f32 v130, v130
v_exp_f32 v131, v131
v_cvt_pk_bf16_f32 v144, v128, v129
v_cvt_pk_bf16_f32 v145, v130, v131
v_mfma_f32_32x32x16_bf16 v[112:127], v[184:187], v[32:35], 0
buffer_load_dwordx4 a[140:143], v2, s[8:11], s13 offen offset:3072 sc1
v_exp_f32 v132, v132
v_exp_f32 v133, v133
v_exp_f32 v134, v134
v_exp_f32 v135, v135
v_cvt_pk_bf16_f32 v146, v132, v133
v_cvt_pk_bf16_f32 v147, v134, v135
v_mfma_f32_32x32x16_bf16 v[112:127], v[188:191], v[36:39], v[112:127]
s_add_u32 s15, s15, 24576
s_add_u32 s16, s16, 24576
s_mov_b32 m0, s16
s_nop 0
buffer_load_dwordx4 v2, s[8:11], s15 offen offset:0 sc1 lds
v_exp_f32 v136, v136
v_exp_f32 v137, v137
v_exp_f32 v138, v138
v_exp_f32 v139, v139
v_cvt_pk_bf16_f32 v148, v136, v137
v_cvt_pk_bf16_f32 v149, v138, v139
v_mfma_f32_32x32x16_bf16 v[64:79], v[192:195], v[144:147], v[64:79]
s_add_u32 s12, s12, 4096
buffer_load_dwordx4 a[32:35], v2, s[8:11], s12 offen offset:0 sc1
v_exp_f32 v140, v140
v_exp_f32 v141, v141
v_exp_f32 v142, v142
v_exp_f32 v143, v143
v_cvt_pk_bf16_f32 v150, v140, v141
v_cvt_pk_bf16_f32 v151, v142, v143
v_exp_f32 v112, v112
v_exp_f32 v113, v113
v_mfma_f32_32x32x16_bf16 v[64:79], v[196:199], v[148:151], v[64:79]
s_add_u32 s13, s13, 4096
buffer_load_dwordx4 a[144:147], v2, s[8:11], s13 offen offset:0 sc1
v_exp_f32 v114, v114
v_exp_f32 v115, v115
v_cvt_pk_bf16_f32 v144, v112, v113
v_cvt_pk_bf16_f32 v145, v114, v115
v_mfma_f32_32x32x16_bf16 v[128:143], v[184:187], v[40:43], 0
buffer_load_dwordx4 v2, s[8:11], s15 offen offset:1024 sc1 lds
v_exp_f32 v116, v116
v_exp_f32 v117, v117
v_exp_f32 v118, v118
v_exp_f32 v119, v119
v_cvt_pk_bf16_f32 v146, v116, v117
v_cvt_pk_bf16_f32 v147, v118, v119
v_mfma_f32_32x32x16_bf16 v[128:143], v[188:191], v[44:47], v[128:143]
buffer_load_dwordx4 a[36:39], v2, s[8:11], s12 offen offset:1024 sc1
v_exp_f32 v120, v120
v_exp_f32 v121, v121
v_exp_f32 v122, v122
v_exp_f32 v123, v123
v_cvt_pk_bf16_f32 v148, v120, v121
v_cvt_pk_bf16_f32 v149, v122, v123
v_mfma_f32_32x32x16_bf16 v[80:95], v[192:195], v[144:147], v[80:95]
v_exp_f32 v124, v124
v_exp_f32 v125, v125
v_exp_f32 v126, v126
v_exp_f32 v127, v127
v_cvt_pk_bf16_f32 v150, v124, v125
v_cvt_pk_bf16_f32 v151, v126, v127
v_exp_f32 v128, v128
v_exp_f32 v129, v129
s_waitcnt vmcnt(40)
v_mfma_f32_32x32x16_bf16 v[80:95], v[196:199], v[148:151], v[80:95]
v_exp_f32 v130, v130
v_exp_f32 v131, v131
v_cvt_pk_bf16_f32 v144, v128, v129
v_cvt_pk_bf16_f32 v145, v130, v131
v_mfma_f32_32x32x16_bf16 v[112:127], v[200:203], v[16:19], 0
v_exp_f32 v132, v132
v_exp_f32 v133, v133
v_exp_f32 v134, v134
v_exp_f32 v135, v135
v_cvt_pk_bf16_f32 v146, v132, v133
v_cvt_pk_bf16_f32 v147, v134, v135
v_mfma_f32_32x32x16_bf16 v[112:127], v[204:207], v[20:23], v[112:127]
v_exp_f32 v136, v136
v_exp_f32 v137, v137
v_exp_f32 v138, v138
v_exp_f32 v139, v139
v_cvt_pk_bf16_f32 v148, v136, v137
v_cvt_pk_bf16_f32 v149, v138, v139
v_mfma_f32_32x32x16_bf16 v[96:111], v[192:195], v[144:147], v[96:111]
v_exp_f32 v140, v140
v_exp_f32 v141, v141
v_exp_f32 v142, v142
v_exp_f32 v143, v143
v_cvt_pk_bf16_f32 v150, v140, v141
v_cvt_pk_bf16_f32 v151, v142, v143
v_exp_f32 v112, v112
v_exp_f32 v113, v113
v_mfma_f32_32x32x16_bf16 v[96:111], v[196:199], v[148:151], v[96:111]
s_add_u32 s42, s40, 24576
buffer_load_dwordx4 v[184:187], v2, s[8:11], s42 offen offset:0 sc1
v_exp_f32 v114, v114
v_exp_f32 v115, v115
v_cvt_pk_bf16_f32 v144, v112, v113
v_cvt_pk_bf16_f32 v145, v114, v115
v_mfma_f32_32x32x16_bf16 v[128:143], v[200:203], v[24:27], 0
buffer_load_dwordx4 v[188:191], v2, s[8:11], s42 offen offset:1024 sc1
v_exp_f32 v116, v116
v_exp_f32 v117, v117
v_exp_f32 v118, v118
v_exp_f32 v119, v119
v_cvt_pk_bf16_f32 v146, v116, v117
v_cvt_pk_bf16_f32 v147, v118, v119
v_mfma_f32_32x32x16_bf16 v[128:143], v[204:207], v[28:31], v[128:143]
s_add_u32 s43, s41, 24576
buffer_load_dwordx4 v[192:195], v2, s[8:11], s43 offen offset:0 sc1
v_exp_f32 v120, v120
v_exp_f32 v121, v121
v_exp_f32 v122, v122
v_exp_f32 v123, v123
v_cvt_pk_bf16_f32 v148, v120, v121
v_cvt_pk_bf16_f32 v149, v122, v123
v_mfma_f32_32x32x16_bf16 v[48:63], v[208:211], v[144:147], v[48:63]
buffer_load_dwordx4 v[196:199], v2, s[8:11], s43 offen offset:1024 sc1
v_exp_f32 v124, v124
v_exp_f32 v125, v125
v_exp_f32 v126, v126
v_exp_f32 v127, v127
v_cvt_pk_bf16_f32 v150, v124, v125
v_cvt_pk_bf16_f32 v151, v126, v127
v_exp_f32 v128, v128
v_exp_f32 v129, v129
v_mfma_f32_32x32x16_bf16 v[48:63], v[212:215], v[148:151], v[48:63]
buffer_load_dwordx4 a[148:151], v2, s[8:11], s13 offen offset:1024 sc1
v_exp_f32 v130, v130
v_exp_f32 v131, v131
v_cvt_pk_bf16_f32 v144, v128, v129
v_cvt_pk_bf16_f32 v145, v130, v131
v_mfma_f32_32x32x16_bf16 v[112:127], v[200:203], v[32:35], 0
buffer_load_dwordx4 v2, s[8:11], s15 offen offset:2048 sc1 lds
v_exp_f32 v132, v132
v_exp_f32 v133, v133
v_exp_f32 v134, v134
v_exp_f32 v135, v135
v_cvt_pk_bf16_f32 v146, v132, v133
v_cvt_pk_bf16_f32 v147, v134, v135
v_mfma_f32_32x32x16_bf16 v[112:127], v[204:207], v[36:39], v[112:127]
buffer_load_dwordx4 a[40:43], v2, s[8:11], s12 offen offset:2048 sc1
v_exp_f32 v136, v136
v_exp_f32 v137, v137
v_exp_f32 v138, v138
v_exp_f32 v139, v139
v_cvt_pk_bf16_f32 v148, v136, v137
v_cvt_pk_bf16_f32 v149, v138, v139
v_mfma_f32_32x32x16_bf16 v[64:79], v[208:211], v[144:147], v[64:79]
buffer_load_dwordx4 a[152:155], v2, s[8:11], s13 offen offset:2048 sc1
v_exp_f32 v140, v140
v_exp_f32 v141, v141
v_exp_f32 v142, v142
v_exp_f32 v143, v143
v_cvt_pk_bf16_f32 v150, v140, v141
v_cvt_pk_bf16_f32 v151, v142, v143
v_exp_f32 v112, v112
v_exp_f32 v113, v113
v_mfma_f32_32x32x16_bf16 v[64:79], v[212:215], v[148:151], v[64:79]
buffer_load_dwordx4 v2, s[8:11], s15 offen offset:3072 sc1 lds
v_exp_f32 v114, v114
v_exp_f32 v115, v115
v_cvt_pk_bf16_f32 v144, v112, v113
v_cvt_pk_bf16_f32 v145, v114, v115
v_mfma_f32_32x32x16_bf16 v[128:143], v[200:203], v[40:43], 0
buffer_load_dwordx4 a[44:47], v2, s[8:11], s12 offen offset:3072 sc1
v_exp_f32 v116, v116
v_exp_f32 v117, v117
v_exp_f32 v118, v118
v_exp_f32 v119, v119
v_cvt_pk_bf16_f32 v146, v116, v117
v_cvt_pk_bf16_f32 v147, v118, v119
v_mfma_f32_32x32x16_bf16 v[128:143], v[204:207], v[44:47], v[128:143]
buffer_load_dwordx4 a[156:159], v2, s[8:11], s13 offen offset:3072 sc1
v_exp_f32 v120, v120
v_exp_f32 v121, v121
v_exp_f32 v122, v122
v_exp_f32 v123, v123
v_cvt_pk_bf16_f32 v148, v120, v121
v_cvt_pk_bf16_f32 v149, v122, v123
v_mfma_f32_32x32x16_bf16 v[80:95], v[208:211], v[144:147], v[80:95]
v_exp_f32 v124, v124
v_exp_f32 v125, v125
v_exp_f32 v126, v126
v_exp_f32 v127, v127
v_cvt_pk_bf16_f32 v150, v124, v125
v_cvt_pk_bf16_f32 v151, v126, v127
v_exp_f32 v128, v128
v_exp_f32 v129, v129
s_waitcnt vmcnt(40)
v_mfma_f32_32x32x16_bf16 v[80:95], v[212:215], v[148:151], v[80:95]
v_exp_f32 v130, v130
v_exp_f32 v131, v131
v_cvt_pk_bf16_f32 v144, v128, v129
v_cvt_pk_bf16_f32 v145, v130, v131
v_mfma_f32_32x32x16_bf16 v[112:127], v[216:219], v[16:19], 0
v_exp_f32 v132, v132
v_exp_f32 v133, v133
v_exp_f32 v134, v134
v_exp_f32 v135, v135
v_cvt_pk_bf16_f32 v146, v132, v133
v_cvt_pk_bf16_f32 v147, v134, v135
v_mfma_f32_32x32x16_bf16 v[112:127], v[220:223], v[20:23], v[112:127]
v_exp_f32 v136, v136
v_exp_f32 v137, v137
v_exp_f32 v138, v138
v_exp_f32 v139, v139
v_cvt_pk_bf16_f32 v148, v136, v137
v_cvt_pk_bf16_f32 v149, v138, v139
v_mfma_f32_32x32x16_bf16 v[96:111], v[208:211], v[144:147], v[96:111]
v_exp_f32 v140, v140
v_exp_f32 v141, v141
v_exp_f32 v142, v142
v_exp_f32 v143, v143
v_cvt_pk_bf16_f32 v150, v140, v141
v_cvt_pk_bf16_f32 v151, v142, v143
v_exp_f32 v112, v112
v_exp_f32 v113, v113
v_mfma_f32_32x32x16_bf16 v[96:111], v[212:215], v[148:151], v[96:111]
s_add_u32 s42, s40, 26624
buffer_load_dwordx4 v[200:203], v2, s[8:11], s42 offen offset:0 sc1
v_exp_f32 v114, v114
v_exp_f32 v115, v115
v_cvt_pk_bf16_f32 v144, v112, v113
v_cvt_pk_bf16_f32 v145, v114, v115
v_mfma_f32_32x32x16_bf16 v[128:143], v[216:219], v[24:27], 0
buffer_load_dwordx4 v[204:207], v2, s[8:11], s42 offen offset:1024 sc1
v_exp_f32 v116, v116
v_exp_f32 v117, v117
v_exp_f32 v118, v118
v_exp_f32 v119, v119
v_cvt_pk_bf16_f32 v146, v116, v117
v_cvt_pk_bf16_f32 v147, v118, v119
v_mfma_f32_32x32x16_bf16 v[128:143], v[220:223], v[28:31], v[128:143]
s_add_u32 s43, s41, 26624
buffer_load_dwordx4 v[208:211], v2, s[8:11], s43 offen offset:0 sc1
v_exp_f32 v120, v120
v_exp_f32 v121, v121
v_exp_f32 v122, v122
v_exp_f32 v123, v123
v_cvt_pk_bf16_f32 v148, v120, v121
v_cvt_pk_bf16_f32 v149, v122, v123
v_mfma_f32_32x32x16_bf16 v[48:63], v[224:227], v[144:147], v[48:63]
buffer_load_dwordx4 v[212:215], v2, s[8:11], s43 offen offset:1024 sc1
v_exp_f32 v124, v124
v_exp_f32 v125, v125
v_exp_f32 v126, v126
v_exp_f32 v127, v127
v_cvt_pk_bf16_f32 v150, v124, v125
v_cvt_pk_bf16_f32 v151, v126, v127
v_exp_f32 v128, v128
v_exp_f32 v129, v129
v_mfma_f32_32x32x16_bf16 v[48:63], v[228:231], v[148:151], v[48:63]
s_add_u32 s15, s15, 4096
s_add_u32 s16, s16, 4096
s_mov_b32 m0, s16
s_nop 0
buffer_load_dwordx4 v2, s[8:11], s15 offen offset:0 sc1 lds
v_exp_f32 v130, v130
v_exp_f32 v131, v131
v_cvt_pk_bf16_f32 v144, v128, v129
v_cvt_pk_bf16_f32 v145, v130, v131
v_mfma_f32_32x32x16_bf16 v[112:127], v[216:219], v[32:35], 0
s_add_u32 s12, s12, 4096
buffer_load_dwordx4 a[48:51], v2, s[8:11], s12 offen offset:0 sc1
v_exp_f32 v132, v132
v_exp_f32 v133, v133
v_exp_f32 v134, v134
v_exp_f32 v135, v135
v_cvt_pk_bf16_f32 v146, v132, v133
v_cvt_pk_bf16_f32 v147, v134, v135
v_mfma_f32_32x32x16_bf16 v[112:127], v[220:223], v[36:39], v[112:127]
s_add_u32 s13, s13, 4096
buffer_load_dwordx4 a[160:163], v2, s[8:11], s13 offen offset:0 sc1
v_exp_f32 v136, v136
v_exp_f32 v137, v137
v_exp_f32 v138, v138
v_exp_f32 v139, v139
v_cvt_pk_bf16_f32 v148, v136, v137
v_cvt_pk_bf16_f32 v149, v138, v139
v_mfma_f32_32x32x16_bf16 v[64:79], v[224:227], v[144:147], v[64:79]
buffer_load_dwordx4 v2, s[8:11], s15 offen offset:1024 sc1 lds
v_exp_f32 v140, v140
v_exp_f32 v141, v141
v_exp_f32 v142, v142
v_exp_f32 v143, v143
v_cvt_pk_bf16_f32 v150, v140, v141
v_cvt_pk_bf16_f32 v151, v142, v143
v_exp_f32 v112, v112
v_exp_f32 v113, v113
v_mfma_f32_32x32x16_bf16 v[64:79], v[228:231], v[148:151], v[64:79]
buffer_load_dwordx4 a[52:55], v2, s[8:11], s12 offen offset:1024 sc1
v_exp_f32 v114, v114
v_exp_f32 v115, v115
v_cvt_pk_bf16_f32 v144, v112, v113
v_cvt_pk_bf16_f32 v145, v114, v115
v_mfma_f32_32x32x16_bf16 v[128:143], v[216:219], v[40:43], 0
buffer_load_dwordx4 a[164:167], v2, s[8:11], s13 offen offset:1024 sc1
v_exp_f32 v116, v116
v_exp_f32 v117, v117
v_exp_f32 v118, v118
v_exp_f32 v119, v119
v_cvt_pk_bf16_f32 v146, v116, v117
v_cvt_pk_bf16_f32 v147, v118, v119
v_mfma_f32_32x32x16_bf16 v[128:143], v[220:223], v[44:47], v[128:143]
buffer_load_dwordx4 v2, s[8:11], s15 offen offset:2048 sc1 lds
v_exp_f32 v120, v120
v_exp_f32 v121, v121
v_exp_f32 v122, v122
v_exp_f32 v123, v123
v_cvt_pk_bf16_f32 v148, v120, v121
v_cvt_pk_bf16_f32 v149, v122, v123
v_mfma_f32_32x32x16_bf16 v[80:95], v[224:227], v[144:147], v[80:95]
v_exp_f32 v124, v124
v_exp_f32 v125, v125
v_exp_f32 v126, v126
v_exp_f32 v127, v127
v_cvt_pk_bf16_f32 v150, v124, v125
v_cvt_pk_bf16_f32 v151, v126, v127
v_exp_f32 v128, v128
v_exp_f32 v129, v129
s_waitcnt vmcnt(40)
v_mfma_f32_32x32x16_bf16 v[80:95], v[228:231], v[148:151], v[80:95]
v_exp_f32 v130, v130
v_exp_f32 v131, v131
v_cvt_pk_bf16_f32 v144, v128, v129
v_cvt_pk_bf16_f32 v145, v130, v131
v_mfma_f32_32x32x16_bf16 v[112:127], v[152:155], v[16:19], 0
v_exp_f32 v132, v132
v_exp_f32 v133, v133
v_exp_f32 v134, v134
v_exp_f32 v135, v135
v_cvt_pk_bf16_f32 v146, v132, v133
v_cvt_pk_bf16_f32 v147, v134, v135
v_mfma_f32_32x32x16_bf16 v[112:127], v[156:159], v[20:23], v[112:127]
v_exp_f32 v136, v136
v_exp_f32 v137, v137
v_exp_f32 v138, v138
v_exp_f32 v139, v139
v_cvt_pk_bf16_f32 v148, v136, v137
v_cvt_pk_bf16_f32 v149, v138, v139
v_mfma_f32_32x32x16_bf16 v[96:111], v[224:227], v[144:147], v[96:111]
v_exp_f32 v140, v140
v_exp_f32 v141, v141
v_exp_f32 v142, v142
v_exp_f32 v143, v143
v_cvt_pk_bf16_f32 v150, v140, v141
v_cvt_pk_bf16_f32 v151, v142, v143
v_exp_f32 v112, v112
v_exp_f32 v113, v113
v_mfma_f32_32x32x16_bf16 v[96:111], v[228:231], v[148:151], v[96:111]
s_add_u32 s42, s40, 28672
buffer_load_dwordx4 v[216:219], v2, s[8:11], s42 offen offset:0 sc1
v_exp_f32 v114, v114
v_exp_f32 v115, v115
v_cvt_pk_bf16_f32 v144, v112, v113
v_cvt_pk_bf16_f32 v145, v114, v115
v_mfma_f32_32x32x16_bf16 v[128:143], v[152:155], v[24:27], 0
buffer_load_dwordx4 v[220:223], v2, s[8:11], s42 offen offset:1024 sc1
v_exp_f32 v116, v116
v_exp_f32 v117, v117
v_exp_f32 v118, v118
v_exp_f32 v119, v119
v_cvt_pk_bf16_f32 v146, v116, v117
v_cvt_pk_bf16_f32 v147, v118, v119
v_mfma_f32_32x32x16_bf16 v[128:143], v[156:159], v[28:31], v[128:143]
s_add_u32 s43, s41, 28672
buffer_load_dwordx4 v[224:227], v2, s[8:11], s43 offen offset:0 sc1
v_exp_f32 v120, v120
v_exp_f32 v121, v121
v_exp_f32 v122, v122
v_exp_f32 v123, v123
v_cvt_pk_bf16_f32 v148, v120, v121
v_cvt_pk_bf16_f32 v149, v122, v123
v_mfma_f32_32x32x16_bf16 v[48:63], v[160:163], v[144:147], v[48:63]
buffer_load_dwordx4 v[228:231], v2, s[8:11], s43 offen offset:1024 sc1
v_exp_f32 v124, v124
v_exp_f32 v125, v125
v_exp_f32 v126, v126
v_exp_f32 v127, v127
v_cvt_pk_bf16_f32 v150, v124, v125
v_cvt_pk_bf16_f32 v151, v126, v127
v_exp_f32 v128, v128
v_exp_f32 v129, v129
v_mfma_f32_32x32x16_bf16 v[48:63], v[164:167], v[148:151], v[48:63]
buffer_load_dwordx4 a[56:59], v2, s[8:11], s12 offen offset:2048 sc1
v_exp_f32 v130, v130
v_exp_f32 v131, v131
v_cvt_pk_bf16_f32 v144, v128, v129
v_cvt_pk_bf16_f32 v145, v130, v131
v_mfma_f32_32x32x16_bf16 v[112:127], v[152:155], v[32:35], 0
buffer_load_dwordx4 a[168:171], v2, s[8:11], s13 offen offset:2048 sc1
v_exp_f32 v132, v132
v_exp_f32 v133, v133
v_exp_f32 v134, v134
v_exp_f32 v135, v135
v_cvt_pk_bf16_f32 v146, v132, v133
v_cvt_pk_bf16_f32 v147, v134, v135
v_mfma_f32_32x32x16_bf16 v[112:127], v[156:159], v[36:39], v[112:127]
s_add_u32 s15, s15, 24576
s_add_u32 s16, s16, 24576
s_mov_b32 m0, s16
s_nop 0
buffer_load_dwordx4 v2, s[8:11], s15 offen offset:0 sc1 lds
v_exp_f32 v136, v136
v_exp_f32 v137, v137
v_exp_f32 v138, v138
v_exp_f32 v139, v139
v_cvt_pk_bf16_f32 v148, v136, v137
v_cvt_pk_bf16_f32 v149, v138, v139
v_mfma_f32_32x32x16_bf16 v[64:79], v[160:163], v[144:147], v[64:79]
buffer_load_dwordx4 a[60:63], v2, s[8:11], s12 offen offset:3072 sc1
v_exp_f32 v140, v140
v_exp_f32 v141, v141
v_exp_f32 v142, v142
v_exp_f32 v143, v143
v_cvt_pk_bf16_f32 v150, v140, v141
v_cvt_pk_bf16_f32 v151, v142, v143
v_exp_f32 v112, v112
v_exp_f32 v113, v113
v_mfma_f32_32x32x16_bf16 v[64:79], v[164:167], v[148:151], v[64:79]
buffer_load_dwordx4 a[172:175], v2, s[8:11], s13 offen offset:3072 sc1
v_exp_f32 v114, v114
v_exp_f32 v115, v115
v_cvt_pk_bf16_f32 v144, v112, v113
v_cvt_pk_bf16_f32 v145, v114, v115
v_mfma_f32_32x32x16_bf16 v[128:143], v[152:155], v[40:43], 0
buffer_load_dwordx4 v2, s[8:11], s15 offen offset:1024 sc1 lds
v_exp_f32 v116, v116
v_exp_f32 v117, v117
v_exp_f32 v118, v118
v_exp_f32 v119, v119
v_cvt_pk_bf16_f32 v146, v116, v117
v_cvt_pk_bf16_f32 v147, v118, v119
v_mfma_f32_32x32x16_bf16 v[128:143], v[156:159], v[44:47], v[128:143]
s_add_u32 s12, s12, 4096
buffer_load_dwordx4 a[64:67], v2, s[8:11], s12 offen offset:0 sc1
v_exp_f32 v120, v120
v_exp_f32 v121, v121
v_exp_f32 v122, v122
v_exp_f32 v123, v123
v_cvt_pk_bf16_f32 v148, v120, v121
v_cvt_pk_bf16_f32 v149, v122, v123
v_mfma_f32_32x32x16_bf16 v[80:95], v[160:163], v[144:147], v[80:95]
v_exp_f32 v124, v124
v_exp_f32 v125, v125
v_exp_f32 v126, v126
v_exp_f32 v127, v127
v_cvt_pk_bf16_f32 v150, v124, v125
v_cvt_pk_bf16_f32 v151, v126, v127
v_exp_f32 v128, v128
v_exp_f32 v129, v129
s_waitcnt vmcnt(40)
v_mfma_f32_32x32x16_bf16 v[80:95], v[164:167], v[148:151], v[80:95]
v_exp_f32 v130, v130
v_exp_f32 v131, v131
v_cvt_pk_bf16_f32 v144, v128, v129
v_cvt_pk_bf16_f32 v145, v130, v131
v_mfma_f32_32x32x16_bf16 v[112:127], v[168:171], v[16:19], 0
v_exp_f32 v132, v132
v_exp_f32 v133, v133
v_exp_f32 v134, v134
v_exp_f32 v135, v135
v_cvt_pk_bf16_f32 v146, v132, v133
v_cvt_pk_bf16_f32 v147, v134, v135
v_mfma_f32_32x32x16_bf16 v[112:127], v[172:175], v[20:23], v[112:127]
v_exp_f32 v136, v136
v_exp_f32 v137, v137
v_exp_f32 v138, v138
v_exp_f32 v139, v139
v_cvt_pk_bf16_f32 v148, v136, v137
v_cvt_pk_bf16_f32 v149, v138, v139
v_mfma_f32_32x32x16_bf16 v[96:111], v[160:163], v[144:147], v[96:111]
v_exp_f32 v140, v140
v_exp_f32 v141, v141
v_exp_f32 v142, v142
v_exp_f32 v143, v143
v_cvt_pk_bf16_f32 v150, v140, v141
v_cvt_pk_bf16_f32 v151, v142, v143
v_exp_f32 v112, v112
v_exp_f32 v113, v113
v_mfma_f32_32x32x16_bf16 v[96:111], v[164:167], v[148:151], v[96:111]
s_add_u32 s42, s40, 30720
buffer_load_dwordx4 v[152:155], v2, s[8:11], s42 offen offset:0 sc1
v_exp_f32 v114, v114
v_exp_f32 v115, v115
v_cvt_pk_bf16_f32 v144, v112, v113
v_cvt_pk_bf16_f32 v145, v114, v115
v_mfma_f32_32x32x16_bf16 v[128:143], v[168:171], v[24:27], 0
buffer_load_dwordx4 v[156:159], v2, s[8:11], s42 offen offset:1024 sc1
v_exp_f32 v116, v116
v_exp_f32 v117, v117
v_exp_f32 v118, v118
v_exp_f32 v119, v119
v_cvt_pk_bf16_f32 v146, v116, v117
v_cvt_pk_bf16_f32 v147, v118, v119
v_mfma_f32_32x32x16_bf16 v[128:143], v[172:175], v[28:31], v[128:143]
s_add_u32 s43, s41, 30720
buffer_load_dwordx4 v[160:163], v2, s[8:11], s43 offen offset:0 sc1
v_exp_f32 v120, v120
v_exp_f32 v121, v121
v_exp_f32 v122, v122
v_exp_f32 v123, v123
v_cvt_pk_bf16_f32 v148, v120, v121
v_cvt_pk_bf16_f32 v149, v122, v123
v_mfma_f32_32x32x16_bf16 v[48:63], v[176:179], v[144:147], v[48:63]
buffer_load_dwordx4 v[164:167], v2, s[8:11], s43 offen offset:1024 sc1
v_exp_f32 v124, v124
v_exp_f32 v125, v125
v_exp_f32 v126, v126
v_exp_f32 v127, v127
v_cvt_pk_bf16_f32 v150, v124, v125
v_cvt_pk_bf16_f32 v151, v126, v127
v_exp_f32 v128, v128
v_exp_f32 v129, v129
v_mfma_f32_32x32x16_bf16 v[48:63], v[180:183], v[148:151], v[48:63]
s_add_u32 s13, s13, 4096
buffer_load_dwordx4 a[176:179], v2, s[8:11], s13 offen offset:0 sc1
v_exp_f32 v130, v130
v_exp_f32 v131, v131
v_cvt_pk_bf16_f32 v144, v128, v129
v_cvt_pk_bf16_f32 v145, v130, v131
v_mfma_f32_32x32x16_bf16 v[112:127], v[168:171], v[32:35], 0
buffer_load_dwordx4 v2, s[8:11], s15 offen offset:2048 sc1 lds
v_exp_f32 v132, v132
v_exp_f32 v133, v133
v_exp_f32 v134, v134
v_exp_f32 v135, v135
v_cvt_pk_bf16_f32 v146, v132, v133
v_cvt_pk_bf16_f32 v147, v134, v135
v_mfma_f32_32x32x16_bf16 v[112:127], v[172:175], v[36:39], v[112:127]
buffer_load_dwordx4 a[68:71], v2, s[8:11], s12 offen offset:1024 sc1
v_exp_f32 v136, v136
v_exp_f32 v137, v137
v_exp_f32 v138, v138
v_exp_f32 v139, v139
v_cvt_pk_bf16_f32 v148, v136, v137
v_cvt_pk_bf16_f32 v149, v138, v139
v_mfma_f32_32x32x16_bf16 v[64:79], v[176:179], v[144:147], v[64:79]
buffer_load_dwordx4 a[180:183], v2, s[8:11], s13 offen offset:1024 sc1
v_exp_f32 v140, v140
v_exp_f32 v141, v141
v_exp_f32 v142, v142
v_exp_f32 v143, v143
v_cvt_pk_bf16_f32 v150, v140, v141
v_cvt_pk_bf16_f32 v151, v142, v143
v_exp_f32 v112, v112
v_exp_f32 v113, v113
v_mfma_f32_32x32x16_bf16 v[64:79], v[180:183], v[148:151], v[64:79]
buffer_load_dwordx4 v2, s[8:11], s15 offen offset:3072 sc1 lds
v_exp_f32 v114, v114
v_exp_f32 v115, v115
v_cvt_pk_bf16_f32 v144, v112, v113
v_cvt_pk_bf16_f32 v145, v114, v115
v_mfma_f32_32x32x16_bf16 v[128:143], v[168:171], v[40:43], 0
buffer_load_dwordx4 a[72:75], v2, s[8:11], s12 offen offset:2048 sc1
v_exp_f32 v116, v116
v_exp_f32 v117, v117
v_exp_f32 v118, v118
v_exp_f32 v119, v119
v_cvt_pk_bf16_f32 v146, v116, v117
v_cvt_pk_bf16_f32 v147, v118, v119
v_mfma_f32_32x32x16_bf16 v[128:143], v[172:175], v[44:47], v[128:143]
buffer_load_dwordx4 a[184:187], v2, s[8:11], s13 offen offset:2048 sc1
v_exp_f32 v120, v120
v_exp_f32 v121, v121
v_exp_f32 v122, v122
v_exp_f32 v123, v123
v_cvt_pk_bf16_f32 v148, v120, v121
v_cvt_pk_bf16_f32 v149, v122, v123
v_mfma_f32_32x32x16_bf16 v[80:95], v[176:179], v[144:147], v[80:95]
v_exp_f32 v124, v124
v_exp_f32 v125, v125
v_exp_f32 v126, v126
v_exp_f32 v127, v127
v_cvt_pk_bf16_f32 v150, v124, v125
v_cvt_pk_bf16_f32 v151, v126, v127
v_exp_f32 v128, v128
v_exp_f32 v129, v129
s_waitcnt vmcnt(40)
v_mfma_f32_32x32x16_bf16 v[80:95], v[180:183], v[148:151], v[80:95]
v_exp_f32 v130, v130
v_exp_f32 v131, v131
v_cvt_pk_bf16_f32 v144, v128, v129
v_cvt_pk_bf16_f32 v145, v130, v131
v_mfma_f32_32x32x16_bf16 v[112:127], v[184:187], v[16:19], 0
v_exp_f32 v132, v132
v_exp_f32 v133, v133
v_exp_f32 v134, v134
v_exp_f32 v135, v135
v_cvt_pk_bf16_f32 v146, v132, v133
v_cvt_pk_bf16_f32 v147, v134, v135
v_mfma_f32_32x32x16_bf16 v[112:127], v[188:191], v[20:23], v[112:127]
v_exp_f32 v136, v136
v_exp_f32 v137, v137
v_exp_f32 v138, v138
v_exp_f32 v139, v139
v_cvt_pk_bf16_f32 v148, v136, v137
v_cvt_pk_bf16_f32 v149, v138, v139
v_mfma_f32_32x32x16_bf16 v[96:111], v[176:179], v[144:147], v[96:111]
v_exp_f32 v140, v140
v_exp_f32 v141, v141
v_exp_f32 v142, v142
v_exp_f32 v143, v143
v_cvt_pk_bf16_f32 v150, v140, v141
v_cvt_pk_bf16_f32 v151, v142, v143
v_exp_f32 v112, v112
v_exp_f32 v113, v113
v_mfma_f32_32x32x16_bf16 v[96:111], v[180:183], v[148:151], v[96:111]
s_add_u32 s15, s15, 4096
s_add_u32 s16, s16, 4096
s_mov_b32 m0, s16
s_nop 0
buffer_load_dwordx4 v2, s[8:11], s15 offen offset:0 sc1 lds
v_exp_f32 v114, v114
v_exp_f32 v115, v115
v_cvt_pk_bf16_f32 v144, v112, v113
v_cvt_pk_bf16_f32 v145, v114, v115
v_mfma_f32_32x32x16_bf16 v[128:143], v[184:187], v[24:27], 0
buffer_load_dwordx4 a[76:79], v2, s[8:11], s12 offen offset:3072 sc1
v_exp_f32 v116, v116
v_exp_f32 v117, v117
v_exp_f32 v118, v118
v_exp_f32 v119, v119
v_cvt_pk_bf16_f32 v146, v116, v117
v_cvt_pk_bf16_f32 v147, v118, v119
v_mfma_f32_32x32x16_bf16 v[128:143], v[188:191], v[28:31], v[128:143]
buffer_load_dwordx4 a[188:191], v2, s[8:11], s13 offen offset:3072 sc1
v_exp_f32 v120, v120
v_exp_f32 v121, v121
v_exp_f32 v122, v122
v_exp_f32 v123, v123
v_cvt_pk_bf16_f32 v148, v120, v121
v_cvt_pk_bf16_f32 v149, v122, v123
v_mfma_f32_32x32x16_bf16 v[48:63], v[192:195], v[144:147], v[48:63]
buffer_load_dwordx4 v2, s[8:11], s15 offen offset:1024 sc1 lds
v_exp_f32 v124, v124
v_exp_f32 v125, v125
v_exp_f32 v126, v126
v_exp_f32 v127, v127
v_cvt_pk_bf16_f32 v150, v124, v125
v_cvt_pk_bf16_f32 v151, v126, v127
v_exp_f32 v128, v128
v_exp_f32 v129, v129
v_mfma_f32_32x32x16_bf16 v[48:63], v[196:199], v[148:151], v[48:63]
s_add_u32 s12, s12, 4096
buffer_load_dwordx4 a[80:83], v2, s[8:11], s12 offen offset:0 sc1
v_exp_f32 v130, v130
v_exp_f32 v131, v131
v_cvt_pk_bf16_f32 v144, v128, v129
v_cvt_pk_bf16_f32 v145, v130, v131
v_mfma_f32_32x32x16_bf16 v[112:127], v[184:187], v[32:35], 0
s_add_u32 s13, s13, 4096
buffer_load_dwordx4 a[192:195], v2, s[8:11], s13 offen offset:0 sc1
v_exp_f32 v132, v132
v_exp_f32 v133, v133
v_exp_f32 v134, v134
v_exp_f32 v135, v135
v_cvt_pk_bf16_f32 v146, v132, v133
v_cvt_pk_bf16_f32 v147, v134, v135
v_mfma_f32_32x32x16_bf16 v[112:127], v[188:191], v[36:39], v[112:127]
buffer_load_dwordx4 v2, s[8:11], s15 offen offset:2048 sc1 lds
v_exp_f32 v136, v136
v_exp_f32 v137, v137
v_exp_f32 v138, v138
v_exp_f32 v139, v139
v_cvt_pk_bf16_f32 v148, v136, v137
v_cvt_pk_bf16_f32 v149, v138, v139
v_mfma_f32_32x32x16_bf16 v[64:79], v[192:195], v[144:147], v[64:79]
v_exp_f32 v140, v140
v_exp_f32 v141, v141
v_exp_f32 v142, v142
v_exp_f32 v143, v143
v_cvt_pk_bf16_f32 v150, v140, v141
v_cvt_pk_bf16_f32 v151, v142, v143
v_exp_f32 v112, v112
v_exp_f32 v113, v113
v_mfma_f32_32x32x16_bf16 v[64:79], v[196:199], v[148:151], v[64:79]
v_exp_f32 v114, v114
v_exp_f32 v115, v115
v_cvt_pk_bf16_f32 v144, v112, v113
v_cvt_pk_bf16_f32 v145, v114, v115
v_mfma_f32_32x32x16_bf16 v[128:143], v[184:187], v[40:43], 0
v_exp_f32 v116, v116
v_exp_f32 v117, v117
v_exp_f32 v118, v118
v_exp_f32 v119, v119
v_cvt_pk_bf16_f32 v146, v116, v117
v_cvt_pk_bf16_f32 v147, v118, v119
v_mfma_f32_32x32x16_bf16 v[128:143], v[188:191], v[44:47], v[128:143]
v_exp_f32 v120, v120
v_exp_f32 v121, v121
v_exp_f32 v122, v122
v_exp_f32 v123, v123
v_cvt_pk_bf16_f32 v148, v120, v121
v_cvt_pk_bf16_f32 v149, v122, v123
v_mfma_f32_32x32x16_bf16 v[80:95], v[192:195], v[144:147], v[80:95]
v_exp_f32 v124, v124
v_exp_f32 v125, v125
v_exp_f32 v126, v126
v_exp_f32 v127, v127
v_cvt_pk_bf16_f32 v150, v124, v125
v_cvt_pk_bf16_f32 v151, v126, v127
v_exp_f32 v128, v128
v_exp_f32 v129, v129
s_waitcnt vmcnt(36)
v_mfma_f32_32x32x16_bf16 v[80:95], v[196:199], v[148:151], v[80:95]
v_exp_f32 v130, v130
v_exp_f32 v131, v131
v_cvt_pk_bf16_f32 v144, v128, v129
v_cvt_pk_bf16_f32 v145, v130, v131
v_mfma_f32_32x32x16_bf16 v[112:127], v[200:203], v[16:19], 0
v_exp_f32 v132, v132
v_exp_f32 v133, v133
v_exp_f32 v134, v134
v_exp_f32 v135, v135
v_cvt_pk_bf16_f32 v146, v132, v133
v_cvt_pk_bf16_f32 v147, v134, v135
v_mfma_f32_32x32x16_bf16 v[112:127], v[204:207], v[20:23], v[112:127]
v_exp_f32 v136, v136
v_exp_f32 v137, v137
v_exp_f32 v138, v138
v_exp_f32 v139, v139
v_cvt_pk_bf16_f32 v148, v136, v137
v_cvt_pk_bf16_f32 v149, v138, v139
v_mfma_f32_32x32x16_bf16 v[96:111], v[192:195], v[144:147], v[96:111]
v_exp_f32 v140, v140
v_exp_f32 v141, v141
v_exp_f32 v142, v142
v_exp_f32 v143, v143
v_cvt_pk_bf16_f32 v150, v140, v141
v_cvt_pk_bf16_f32 v151, v142, v143
v_exp_f32 v112, v112
v_exp_f32 v113, v113
v_mfma_f32_32x32x16_bf16 v[96:111], v[196:199], v[148:151], v[96:111]
buffer_load_dwordx4 a[84:87], v2, s[8:11], s12 offen offset:1024 sc1
v_exp_f32 v114, v114
v_exp_f32 v115, v115
v_cvt_pk_bf16_f32 v144, v112, v113
v_cvt_pk_bf16_f32 v145, v114, v115
v_mfma_f32_32x32x16_bf16 v[128:143], v[200:203], v[24:27], 0
buffer_load_dwordx4 a[196:199], v2, s[8:11], s13 offen offset:1024 sc1
v_exp_f32 v116, v116
v_exp_f32 v117, v117
v_exp_f32 v118, v118
v_exp_f32 v119, v119
v_cvt_pk_bf16_f32 v146, v116, v117
v_cvt_pk_bf16_f32 v147, v118, v119
v_mfma_f32_32x32x16_bf16 v[128:143], v[204:207], v[28:31], v[128:143]
s_add_u32 s15, s15, 24576
s_add_u32 s16, s16, 24576
s_mov_b32 m0, s16
s_nop 0
buffer_load_dwordx4 v2, s[8:11], s15 offen offset:0 sc1 lds
v_exp_f32 v120, v120
v_exp_f32 v121, v121
v_exp_f32 v122, v122
v_exp_f32 v123, v123
v_cvt_pk_bf16_f32 v148, v120, v121
v_cvt_pk_bf16_f32 v149, v122, v123
v_mfma_f32_32x32x16_bf16 v[48:63], v[208:211], v[144:147], v[48:63]
buffer_load_dwordx4 a[88:91], v2, s[8:11], s12 offen offset:2048 sc1
v_exp_f32 v124, v124
v_exp_f32 v125, v125
v_exp_f32 v126, v126
v_exp_f32 v127, v127
v_cvt_pk_bf16_f32 v150, v124, v125
v_cvt_pk_bf16_f32 v151, v126, v127
v_exp_f32 v128, v128
v_exp_f32 v129, v129
v_mfma_f32_32x32x16_bf16 v[48:63], v[212:215], v[148:151], v[48:63]
buffer_load_dwordx4 a[200:203], v2, s[8:11], s13 offen offset:2048 sc1
v_exp_f32 v130, v130
v_exp_f32 v131, v131
v_cvt_pk_bf16_f32 v144, v128, v129
v_cvt_pk_bf16_f32 v145, v130, v131
v_mfma_f32_32x32x16_bf16 v[112:127], v[200:203], v[32:35], 0
buffer_load_dwordx4 v2, s[8:11], s15 offen offset:1024 sc1 lds
v_exp_f32 v132, v132
v_exp_f32 v133, v133
v_exp_f32 v134, v134
v_exp_f32 v135, v135
v_cvt_pk_bf16_f32 v146, v132, v133
v_cvt_pk_bf16_f32 v147, v134, v135
v_mfma_f32_32x32x16_bf16 v[112:127], v[204:207], v[36:39], v[112:127]
buffer_load_dwordx4 a[92:95], v2, s[8:11], s12 offen offset:3072 sc1
v_exp_f32 v136, v136
v_exp_f32 v137, v137
v_exp_f32 v138, v138
v_exp_f32 v139, v139
v_cvt_pk_bf16_f32 v148, v136, v137
v_cvt_pk_bf16_f32 v149, v138, v139
v_mfma_f32_32x32x16_bf16 v[64:79], v[208:211], v[144:147], v[64:79]
v_exp_f32 v140, v140
v_exp_f32 v141, v141
v_exp_f32 v142, v142
v_exp_f32 v143, v143
v_cvt_pk_bf16_f32 v150, v140, v141
v_cvt_pk_bf16_f32 v151, v142, v143
v_exp_f32 v112, v112
v_exp_f32 v113, v113
v_mfma_f32_32x32x16_bf16 v[64:79], v[212:215], v[148:151], v[64:79]
v_exp_f32 v114, v114
v_exp_f32 v115, v115
v_cvt_pk_bf16_f32 v144, v112, v113
v_cvt_pk_bf16_f32 v145, v114, v115
v_mfma_f32_32x32x16_bf16 v[128:143], v[200:203], v[40:43], 0
v_exp_f32 v116, v116
v_exp_f32 v117, v117
v_exp_f32 v118, v118
v_exp_f32 v119, v119
v_cvt_pk_bf16_f32 v146, v116, v117
v_cvt_pk_bf16_f32 v147, v118, v119
v_mfma_f32_32x32x16_bf16 v[128:143], v[204:207], v[44:47], v[128:143]
v_exp_f32 v120, v120
v_exp_f32 v121, v121
v_exp_f32 v122, v122
v_exp_f32 v123, v123
v_cvt_pk_bf16_f32 v148, v120, v121
v_cvt_pk_bf16_f32 v149, v122, v123
v_mfma_f32_32x32x16_bf16 v[80:95], v[208:211], v[144:147], v[80:95]
v_exp_f32 v124, v124
v_exp_f32 v125, v125
v_exp_f32 v126, v126
v_exp_f32 v127, v127
v_cvt_pk_bf16_f32 v150, v124, v125
v_cvt_pk_bf16_f32 v151, v126, v127
v_exp_f32 v128, v128
v_exp_f32 v129, v129
s_waitcnt vmcnt(32)
v_mfma_f32_32x32x16_bf16 v[80:95], v[212:215], v[148:151], v[80:95]
v_exp_f32 v130, v130
v_exp_f32 v131, v131
v_cvt_pk_bf16_f32 v144, v128, v129
v_cvt_pk_bf16_f32 v145, v130, v131
v_mfma_f32_32x32x16_bf16 v[112:127], v[216:219], v[16:19], 0
v_exp_f32 v132, v132
v_exp_f32 v133, v133
v_exp_f32 v134, v134
v_exp_f32 v135, v135
v_cvt_pk_bf16_f32 v146, v132, v133
v_cvt_pk_bf16_f32 v147, v134, v135
v_mfma_f32_32x32x16_bf16 v[112:127], v[220:223], v[20:23], v[112:127]
v_exp_f32 v136, v136
v_exp_f32 v137, v137
v_exp_f32 v138, v138
v_exp_f32 v139, v139
v_cvt_pk_bf16_f32 v148, v136, v137
v_cvt_pk_bf16_f32 v149, v138, v139
v_mfma_f32_32x32x16_bf16 v[96:111], v[208:211], v[144:147], v[96:111]
v_exp_f32 v140, v140
v_exp_f32 v141, v141
v_exp_f32 v142, v142
v_exp_f32 v143, v143
v_cvt_pk_bf16_f32 v150, v140, v141
v_cvt_pk_bf16_f32 v151, v142, v143
v_exp_f32 v112, v112
v_exp_f32 v113, v113
v_mfma_f32_32x32x16_bf16 v[96:111], v[212:215], v[148:151], v[96:111]
buffer_load_dwordx4 a[204:207], v2, s[8:11], s13 offen offset:3072 sc1
v_exp_f32 v114, v114
v_exp_f32 v115, v115
v_cvt_pk_bf16_f32 v144, v112, v113
v_cvt_pk_bf16_f32 v145, v114, v115
v_mfma_f32_32x32x16_bf16 v[128:143], v[216:219], v[24:27], 0
buffer_load_dwordx4 v2, s[8:11], s15 offen offset:2048 sc1 lds
v_exp_f32 v116, v116
v_exp_f32 v117, v117
v_exp_f32 v118, v118
v_exp_f32 v119, v119
v_cvt_pk_bf16_f32 v146, v116, v117
v_cvt_pk_bf16_f32 v147, v118, v119
v_mfma_f32_32x32x16_bf16 v[128:143], v[220:223], v[28:31], v[128:143]
s_add_u32 s12, s12, 4096
buffer_load_dwordx4 a[96:99], v2, s[8:11], s12 offen offset:0 sc1
v_exp_f32 v120, v120
v_exp_f32 v121, v121
v_exp_f32 v122, v122
v_exp_f32 v123, v123
v_cvt_pk_bf16_f32 v148, v120, v121
v_cvt_pk_bf16_f32 v149, v122, v123
v_mfma_f32_32x32x16_bf16 v[48:63], v[224:227], v[144:147], v[48:63]
s_add_u32 s13, s13, 4096
buffer_load_dwordx4 a[208:211], v2, s[8:11], s13 offen offset:0 sc1
v_exp_f32 v124, v124
v_exp_f32 v125, v125
v_exp_f32 v126, v126
v_exp_f32 v127, v127
v_cvt_pk_bf16_f32 v150, v124, v125
v_cvt_pk_bf16_f32 v151, v126, v127
v_exp_f32 v128, v128
v_exp_f32 v129, v129
v_mfma_f32_32x32x16_bf16 v[48:63], v[228:231], v[148:151], v[48:63]
buffer_load_dwordx4 v2, s[8:11], s15 offen offset:3072 sc1 lds
v_exp_f32 v130, v130
v_exp_f32 v131, v131
v_cvt_pk_bf16_f32 v144, v128, v129
v_cvt_pk_bf16_f32 v145, v130, v131
v_mfma_f32_32x32x16_bf16 v[112:127], v[216:219], v[32:35], 0
buffer_load_dwordx4 a[100:103], v2, s[8:11], s12 offen offset:1024 sc1
v_exp_f32 v132, v132
v_exp_f32 v133, v133
v_exp_f32 v134, v134
v_exp_f32 v135, v135
v_cvt_pk_bf16_f32 v146, v132, v133
v_cvt_pk_bf16_f32 v147, v134, v135
v_mfma_f32_32x32x16_bf16 v[112:127], v[220:223], v[36:39], v[112:127]
buffer_load_dwordx4 a[212:215], v2, s[8:11], s13 offen offset:1024 sc1
v_exp_f32 v136, v136
v_exp_f32 v137, v137
v_exp_f32 v138, v138
v_exp_f32 v139, v139
v_cvt_pk_bf16_f32 v148, v136, v137
v_cvt_pk_bf16_f32 v149, v138, v139
v_mfma_f32_32x32x16_bf16 v[64:79], v[224:227], v[144:147], v[64:79]
v_exp_f32 v140, v140
v_exp_f32 v141, v141
v_exp_f32 v142, v142
v_exp_f32 v143, v143
v_cvt_pk_bf16_f32 v150, v140, v141
v_cvt_pk_bf16_f32 v151, v142, v143
v_exp_f32 v112, v112
v_exp_f32 v113, v113
v_mfma_f32_32x32x16_bf16 v[64:79], v[228:231], v[148:151], v[64:79]
v_exp_f32 v114, v114
v_exp_f32 v115, v115
v_cvt_pk_bf16_f32 v144, v112, v113
v_cvt_pk_bf16_f32 v145, v114, v115
v_mfma_f32_32x32x16_bf16 v[128:143], v[216:219], v[40:43], 0
v_exp_f32 v116, v116
v_exp_f32 v117, v117
v_exp_f32 v118, v118
v_exp_f32 v119, v119
v_cvt_pk_bf16_f32 v146, v116, v117
v_cvt_pk_bf16_f32 v147, v118, v119
v_mfma_f32_32x32x16_bf16 v[128:143], v[220:223], v[44:47], v[128:143]
v_exp_f32 v120, v120
v_exp_f32 v121, v121
v_exp_f32 v122, v122
v_exp_f32 v123, v123
v_cvt_pk_bf16_f32 v148, v120, v121
v_cvt_pk_bf16_f32 v149, v122, v123
v_mfma_f32_32x32x16_bf16 v[80:95], v[224:227], v[144:147], v[80:95]
v_exp_f32 v124, v124
v_exp_f32 v125, v125
v_exp_f32 v126, v126
v_exp_f32 v127, v127
v_cvt_pk_bf16_f32 v150, v124, v125
v_cvt_pk_bf16_f32 v151, v126, v127
v_exp_f32 v128, v128
v_exp_f32 v129, v129
s_waitcnt vmcnt(28)
v_mfma_f32_32x32x16_bf16 v[80:95], v[228:231], v[148:151], v[80:95]
v_exp_f32 v130, v130
v_exp_f32 v131, v131
v_cvt_pk_bf16_f32 v144, v128, v129
v_cvt_pk_bf16_f32 v145, v130, v131
v_mfma_f32_32x32x16_bf16 v[112:127], v[152:155], v[24:27], 0
v_exp_f32 v132, v132
v_exp_f32 v133, v133
v_exp_f32 v134, v134
v_exp_f32 v135, v135
v_cvt_pk_bf16_f32 v146, v132, v133
v_cvt_pk_bf16_f32 v147, v134, v135
v_mfma_f32_32x32x16_bf16 v[112:127], v[156:159], v[28:31], v[112:127]
v_exp_f32 v136, v136
v_exp_f32 v137, v137
v_exp_f32 v138, v138
v_exp_f32 v139, v139
v_cvt_pk_bf16_f32 v148, v136, v137
v_cvt_pk_bf16_f32 v149, v138, v139
v_mfma_f32_32x32x16_bf16 v[96:111], v[224:227], v[144:147], v[96:111]
v_exp_f32 v140, v140
v_exp_f32 v141, v141
v_exp_f32 v142, v142
v_exp_f32 v143, v143
v_cvt_pk_bf16_f32 v150, v140, v141
v_cvt_pk_bf16_f32 v151, v142, v143
v_exp_f32 v112, v112
v_exp_f32 v113, v113
v_mfma_f32_32x32x16_bf16 v[96:111], v[228:231], v[148:151], v[96:111]
s_add_u32 s15, s15, 4096
s_add_u32 s16, s16, 4096
s_mov_b32 m0, s16
s_nop 0
buffer_load_dwordx4 v2, s[8:11], s15 offen offset:0 sc1 lds
v_exp_f32 v114, v114
v_exp_f32 v115, v115
v_cvt_pk_bf16_f32 v144, v112, v113
v_cvt_pk_bf16_f32 v145, v114, v115
v_mfma_f32_32x32x16_bf16 v[128:143], v[152:155], v[32:35], 0
buffer_load_dwordx4 a[104:107], v2, s[8:11], s12 offen offset:2048 sc1
v_exp_f32 v116, v116
v_exp_f32 v117, v117
v_exp_f32 v118, v118
v_exp_f32 v119, v119
v_cvt_pk_bf16_f32 v146, v116, v117
v_cvt_pk_bf16_f32 v147, v118, v119
v_mfma_f32_32x32x16_bf16 v[128:143], v[156:159], v[36:39], v[128:143]
buffer_load_dwordx4 a[216:219], v2, s[8:11], s13 offen offset:2048 sc1
v_exp_f32 v120, v120
v_exp_f32 v121, v121
v_exp_f32 v122, v122
v_exp_f32 v123, v123
v_cvt_pk_bf16_f32 v148, v120, v121
v_cvt_pk_bf16_f32 v149, v122, v123
v_mfma_f32_32x32x16_bf16 v[64:79], v[160:163], v[144:147], v[64:79]
buffer_load_dwordx4 v2, s[8:11], s15 offen offset:1024 sc1 lds
v_exp_f32 v124, v124
v_exp_f32 v125, v125
v_exp_f32 v126, v126
v_exp_f32 v127, v127
v_cvt_pk_bf16_f32 v150, v124, v125
v_cvt_pk_bf16_f32 v151, v126, v127
v_exp_f32 v128, v128
v_exp_f32 v129, v129
v_mfma_f32_32x32x16_bf16 v[64:79], v[164:167], v[148:151], v[64:79]
buffer_load_dwordx4 a[108:111], v2, s[8:11], s12 offen offset:3072 sc1
v_exp_f32 v130, v130
v_exp_f32 v131, v131
v_cvt_pk_bf16_f32 v144, v128, v129
v_cvt_pk_bf16_f32 v145, v130, v131
v_mfma_f32_32x32x16_bf16 v[112:127], v[152:155], v[40:43], 0
buffer_load_dwordx4 a[220:223], v2, s[8:11], s13 offen offset:3072 sc1
v_exp_f32 v132, v132
v_exp_f32 v133, v133
v_exp_f32 v134, v134
v_exp_f32 v135, v135
v_cvt_pk_bf16_f32 v146, v132, v133
v_cvt_pk_bf16_f32 v147, v134, v135
v_mfma_f32_32x32x16_bf16 v[112:127], v[156:159], v[44:47], v[112:127]
buffer_load_dwordx4 v2, s[8:11], s15 offen offset:2048 sc1 lds
v_exp_f32 v136, v136
v_exp_f32 v137, v137
v_exp_f32 v138, v138
v_exp_f32 v139, v139
v_cvt_pk_bf16_f32 v148, v136, v137
v_cvt_pk_bf16_f32 v149, v138, v139
v_mfma_f32_32x32x16_bf16 v[80:95], v[160:163], v[144:147], v[80:95]
v_exp_f32 v140, v140
v_exp_f32 v141, v141
v_exp_f32 v142, v142
v_exp_f32 v143, v143
v_cvt_pk_bf16_f32 v150, v140, v141
v_cvt_pk_bf16_f32 v151, v142, v143
ds_write_b128 v8, v[64:67] offset:0
ds_write_b128 v8, v[68:71] offset:1024
ds_write_b128 v8, v[72:75] offset:2048
ds_write_b128 v8, v[76:79] offset:3072
v_exp_f32 v112, v112
v_exp_f32 v113, v113
v_mfma_f32_32x32x16_bf16 v[80:95], v[164:167], v[148:151], v[80:95]
v_exp_f32 v114, v114
v_exp_f32 v115, v115
v_cvt_pk_bf16_f32 v144, v112, v113
v_cvt_pk_bf16_f32 v145, v114, v115
v_mfma_f32_32x32x16_bf16 v[128:143], v[152:155], v[16:19], 0
v_exp_f32 v116, v116
v_exp_f32 v117, v117
v_exp_f32 v118, v118
v_exp_f32 v119, v119
v_cvt_pk_bf16_f32 v146, v116, v117
v_cvt_pk_bf16_f32 v147, v118, v119
v_mfma_f32_32x32x16_bf16 v[128:143], v[156:159], v[20:23], v[128:143]
v_exp_f32 v120, v120
v_exp_f32 v121, v121
v_exp_f32 v122, v122
v_exp_f32 v123, v123
v_cvt_pk_bf16_f32 v148, v120, v121
v_cvt_pk_bf16_f32 v149, v122, v123
v_mfma_f32_32x32x16_bf16 v[96:111], v[160:163], v[144:147], v[96:111]
v_exp_f32 v124, v124
v_exp_f32 v125, v125
v_exp_f32 v126, v126
v_exp_f32 v127, v127
v_cvt_pk_bf16_f32 v150, v124, v125
v_cvt_pk_bf16_f32 v151, v126, v127
ds_write_b128 v9, v[80:83] offset:0
ds_write_b128 v9, v[84:87] offset:1024
ds_write_b128 v9, v[88:91] offset:2048
ds_write_b128 v9, v[92:95] offset:3072
v_exp_f32 v128, v128
v_exp_f32 v129, v129
v_mfma_f32_32x32x16_bf16 v[96:111], v[164:167], v[148:151], v[96:111]
v_exp_f32 v130, v130
v_exp_f32 v131, v131
v_cvt_pk_bf16_f32 v144, v128, v129
v_cvt_pk_bf16_f32 v145, v130, v131
v_exp_f32 v132, v132
v_exp_f32 v133, v133
v_exp_f32 v134, v134
v_exp_f32 v135, v135
v_cvt_pk_bf16_f32 v146, v132, v133
v_cvt_pk_bf16_f32 v147, v134, v135
v_exp_f32 v136, v136
v_exp_f32 v137, v137
v_exp_f32 v138, v138
v_exp_f32 v139, v139
v_cvt_pk_bf16_f32 v148, v136, v137
v_cvt_pk_bf16_f32 v149, v138, v139
v_mfma_f32_32x32x16_bf16 v[48:63], v[160:163], v[144:147], v[48:63]
v_exp_f32 v140, v140
v_exp_f32 v141, v141
v_exp_f32 v142, v142
v_exp_f32 v143, v143
v_cvt_pk_bf16_f32 v150, v140, v141
v_cvt_pk_bf16_f32 v151, v142, v143
ds_write_b128 v10, v[96:99] offset:0
ds_write_b128 v10, v[100:103] offset:1024
ds_write_b128 v10, v[104:107] offset:2048
ds_write_b128 v10, v[108:111] offset:3072
v_mfma_f32_32x32x16_bf16 v[48:63], v[164:167], v[148:151], v[48:63]
s_mov_b32 s86, s12
s_mov_b32 s87, s13
v_lshlrev_b32 v2, 4, v1
s_waitcnt lgkmcnt(0)
s_barrier
ds_read_b128 v[112:115], v11 offset:0
ds_read_b128 v[116:119], v11 offset:1024
ds_read_b128 v[120:123], v11 offset:2048
ds_read_b128 v[124:127], v11 offset:3072
ds_read_b128 v[128:131], v11 offset:4096
ds_read_b128 v[132:135], v11 offset:5120
ds_read_b128 v[136:139], v11 offset:6144
ds_read_b128 v[140:143], v11 offset:7168
ds_read_b128 v[144:147], v11 offset:8192
ds_read_b128 v[148:151], v11 offset:9216
ds_read_b128 v[152:155], v11 offset:10240
ds_read_b128 v[156:159], v11 offset:11264
s_waitcnt lgkmcnt(8)
v_add_f32 v48, v48, v112
v_add_f32 v49, v49, v113
v_add_f32 v50, v50, v114
v_add_f32 v51, v51, v115
v_add_f32 v52, v52, v116
v_add_f32 v53, v53, v117
v_add_f32 v54, v54, v118
v_add_f32 v55, v55, v119
v_add_f32 v56, v56, v120
v_add_f32 v57, v57, v121
v_add_f32 v58, v58, v122
v_add_f32 v59, v59, v123
v_add_f32 v60, v60, v124
v_add_f32 v61, v61, v125
v_add_f32 v62, v62, v126
v_add_f32 v63, v63, v127
s_waitcnt lgkmcnt(4)
v_add_f32 v48, v48, v128
v_add_f32 v49, v49, v129
v_add_f32 v50, v50, v130
v_add_f32 v51, v51, v131
v_add_f32 v52, v52, v132
v_add_f32 v53, v53, v133
v_add_f32 v54, v54, v134
v_add_f32 v55, v55, v135
v_add_f32 v56, v56, v136
v_add_f32 v57, v57, v137
v_add_f32 v58, v58, v138
v_add_f32 v59, v59, v139
v_add_f32 v60, v60, v140
v_add_f32 v61, v61, v141
v_add_f32 v62, v62, v142
v_add_f32 v63, v63, v143
s_waitcnt lgkmcnt(0)
v_add_f32 v48, v48, v144
v_add_f32 v49, v49, v145
v_add_f32 v50, v50, v146
v_add_f32 v51, v51, v147
v_add_f32 v52, v52, v148
v_add_f32 v53, v53, v149
v_add_f32 v54, v54, v150
v_add_f32 v55, v55, v151
v_add_f32 v56, v56, v152
v_add_f32 v57, v57, v153
v_add_f32 v58, v58, v154
v_add_f32 v59, v59, v155
v_add_f32 v60, v60, v156
v_add_f32 v61, v61, v157
v_add_f32 v62, v62, v158
v_add_f32 v63, v63, v159
v_mov_b32 v5, v60
v_mov_b32 v6, v60
s_nop 1
v_permlane32_swap_b32 v5, v6
v_mov_b32 v10, v6
v_rcp_f32 v6, v6
s_nop 0
v_mul_f32 v48, v48, v6
v_mul_f32 v49, v49, v6
v_mul_f32 v50, v50, v6
v_mul_f32 v51, v51, v6
v_mul_f32 v52, v52, v6
v_mul_f32 v53, v53, v6
v_mul_f32 v54, v54, v6
v_mul_f32 v55, v55, v6
v_mul_f32 v56, v56, v6
v_mul_f32 v57, v57, v6
v_mul_f32 v58, v58, v6
v_mul_f32 v59, v59, v6
v_mul_f32 v60, v60, v6
v_mul_f32 v61, v61, v6
v_mul_f32 v62, v62, v6
v_mul_f32 v63, v63, v6
v_cvt_pk_bf16_f32 v16, v48, v49
v_cvt_pk_bf16_f32 v17, v50, v51
v_cvt_pk_bf16_f32 v18, v52, v53
v_cvt_pk_bf16_f32 v19, v54, v55
v_cvt_pk_bf16_f32 v20, v56, v57
v_cvt_pk_bf16_f32 v21, v58, v59
v_cvt_pk_bf16_f32 v22, v60, v61
v_cvt_pk_bf16_f32 v23, v62, v63
v_cmp_lt_u32 vcc, 31, v1
v_mov_b32 v4, 0
s_nop 0
v_cndmask_b32 v22, v22, v4, vcc
v_cndmask_b32 v23, v23, v4, vcc
s_lshl_b32 s28, s7, 2
s_add_u32 s28, s28, s3
s_lshl_b32 s28, s28, 4
s_add_u32 s28, s28, s6
s_lshl_b32 s28, s28, 11
s_add_u32 s28, s28, 7340032
buffer_store_dwordx4 v[16:19], v2, s[8:11], s28 offen sc1
buffer_store_dwordx4 v[20:23], v2, s[8:11], s28 offen offset:1024 sc1
s_mov_b32 s28, 0x1f800000
v_cmp_nle_f32 vcc, s28, v10
s_cmp_lg_u64 vcc, 0
s_cselect_b32 s28, 1, 0
s_mul_i32 s29, s3, 12288
s_add_u32 s29, s29, 0
v_mov_b32 v5, s29
v_mov_b32 v6, s28
ds_write_b32 v5, v6
s_waitcnt vmcnt(0) lgkmcnt(0)
s_barrier
v_and_b32 v5, 3, v1
v_mul_u32_u24 v5, 12288, v5
v_add_u32 v5, 0, v5
ds_read_b32 v6, v5
s_waitcnt lgkmcnt(0)
v_cmp_ne_u32 vcc, 0, v6
s_cmp_lg_u64 vcc, 0
s_cbranch_scc0 att_ok_75
s_branch adaLN_cond__softmax_full_mha__glu_gated_geglu__prompt_kernel_exact
adaLN_cond__softmax_full_mha__glu_gated_geglu__prompt_kernel_exact_done:
s_waitcnt vmcnt(0)
s_barrier
att_ok_75:
s_cmp_lg_u32 s3, 0
s_cbranch_scc1 gf_skip_76
s_lshl_b32 s28, s4, 5
s_add_u32 s28, s28, s5
s_lshl_b32 s28, s28, 7
s_add_u32 s28, s28, 32145408
v_lshlrev_b32 v2, 2, v1
v_mov_b32 v3, s88
s_mov_b32 exec_hi, 0
buffer_store_dword v3, v2, s[8:11], s28 offen sc1
s_mov_b32 exec_hi, -1
gf_skip_76:
s_lshr_b32 s28, s5, 1
s_mul_i32 s6, s28, 200704
s_add_u32 s6, s6, 22020096
s_and_b32 s29, s5, 1
s_lshl_b32 s29, s29, 2
s_lshl_b32 s30, s4, 3
s_add_u32 s29, s29, s30
s_add_u32 s29, s29, s3
s_mov_b32 s46, s29
s_mul_i32 s30, s29, 112
s_mul_i32 s31, s28, 7
s_add_u32 s30, s30, s31
s_lshl_b32 s7, s30, 10
s_add_u32 s7, s7, 13631488
v_lshlrev_b32 v2, 4, v1
s_mov_b32 s91, s6
s_mov_b32 s45, s7
s_min_u32 s39, s5, 27
s_mul_hi_u32 s6, s39, 613566757
s_mul_i32 s28, s6, 7
s_sub_u32 s7, s39, s28
s_lshl_b32 s28, s4, 3
s_lshl_b32 s29, s6, 1
s_add_u32 s28, s28, s29
s_lshr_b32 s29, s3, 1
s_add_u32 s34, s28, s29
s_xor_b32 s29, s29, 1
s_add_u32 s35, s28, s29
s_lshl_b32 s28, s7, 1
s_and_b32 s29, s3, 1
s_add_u32 s36, s28, s29
s_xor_b32 s29, s29, 1
s_add_u32 s37, s28, s29
s_cmp_ge_u32 s5, 28
s_cbranch_scc1 p3_skip_77
v_lshlrev_b32 v2, 4, v1
s_mul_i32 s28, s3, 8192
s_mul_i32 s29, s36, 32768
s_add_u32 s29, s29, s28
s_add_u32 s29, s29, 20971520
buffer_load_dwordx4 v[144:147], v2, s[8:11], s29 offen offset:0 sc1
buffer_load_dwordx4 v[148:151], v2, s[8:11], s29 offen offset:1024 sc1
buffer_load_dwordx4 v[152:155], v2, s[8:11], s29 offen offset:2048 sc1
buffer_load_dwordx4 v[156:159], v2, s[8:11], s29 offen offset:3072 sc1
s_add_u32 s29, s29, 4096
buffer_load_dwordx4 v[160:163], v2, s[8:11], s29 offen offset:0 sc1
buffer_load_dwordx4 v[164:167], v2, s[8:11], s29 offen offset:1024 sc1
buffer_load_dwordx4 v[168:171], v2, s[8:11], s29 offen offset:2048 sc1
buffer_load_dwordx4 v[172:175], v2, s[8:11], s29 offen offset:3072 sc1
s_mul_i32 s29, s37, 32768
s_add_u32 s29, s29, s28
s_add_u32 s29, s29, 20971520
buffer_load_dwordx4 v[176:179], v2, s[8:11], s29 offen offset:0 sc1
buffer_load_dwordx4 v[180:183], v2, s[8:11], s29 offen offset:1024 sc1
buffer_load_dwordx4 v[184:187], v2, s[8:11], s29 offen offset:2048 sc1
buffer_load_dwordx4 v[188:191], v2, s[8:11], s29 offen offset:3072 sc1
s_add_u32 s29, s29, 4096
buffer_load_dwordx4 v[192:195], v2, s[8:11], s29 offen offset:0 sc1
buffer_load_dwordx4 v[196:199], v2, s[8:11], s29 offen offset:1024 sc1
buffer_load_dwordx4 v[200:203], v2, s[8:11], s29 offen offset:2048 sc1
buffer_load_dwordx4 v[204:207], v2, s[8:11], s29 offen offset:3072 sc1
v_lshrrev_b32 v3, 5, v1
v_lshlrev_b32 v4, 4, v3
v_and_b32 v5, 31, v1
v_mul_u32_u24 v5, 896, v5
v_lshl_add_u32 v5, v3, 3, v5
s_mul_i32 s28, s34, 28672
s_lshl_b32 s29, s36, 6
s_add_u32 s28, s28, s29
buffer_load_dwordx2 v[208:209], v5, s[20:23], s28 offen offset:0
buffer_load_dwordx2 v[210:211], v5, s[20:23], s28 offen offset:16
buffer_load_dwordx2 v[212:213], v5, s[20:23], s28 offen offset:32
buffer_load_dwordx2 v[214:215], v5, s[20:23], s28 offen offset:48
s_lshl_b32 s28, s36, 7
s_add_u32 s28, s28, 3584
buffer_load_dwordx4 v[216:219], v4, s[8:11], s28 offen offset:0 sc1
buffer_load_dwordx4 v[220:223], v4, s[8:11], s28 offen offset:32 sc1
buffer_load_dwordx4 v[224:227], v4, s[8:11], s28 offen offset:64 sc1
buffer_load_dwordx4 v[228:231], v4, s[8:11], s28 offen offset:96 sc1
v_and_b32 v4, 15, v1
v_lshrrev_b32 v5, 1, v4
v_lshlrev_b32 v5, 5, v5
v_and_b32 v4, 1, v4
v_add_u32 v4, v4, v5
s_lshl_b32 s28, s4, 1
s_lshr_b32 s29, s6, 1
s_add_u32 s28, s28, s29
s_lshl_b32 s28, s28, 1
v_add_u32 v4, s28, v4
v_lshlrev_b32 v4, 7, v4
s_cmp_lg_u32 s3, 0
s_cbranch_scc1 gw_end_81
s_mov_b32 s38, 0
s_mov_b32 s39, 32145408
gw_poll_79:
buffer_load_dword v3, v4, s[8:11], s39 offen sc1
s_waitcnt vmcnt(0)
v_cmp_ne_u32 vcc, s88, v3
s_cbranch_vccz gw_done_80
s_mov_b64 exec, vcc
s_sleep 2
s_add_u32 s38, s38, 1
s_cmp_lt_u32 s38, 131072
s_cbranch_scc1 gw_poll_79
gw_done_80:
s_mov_b64 exec, -1
gw_end_81:
s_barrier
v_lshlrev_b32 v2, 4, v1
s_mul_i32 s28, s3, 8192
s_mul_i32 s40, s34, 32768
s_add_u32 s40, s40, s28
s_add_u32 s40, s40, 7340032
s_mul_i32 s41, s35, 32768
s_add_u32 s41, s41, s28
s_add_u32 s41, s41, 7340032
buffer_load_dwordx4 v[80:83], v2, s[8:11], s40 offen offset:0 sc1
buffer_load_dwordx4 v[84:87], v2, s[8:11], s41 offen offset:0 sc1
buffer_load_dwordx4 v[88:91], v2, s[8:11], s40 offen offset:1024 sc1
buffer_load_dwordx4 v[92:95], v2, s[8:11], s41 offen offset:1024 sc1
buffer_load_dwordx4 v[96:99], v2, s[8:11], s40 offen offset:2048 sc1
buffer_load_dwordx4 v[100:103], v2, s[8:11], s41 offen offset:2048 sc1
buffer_load_dwordx4 v[104:107], v2, s[8:11], s40 offen offset:3072 sc1
buffer_load_dwordx4 v[108:111], v2, s[8:11], s41 offen offset:3072 sc1
s_add_u32 s40, s40, 4096
s_add_u32 s41, s41, 4096
buffer_load_dwordx4 v[112:115], v2, s[8:11], s40 offen offset:0 sc1
buffer_load_dwordx4 v[116:119], v2, s[8:11], s41 offen offset:0 sc1
buffer_load_dwordx4 v[120:123], v2, s[8:11], s40 offen offset:1024 sc1
buffer_load_dwordx4 v[124:127], v2, s[8:11], s41 offen offset:1024 sc1
buffer_load_dwordx4 v[128:131], v2, s[8:11], s40 offen offset:2048 sc1
buffer_load_dwordx4 v[132:135], v2, s[8:11], s41 offen offset:2048 sc1
buffer_load_dwordx4 v[136:139], v2, s[8:11], s40 offen offset:3072 sc1
buffer_load_dwordx4 v[140:143], v2, s[8:11], s41 offen offset:3072 sc1
v_lshlrev_b32 v2, 4, v1
s_xor_b32 s28, s3, 1
s_mul_i32 s28, s28, 12288
s_add_u32 s28, s28, 0
v_add_u32 v8, s28, v2
s_xor_b32 s28, s3, 2
s_mul_i32 s28, s28, 12288
s_add_u32 s28, s28, 4096
v_add_u32 v9, s28, v2
s_xor_b32 s28, s3, 3
s_mul_i32 s28, s28, 12288
s_add_u32 s28, s28, 8192
v_add_u32 v10, s28, v2
s_mul_i32 s28, s3, 12288
s_add_u32 s28, s28, 0
v_add_u32 v11, s28, v2
s_waitcnt vmcnt(14)
v_mfma_f32_32x32x16_bf16 v[16:31], v[144:147], v[80:83], 0
v_mfma_f32_32x32x16_bf16 v[32:47], v[176:179], v[80:83], 0
v_mfma_f32_32x32x16_bf16 v[48:63], v[144:147], v[84:87], 0
v_mfma_f32_32x32x16_bf16 v[64:79], v[176:179], v[84:87], 0
s_waitcnt vmcnt(12)
v_mfma_f32_32x32x16_bf16 v[16:31], v[148:151], v[88:91], v[16:31]
v_mfma_f32_32x32x16_bf16 v[32:47], v[180:183], v[88:91], v[32:47]
v_mfma_f32_32x32x16_bf16 v[48:63], v[148:151], v[92:95], v[48:63]
v_mfma_f32_32x32x16_bf16 v[64:79], v[180:183], v[92:95], v[64:79]
s_waitcnt vmcnt(10)
v_mfma_f32_32x32x16_bf16 v[16:31], v[152:155], v[96:99], v[16:31]
v_mfma_f32_32x32x16_bf16 v[32:47], v[184:187], v[96:99], v[32:47]
v_mfma_f32_32x32x16_bf16 v[48:63], v[152:155], v[100:103], v[48:63]
v_mfma_f32_32x32x16_bf16 v[64:79], v[184:187], v[100:103], v[64:79]
s_waitcnt vmcnt(8)
v_mfma_f32_32x32x16_bf16 v[16:31], v[156:159], v[104:107], v[16:31]
v_mfma_f32_32x32x16_bf16 v[32:47], v[188:191], v[104:107], v[32:47]
v_mfma_f32_32x32x16_bf16 v[48:63], v[156:159], v[108:111], v[48:63]
v_mfma_f32_32x32x16_bf16 v[64:79], v[188:191], v[108:111], v[64:79]
s_waitcnt vmcnt(6)
v_mfma_f32_32x32x16_bf16 v[16:31], v[160:163], v[112:115], v[16:31]
v_mfma_f32_32x32x16_bf16 v[32:47], v[192:195], v[112:115], v[32:47]
v_mfma_f32_32x32x16_bf16 v[48:63], v[160:163], v[116:119], v[48:63]
v_mfma_f32_32x32x16_bf16 v[64:79], v[192:195], v[116:119], v[64:79]
s_waitcnt vmcnt(0)
v_mfma_f32_32x32x16_bf16 v[64:79], v[196:199], v[124:127], v[64:79]
v_mfma_f32_32x32x16_bf16 v[64:79], v[200:203], v[132:135], v[64:79]
v_mfma_f32_32x32x16_bf16 v[64:79], v[204:207], v[140:143], v[64:79]
v_mfma_f32_32x32x16_bf16 v[48:63], v[164:167], v[124:127], v[48:63]
v_mfma_f32_32x32x16_bf16 v[48:63], v[168:171], v[132:135], v[48:63]
v_mfma_f32_32x32x16_bf16 v[48:63], v[172:175], v[140:143], v[48:63]
s_nop 8
ds_write_b128 v10, v[64:67] offset:0
ds_write_b128 v10, v[68:71] offset:1024
ds_write_b128 v10, v[72:75] offset:2048
ds_write_b128 v10, v[76:79] offset:3072
v_mfma_f32_32x32x16_bf16 v[32:47], v[196:199], v[120:123], v[32:47]
v_mfma_f32_32x32x16_bf16 v[32:47], v[200:203], v[128:131], v[32:47]
v_mfma_f32_32x32x16_bf16 v[32:47], v[204:207], v[136:139], v[32:47]
ds_write_b128 v9, v[48:51] offset:0
ds_write_b128 v9, v[52:55] offset:1024
ds_write_b128 v9, v[56:59] offset:2048
ds_write_b128 v9, v[60:63] offset:3072
v_mfma_f32_32x32x16_bf16 v[16:31], v[164:167], v[120:123], v[16:31]
v_mfma_f32_32x32x16_bf16 v[16:31], v[168:171], v[128:131], v[16:31]
v_mfma_f32_32x32x16_bf16 v[16:31], v[172:175], v[136:139], v[16:31]
s_nop 4
ds_write_b128 v8, v[32:35] offset:0
ds_write_b128 v8, v[36:39] offset:1024
ds_write_b128 v8, v[40:43] offset:2048
ds_write_b128 v8, v[44:47] offset:3072
v_lshrrev_b32 v3, 5, v1
v_lshlrev_b32 v4, 4, v3
s_lshl_b32 s28, s36, 7
s_add_u32 s28, s28, 7168
buffer_load_dwordx4 v[112:115], v4, s[8:11], s28 offen offset:0 sc1
buffer_load_dwordx4 v[116:119], v4, s[8:11], s28 offen offset:32 sc1
buffer_load_dwordx4 v[120:123], v4, s[8:11], s28 offen offset:64 sc1
buffer_load_dwordx4 v[124:127], v4, s[8:11], s28 offen offset:96 sc1
s_lshl_b32 s28, s36, 7
s_add_u32 s28, s28, 5376
buffer_load_dwordx4 v[128:131], v4, s[8:11], s28 offen offset:0 sc1
buffer_load_dwordx4 v[132:135], v4, s[8:11], s28 offen offset:32 sc1
buffer_load_dwordx4 v[136:139], v4, s[8:11], s28 offen offset:64 sc1
buffer_load_dwordx4 v[140:143], v4, s[8:11], s28 offen offset:96 sc1
s_waitcnt lgkmcnt(0)
s_barrier
ds_read_b128 v[32:35], v11 offset:0
ds_read_b128 v[36:39], v11 offset:1024
ds_read_b128 v[40:43], v11 offset:2048
ds_read_b128 v[44:47], v11 offset:3072
ds_read_b128 v[48:51], v11 offset:4096
ds_read_b128 v[52:55], v11 offset:5120
ds_read_b128 v[56:59], v11 offset:6144
ds_read_b128 v[60:63], v11 offset:7168
ds_read_b128 v[64:67], v11 offset:8192
ds_read_b128 v[68:71], v11 offset:9216
ds_read_b128 v[72:75], v11 offset:10240
ds_read_b128 v[76:79], v11 offset:11264
s_waitcnt lgkmcnt(8)
v_add_f32 v16, v16, v32
v_add_f32 v17, v17, v33
v_add_f32 v18, v18, v34
v_add_f32 v19, v19, v35
v_add_f32 v20, v20, v36
v_add_f32 v21, v21, v37
v_add_f32 v22, v22, v38
v_add_f32 v23, v23, v39
v_add_f32 v24, v24, v40
v_add_f32 v25, v25, v41
v_add_f32 v26, v26, v42
v_add_f32 v27, v27, v43
v_add_f32 v28, v28, v44
v_add_f32 v29, v29, v45
v_add_f32 v30, v30, v46
v_add_f32 v31, v31, v47
s_waitcnt lgkmcnt(4)
v_add_f32 v16, v16, v48
v_add_f32 v17, v17, v49
v_add_f32 v18, v18, v50
v_add_f32 v19, v19, v51
v_add_f32 v20, v20, v52
v_add_f32 v21, v21, v53
v_add_f32 v22, v22, v54
v_add_f32 v23, v23, v55
v_add_f32 v24, v24, v56
v_add_f32 v25, v25, v57
v_add_f32 v26, v26, v58
v_add_f32 v27, v27, v59
v_add_f32 v28, v28, v60
v_add_f32 v29, v29, v61
v_add_f32 v30, v30, v62
v_add_f32 v31, v31, v63
s_waitcnt lgkmcnt(0)
v_add_f32 v16, v16, v64
v_add_f32 v17, v17, v65
v_add_f32 v18, v18, v66
v_add_f32 v19, v19, v67
v_add_f32 v20, v20, v68
v_add_f32 v21, v21, v69
v_add_f32 v22, v22, v70
v_add_f32 v23, v23, v71
v_add_f32 v24, v24, v72
v_add_f32 v25, v25, v73
v_add_f32 v26, v26, v74
v_add_f32 v27, v27, v75
v_add_f32 v28, v28, v76
v_add_f32 v29, v29, v77
v_add_f32 v30, v30, v78
v_add_f32 v31, v31, v79
s_barrier
v_lshlrev_b32 v32, 16, v208
v_and_b32 v33, 0xffff0000, v208
v_lshlrev_b32 v34, 16, v209
v_and_b32 v35, 0xffff0000, v209
v_lshlrev_b32 v36, 16, v210
v_and_b32 v37, 0xffff0000, v210
v_lshlrev_b32 v38, 16, v211
v_and_b32 v39, 0xffff0000, v211
v_lshlrev_b32 v40, 16, v212
v_and_b32 v41, 0xffff0000, v212
v_lshlrev_b32 v42, 16, v213
v_and_b32 v43, 0xffff0000, v213
v_lshlrev_b32 v44, 16, v214
v_and_b32 v45, 0xffff0000, v214
v_lshlrev_b32 v46, 16, v215
v_and_b32 v47, 0xffff0000, v215
v_fmac_f32 v32, v216, v16
v_fmac_f32 v33, v217, v17
v_fmac_f32 v34, v218, v18
v_fmac_f32 v35, v219, v19
v_fmac_f32 v36, v220, v20
v_fmac_f32 v37, v221, v21
v_fmac_f32 v38, v222, v22
v_fmac_f32 v39, v223, v23
v_fmac_f32 v40, v224, v24
v_fmac_f32 v41, v225, v25
v_fmac_f32 v42, v226, v26
v_fmac_f32 v43, v227, v27
v_fmac_f32 v44, v228, v28
v_fmac_f32 v45, v229, v29
v_fmac_f32 v46, v230, v30
v_fmac_f32 v47, v231, v31
v_cvt_pk_bf16_f32 v48, v32, v33
v_cvt_pk_bf16_f32 v49, v34, v35
v_cvt_pk_bf16_f32 v50, v36, v37
v_cvt_pk_bf16_f32 v51, v38, v39
v_cvt_pk_bf16_f32 v52, v40, v41
v_cvt_pk_bf16_f32 v53, v42, v43
v_cvt_pk_bf16_f32 v54, v44, v45
v_cvt_pk_bf16_f32 v55, v46, v47
v_lshlrev_b32 v32, 16, v48
v_and_b32 v33, 0xffff0000, v48
v_lshlrev_b32 v34, 16, v49
v_and_b32 v35, 0xffff0000, v49
v_lshlrev_b32 v36, 16, v50
v_and_b32 v37, 0xffff0000, v50
v_lshlrev_b32 v38, 16, v51
v_and_b32 v39, 0xffff0000, v51
v_lshlrev_b32 v40, 16, v52
v_and_b32 v41, 0xffff0000, v52
v_lshlrev_b32 v42, 16, v53
v_and_b32 v43, 0xffff0000, v53
v_lshlrev_b32 v44, 16, v54
v_and_b32 v45, 0xffff0000, v54
v_lshlrev_b32 v46, 16, v55
v_and_b32 v47, 0xffff0000, v55
v_mov_b32 v244, v48
v_mov_b32 v245, v49
v_mov_b32 v246, v50
v_mov_b32 v247, v51
v_mov_b32 v248, v52
v_mov_b32 v249, v53
v_mov_b32 v250, v54
v_mov_b32 v251, v55
v_mov_b32 v6, v32
v_mul_f32 v7, v32, v32
v_add_f32 v6, v6, v33
v_fmac_f32 v7, v33, v33
v_add_f32 v6, v6, v34
v_fmac_f32 v7, v34, v34
v_add_f32 v6, v6, v35
v_fmac_f32 v7, v35, v35
v_add_f32 v6, v6, v36
v_fmac_f32 v7, v36, v36
v_add_f32 v6, v6, v37
v_fmac_f32 v7, v37, v37
v_add_f32 v6, v6, v38
v_fmac_f32 v7, v38, v38
v_add_f32 v6, v6, v39
v_fmac_f32 v7, v39, v39
v_add_f32 v6, v6, v40
v_fmac_f32 v7, v40, v40
v_add_f32 v6, v6, v41
v_fmac_f32 v7, v41, v41
v_add_f32 v6, v6, v42
v_fmac_f32 v7, v42, v42
v_add_f32 v6, v6, v43
v_fmac_f32 v7, v43, v43
v_add_f32 v6, v6, v44
v_fmac_f32 v7, v44, v44
v_add_f32 v6, v6, v45
v_fmac_f32 v7, v45, v45
v_add_f32 v6, v6, v46
v_fmac_f32 v7, v46, v46
v_add_f32 v6, v6, v47
v_fmac_f32 v7, v47, v47
v_mov_b32 v8, v6
v_mov_b32 v9, v7
s_nop 0
v_permlane32_swap_b32 v6, v8
v_permlane32_swap_b32 v7, v9
v_add_f32 v6, v6, v8
v_add_f32 v7, v7, v9
v_lshlrev_b32 v2, 4, v1
v_and_b32 v5, 31, v1
v_lshlrev_b32 v5, 3, v5
s_mul_i32 s28, s34, 14
s_add_u32 s28, s28, s36
s_cmp_eq_u32 s47, 1
s_cbranch_scc1 pub_loc_82
s_lshl_b32 s29, s28, 9
s_add_u32 s29, s29, 31457280
v_mov_b32 v8, s88
v_mov_b32 v9, s88
v_mov_b32 v10, v6
v_mov_b32 v11, v7
v_lshlrev_b32 v12, 1, v5
v_mov_b32 v6, v10
v_mov_b32 v7, v11
s_mov_b32 exec_hi, 0
buffer_store_dwordx4 v[6:9], v12, s[8:11], s29 offen sc1
s_mov_b64 exec, -1
s_branch pub_end_83
pub_loc_82:
s_lshl_b32 s29, s28, 9
s_add_u32 s29, s29, 31457280
v_mov_b32 v8, s88
v_mov_b32 v9, s88
v_mov_b32 v10, v6
v_mov_b32 v11, v7
v_lshlrev_b32 v12, 1, v5
v_mov_b32 v6, v10
v_mov_b32 v7, v11
s_mov_b32 exec_hi, 0
buffer_store_dwordx4 v[6:9], v12, s[8:11], s29 offen
s_mov_b64 exec, -1
pub_end_83:
v_and_b32 v5, 31, v1
v_lshlrev_b32 v5, 4, v5
v_lshrrev_b32 v3, 5, v1
v_mul_u32_u24 v3, 3584, v3
v_add_u32 v5, v5, v3
s_mul_i32 s29, s34, 7168
s_add_u32 s29, s29, 31457280
s_mov_b32 s38, 0
stat_poll_84:
buffer_load_dwordx4 v[64:67], v5, s[8:11], s29 offen offset:0 sc1
buffer_load_dwordx4 v[68:71], v5, s[8:11], s29 offen offset:512 sc1
buffer_load_dwordx4 v[72:75], v5, s[8:11], s29 offen offset:1024 sc1
buffer_load_dwordx4 v[76:79], v5, s[8:11], s29 offen offset:1536 sc1
buffer_load_dwordx4 v[80:83], v5, s[8:11], s29 offen offset:2048 sc1
buffer_load_dwordx4 v[84:87], v5, s[8:11], s29 offen offset:2560 sc1
buffer_load_dwordx4 v[88:91], v5, s[8:11], s29 offen offset:3072 sc1
s_waitcnt vmcnt(0)
v_cmp_ne_u32 vcc, s88, v66
v_cmp_ne_u32 s[30:31], s88, v70
s_or_b64 vcc, vcc, s[30:31]
v_cmp_ne_u32 s[30:31], s88, v74
s_or_b64 vcc, vcc, s[30:31]
v_cmp_ne_u32 s[30:31], s88, v78
s_or_b64 vcc, vcc, s[30:31]
v_cmp_ne_u32 s[30:31], s88, v82
s_or_b64 vcc, vcc, s[30:31]
v_cmp_ne_u32 s[30:31], s88, v86
s_or_b64 vcc, vcc, s[30:31]
v_cmp_ne_u32 s[30:31], s88, v90
s_or_b64 vcc, vcc, s[30:31]
s_cbranch_vccz stat_done_85
s_add_u32 s38, s38, 1
s_cmp_lt_u32 s38, 0x8000
s_cbranch_scc1 stat_poll_84
stat_done_85:
v_add_f32 v64, v64, v68
v_add_f32 v65, v65, v69
v_add_f32 v64, v64, v72
v_add_f32 v65, v65, v73
v_add_f32 v64, v64, v76
v_add_f32 v65, v65, v77
v_add_f32 v64, v64, v80
v_add_f32 v65, v65, v81
v_add_f32 v64, v64, v84
v_add_f32 v65, v65, v85
v_add_f32 v64, v64, v88
v_add_f32 v65, v65, v89
v_mov_b32 v8, v64
v_mov_b32 v9, v65
s_nop 0
v_permlane32_swap_b32 v64, v8
v_permlane32_swap_b32 v65, v9
v_add_f32 v6, v64, v8
v_add_f32 v7, v65, v9
v_mul_f32 v6, 0x3b124925, v6
v_mul_f32 v7, 0x3b124925, v7
v_fma_f32 v7, -v6, v6, v7
v_max_f32 v7, 0, v7
v_add_f32 v7, 0x3727c5ac, v7
v_rsq_f32 v7, v7
s_nop 0
v_mul_f32 v6, v6, v7
v_fma_f32 v32, v32, v7, -v6
v_fma_f32 v33, v33, v7, -v6
v_fma_f32 v34, v34, v7, -v6
v_fma_f32 v35, v35, v7, -v6
v_fma_f32 v36, v36, v7, -v6
v_fma_f32 v37, v37, v7, -v6
v_fma_f32 v38, v38, v7, -v6
v_fma_f32 v39, v39, v7, -v6
v_fma_f32 v40, v40, v7, -v6
v_fma_f32 v41, v41, v7, -v6
v_fma_f32 v42, v42, v7, -v6
v_fma_f32 v43, v43, v7, -v6
v_fma_f32 v44, v44, v7, -v6
v_fma_f32 v45, v45, v7, -v6
v_fma_f32 v46, v46, v7, -v6
v_fma_f32 v47, v47, v7, -v6
v_fma_f32 v32, v32, v112, v128
v_fma_f32 v33, v33, v113, v129
v_fma_f32 v34, v34, v114, v130
v_fma_f32 v35, v35, v115, v131
v_fma_f32 v36, v36, v116, v132
v_fma_f32 v37, v37, v117, v133
v_fma_f32 v38, v38, v118, v134
v_fma_f32 v39, v39, v119, v135
v_fma_f32 v40, v40, v120, v136
v_fma_f32 v41, v41, v121, v137
v_fma_f32 v42, v42, v122, v138
v_fma_f32 v43, v43, v123, v139
v_fma_f32 v44, v44, v124, v140
v_fma_f32 v45, v45, v125, v141
v_fma_f32 v46, v46, v126, v142
v_fma_f32 v47, v47, v127, v143
v_cvt_pk_bf16_f32 v56, v32, v33
v_cvt_pk_bf16_f32 v57, v34, v35
v_cvt_pk_bf16_f32 v58, v36, v37
v_cvt_pk_bf16_f32 v59, v38, v39
v_cvt_pk_bf16_f32 v60, v40, v41
v_cvt_pk_bf16_f32 v61, v42, v43
v_cvt_pk_bf16_f32 v62, v44, v45
v_cvt_pk_bf16_f32 v63, v46, v47
s_mul_i32 s28, s34, 28
s_lshl_b32 s29, s36, 1
s_add_u32 s28, s28, s29
s_lshl_b32 s28, s28, 10
s_add_u32 s28, s28, 11534336
s_cmp_eq_u32 s47, 1
s_cbranch_scc1 pub_loc_86
buffer_store_dwordx4 v[56:59], v2, s[8:11], s28 offen sc1
buffer_store_dwordx4 v[60:63], v2, s[8:11], s28 offen offset:1024 sc1
s_branch pub_end_87
pub_loc_86:
buffer_store_dwordx4 v[56:59], v2, s[8:11], s28 offen
buffer_store_dwordx4 v[60:63], v2, s[8:11], s28 offen offset:1024
pub_end_87:
s_waitcnt vmcnt(0)
s_lshl_b32 s32, s4, 9
s_lshl_b32 s33, s5, 4
s_add_u32 s32, s32, s33
s_lshl_b32 s33, s3, 2
s_add_u32 s32, s32, s33
s_add_u32 s32, s32, 376832
v_mov_b32 v236, 0
v_mov_b32 v237, s88
s_mov_b64 exec, 1
s_cmp_eq_u32 s47, 1
s_cbranch_scc1 pub_loc_88
buffer_store_dword v237, v236, s[8:11], s32 offen sc1
s_branch pub_end_89
pub_loc_88:
buffer_store_dword v237, v236, s[8:11], s32 offen
pub_end_89:
s_mov_b64 exec, -1
p3_skip_77:
s_mov_b32 s6, s91
s_mov_b32 s7, s45
v_lshlrev_b32 v2, 4, v1
v_and_b32 v6, 15, v1
v_min_u32 v6, 13, v6
v_lshrrev_b32 v7, 1, v6
v_and_b32 v6, 1, v6
v_lshl_add_u32 v6, v7, 2, v6
s_and_b32 s28, s5, 1
s_lshl_b32 s28, s28, 1
s_lshr_b32 s29, s3, 1
s_add_u32 s28, s28, s29
s_mul_i32 s28, s28, 28
s_and_b32 s29, s3, 1
s_lshl_b32 s29, s29, 1
s_add_u32 s28, s28, s29
v_add_u32 v6, s28, v6
v_lshlrev_b32 v6, 2, v6
s_lshl_b32 s28, s4, 9
v_add_u32 v6, s28, v6
s_min_u32 s39, s5, 27
s_mul_hi_u32 s33, s39, 613566757
v_and_b32 v232, 3, v1
s_lshl_b32 s28, s3, 2
v_add_u32 v232, s28, v232
v_lshlrev_b32 v232, 1, v232
s_lshr_b32 s28, s33, 1
v_add_u32 v232, s28, v232
v_lshlrev_b32 v232, 2, v232
s_and_b32 s28, s33, 1
s_lshl_b32 s28, s28, 1
v_add_u32 v232, s28, v232
v_bfe_u32 v233, v1, 2, 1
v_add_u32 v232, v232, v233
v_lshlrev_b32 v232, 2, v232
s_lshl_b32 s28, s4, 9
v_add_u32 v232, s28, v232
s_mul_i32 s28, s33, 7
s_sub_u32 s28, s39, s28
s_mul_i32 s28, s28, 37
v_min_u32 v238, 36, v1
v_add_u32 v238, s28, v238
v_min_u32 v238, 255, v238
v_lshrrev_b32 v239, 3, v238
v_and_b32 v238, 7, v238
v_lshlrev_b32 v238, 7, v238
v_bfe_u32 v240, v239, 2, 2
v_mul_u32_u24 v240, 7, v240
v_and_b32 v241, 3, v239
v_add_u32 v240, v240, v241
s_mul_i32 s28, s3, 28
v_add_u32 v240, s28, v240
v_lshl_add_u32 v238, v240, 10, v238
v_lshrrev_b32 v239, 4, v239
s_lshl_b32 s28, s4, 3
s_lshl_b32 s29, s33, 1
s_add_u32 s28, s28, s29
v_add_u32 v239, s28, v239
v_mul_u32_u24 v239, 114688, v239
v_add_u32 v238, v238, v239
v_lshlrev_b32 v2, 4, v1
v_add_u32 v4, 0x10000, v2
v_add_u32 v5, 0x20000, v2
s_mul_i32 s30, s46, 28672
s_add_u32 s30, s30, 11534336
s_mov_b32 s45, 0xbdd2d3e8
v_mov_b32 v14, 0xc0135761
s_lshr_b32 s28, s5, 1
s_mul_i32 s15, s28, 200704
s_add_u32 s15, s15, 22163456
s_mul_i32 s16, s3, 7168
s_add_u32 s15, s15, s16
s_add_u32 s16, s16, 49152
s_mul_i32 s91, s46, 28672
s_add_u32 s91, s91, 11534336
s_mov_b32 s38, 0
s_mov_b32 s39, 376832
fw_poll_90:
buffer_load_dword v3, v6, s[8:11], s39 offen sc1
s_waitcnt vmcnt(0)
v_cmp_ne_u32 vcc, s88, v3
s_cbranch_vccz fw_done_91
s_sleep 1
s_add_u32 s38, s38, 1
s_cmp_lt_u32 s38, 131072
s_cbranch_scc1 fw_poll_90
fw_done_91:
v_mov_b32 v3, v2
s_mov_b32 s30, s91
buffer_load_dwordx4 v[16:19], v2, s[8:11], s30 offen offset:0 sc1
buffer_load_dwordx4 v[20:23], v2, s[8:11], s30 offen offset:1024 sc1
buffer_load_dwordx4 v[24:27], v2, s[8:11], s30 offen offset:2048 sc1
buffer_load_dwordx4 v[28:31], v2, s[8:11], s30 offen offset:3072 sc1
s_add_u32 s30, s30, 4096
buffer_load_dwordx4 v[32:35], v2, s[8:11], s30 offen offset:0 sc1
buffer_load_dwordx4 v[36:39], v2, s[8:11], s30 offen offset:1024 sc1
buffer_load_dwordx4 v[40:43], v2, s[8:11], s30 offen offset:2048 sc1
buffer_load_dwordx4 v[44:47], v2, s[8:11], s30 offen offset:3072 sc1
s_add_u32 s30, s30, 4096
buffer_load_dwordx4 v[48:51], v2, s[8:11], s30 offen offset:0 sc1
buffer_load_dwordx4 v[52:55], v2, s[8:11], s30 offen offset:1024 sc1
ds_read_b128 v[160:163], v3 offset:49152
ds_read_b128 v[164:167], v4 offset:12288
ds_read_b128 v[168:171], v3 offset:50176
ds_read_b128 v[172:175], v4 offset:13312
ds_read_b128 v[176:179], v3 offset:51200
ds_read_b128 v[180:183], v4 offset:14336
ds_read_b128 v[184:187], v3 offset:52224
s_lshr_b32 s28, s5, 1
s_mul_i32 s17, s28, 200704
s_add_u32 s17, s17, 22134784
s_mul_i32 s18, s3, 7168
s_add_u32 s17, s17, s18
s_add_u32 s18, s18, 0
s_waitcnt lgkmcnt(3)
s_waitcnt vmcnt(9)
v_mfma_f32_32x32x16_bf16 v[128:143], v[160:163], v[16:19], 0
ds_read_b128 v[188:191], v4 offset:15360
buffer_load_dwordx4 v[56:59], v2, s[8:11], s30 offen offset:2048 sc1
v_mfma_f32_32x32x16_bf16 v[144:159], v[164:167], v[16:19], 0
ds_read_b128 v[160:163], v3 offset:53248
s_waitcnt vmcnt(9)
v_mfma_f32_32x32x16_bf16 v[128:143], v[168:171], v[20:23], v[128:143]
ds_read_b128 v[164:167], v4 offset:16384
buffer_load_dwordx4 v[60:63], v2, s[8:11], s30 offen offset:3072 sc1
v_mfma_f32_32x32x16_bf16 v[144:159], v[172:175], v[20:23], v[144:159]
ds_read_b128 v[168:171], v3 offset:54272
s_waitcnt lgkmcnt(3)
s_waitcnt vmcnt(9)
v_mfma_f32_32x32x16_bf16 v[128:143], v[176:179], v[24:27], v[128:143]
ds_read_b128 v[172:175], v4 offset:17408
s_add_u32 s30, s30, 4096
buffer_load_dwordx4 v[64:67], v2, s[8:11], s30 offen offset:0 sc1
v_mfma_f32_32x32x16_bf16 v[144:159], v[180:183], v[24:27], v[144:159]
ds_read_b128 v[176:179], v3 offset:55296
s_waitcnt vmcnt(9)
v_mfma_f32_32x32x16_bf16 v[128:143], v[184:187], v[28:31], v[128:143]
ds_read_b128 v[180:183], v4 offset:18432
buffer_load_dwordx4 v[68:71], v2, s[8:11], s30 offen offset:1024 sc1
v_mfma_f32_32x32x16_bf16 v[144:159], v[188:191], v[28:31], v[144:159]
ds_read_b128 v[184:187], v3 offset:56320
s_waitcnt lgkmcnt(3)
s_waitcnt vmcnt(9)
v_mfma_f32_32x32x16_bf16 v[128:143], v[160:163], v[32:35], v[128:143]
ds_read_b128 v[188:191], v4 offset:19456
buffer_load_dwordx4 v[72:75], v2, s[8:11], s30 offen offset:2048 sc1
v_mfma_f32_32x32x16_bf16 v[144:159], v[164:167], v[32:35], v[144:159]
ds_read_b128 v[160:163], v3 offset:57344
s_waitcnt vmcnt(9)
v_mfma_f32_32x32x16_bf16 v[128:143], v[168:171], v[36:39], v[128:143]
ds_read_b128 v[164:167], v4 offset:20480
buffer_load_dwordx4 v[76:79], v2, s[8:11], s30 offen offset:3072 sc1
v_mfma_f32_32x32x16_bf16 v[144:159], v[172:175], v[36:39], v[144:159]
ds_read_b128 v[168:171], v3 offset:58368
s_waitcnt lgkmcnt(3)
s_waitcnt vmcnt(9)
v_mfma_f32_32x32x16_bf16 v[128:143], v[176:179], v[40:43], v[128:143]
ds_read_b128 v[172:175], v4 offset:21504
s_add_u32 s30, s30, 4096
buffer_load_dwordx4 v[80:83], v2, s[8:11], s30 offen offset:0 sc1
v_mfma_f32_32x32x16_bf16 v[144:159], v[180:183], v[40:43], v[144:159]
ds_read_b128 v[176:179], v3 offset:59392
s_waitcnt vmcnt(9)
v_mfma_f32_32x32x16_bf16 v[128:143], v[184:187], v[44:47], v[128:143]
ds_read_b128 v[180:183], v4 offset:22528
buffer_load_dwordx4 v[84:87], v2, s[8:11], s30 offen offset:1024 sc1
v_mfma_f32_32x32x16_bf16 v[144:159], v[188:191], v[44:47], v[144:159]
ds_read_b128 v[184:187], v3 offset:60416
s_waitcnt lgkmcnt(3)
s_waitcnt vmcnt(9)
v_mfma_f32_32x32x16_bf16 v[128:143], v[160:163], v[48:51], v[128:143]
ds_read_b128 v[188:191], v4 offset:23552
buffer_load_dwordx4 v[88:91], v2, s[8:11], s30 offen offset:2048 sc1
v_mfma_f32_32x32x16_bf16 v[144:159], v[164:167], v[48:51], v[144:159]
ds_read_b128 v[160:163], v3 offset:61440
s_waitcnt vmcnt(9)
v_mfma_f32_32x32x16_bf16 v[128:143], v[168:171], v[52:55], v[128:143]
ds_read_b128 v[164:167], v4 offset:24576
buffer_load_dwordx4 v[92:95], v2, s[8:11], s30 offen offset:3072 sc1
v_mfma_f32_32x32x16_bf16 v[144:159], v[172:175], v[52:55], v[144:159]
ds_read_b128 v[168:171], v3 offset:62464
s_waitcnt lgkmcnt(3)
s_waitcnt vmcnt(9)
v_mfma_f32_32x32x16_bf16 v[128:143], v[176:179], v[56:59], v[128:143]
ds_read_b128 v[172:175], v4 offset:25600
s_add_u32 s30, s30, 4096
buffer_load_dwordx4 v[96:99], v2, s[8:11], s30 offen offset:0 sc1
v_mfma_f32_32x32x16_bf16 v[144:159], v[180:183], v[56:59], v[144:159]
ds_read_b128 v[176:179], v3 offset:63488
s_waitcnt vmcnt(9)
v_mfma_f32_32x32x16_bf16 v[128:143], v[184:187], v[60:63], v[128:143]
ds_read_b128 v[180:183], v4 offset:26624
buffer_load_dwordx4 v[100:103], v2, s[8:11], s30 offen offset:1024 sc1
v_mfma_f32_32x32x16_bf16 v[144:159], v[188:191], v[60:63], v[144:159]
ds_read_b128 v[184:187], v3 offset:64512
s_waitcnt lgkmcnt(3)
s_waitcnt vmcnt(9)
v_mfma_f32_32x32x16_bf16 v[128:143], v[160:163], v[64:67], v[128:143]
ds_read_b128 v[188:191], v4 offset:27648
buffer_load_dwordx4 v[104:107], v2, s[8:11], s30 offen offset:2048 sc1
v_mfma_f32_32x32x16_bf16 v[144:159], v[164:167], v[64:67], v[144:159]
ds_read_b128 v[160:163], v4 offset:0
s_waitcnt vmcnt(9)
v_mfma_f32_32x32x16_bf16 v[128:143], v[168:171], v[68:71], v[128:143]
ds_read_b128 v[164:167], v4 offset:28672
buffer_load_dwordx4 v[108:111], v2, s[8:11], s30 offen offset:3072 sc1
v_mfma_f32_32x32x16_bf16 v[144:159], v[172:175], v[68:71], v[144:159]
ds_read_b128 v[168:171], v4 offset:1024
s_waitcnt lgkmcnt(3)
s_waitcnt vmcnt(9)
v_mfma_f32_32x32x16_bf16 v[128:143], v[176:179], v[72:75], v[128:143]
ds_read_b128 v[172:175], v4 offset:29696
s_add_u32 s30, s30, 4096
buffer_load_dwordx4 v[112:115], v2, s[8:11], s30 offen offset:0 sc1
v_mfma_f32_32x32x16_bf16 v[144:159], v[180:183], v[72:75], v[144:159]
ds_read_b128 v[176:179], v4 offset:2048
s_waitcnt vmcnt(9)
v_mfma_f32_32x32x16_bf16 v[128:143], v[184:187], v[76:79], v[128:143]
ds_read_b128 v[180:183], v4 offset:30720
buffer_load_dwordx4 v[116:119], v2, s[8:11], s30 offen offset:1024 sc1
v_mfma_f32_32x32x16_bf16 v[144:159], v[188:191], v[76:79], v[144:159]
ds_read_b128 v[184:187], v4 offset:3072
s_waitcnt lgkmcnt(3)
s_waitcnt vmcnt(9)
v_mfma_f32_32x32x16_bf16 v[128:143], v[160:163], v[80:83], v[128:143]
ds_read_b128 v[188:191], v4 offset:31744
buffer_load_dwordx4 v[120:123], v2, s[8:11], s30 offen offset:2048 sc1
v_mfma_f32_32x32x16_bf16 v[144:159], v[164:167], v[80:83], v[144:159]
ds_read_b128 v[160:163], v4 offset:4096
s_waitcnt vmcnt(9)
v_mfma_f32_32x32x16_bf16 v[128:143], v[168:171], v[84:87], v[128:143]
ds_read_b128 v[164:167], v4 offset:32768
buffer_load_dwordx4 v[124:127], v2, s[8:11], s30 offen offset:3072 sc1
v_mfma_f32_32x32x16_bf16 v[144:159], v[172:175], v[84:87], v[144:159]
ds_read_b128 v[168:171], v4 offset:5120
s_waitcnt lgkmcnt(3)
s_waitcnt vmcnt(9)
v_mfma_f32_32x32x16_bf16 v[128:143], v[176:179], v[88:91], v[128:143]
ds_read_b128 v[172:175], v4 offset:33792
s_mov_b32 m0, s18
s_nop 0
buffer_load_dwordx4 v2, s[8:11], s17 offen offset:0 sc1 lds
v_mfma_f32_32x32x16_bf16 v[144:159], v[180:183], v[88:91], v[144:159]
ds_read_b128 v[176:179], v4 offset:6144
s_waitcnt vmcnt(9)
v_mfma_f32_32x32x16_bf16 v[128:143], v[184:187], v[92:95], v[128:143]
ds_read_b128 v[180:183], v4 offset:34816
buffer_load_dwordx4 v2, s[8:11], s17 offen offset:1024 sc1 lds
v_mfma_f32_32x32x16_bf16 v[144:159], v[188:191], v[92:95], v[144:159]
ds_read_b128 v[184:187], v4 offset:7168
s_waitcnt lgkmcnt(3)
s_waitcnt vmcnt(9)
v_mfma_f32_32x32x16_bf16 v[128:143], v[160:163], v[96:99], v[128:143]
ds_read_b128 v[188:191], v4 offset:35840
buffer_load_dwordx4 v2, s[8:11], s17 offen offset:2048 sc1 lds
v_mfma_f32_32x32x16_bf16 v[144:159], v[164:167], v[96:99], v[144:159]
ds_read_b128 v[160:163], v4 offset:8192
s_waitcnt vmcnt(9)
v_mfma_f32_32x32x16_bf16 v[128:143], v[168:171], v[100:103], v[128:143]
ds_read_b128 v[164:167], v4 offset:36864
buffer_load_dwordx4 v2, s[8:11], s17 offen offset:3072 sc1 lds
v_mfma_f32_32x32x16_bf16 v[144:159], v[172:175], v[100:103], v[144:159]
ds_read_b128 v[168:171], v4 offset:9216
s_waitcnt lgkmcnt(3)
s_waitcnt vmcnt(9)
v_mfma_f32_32x32x16_bf16 v[128:143], v[176:179], v[104:107], v[128:143]
ds_read_b128 v[172:175], v4 offset:37888
s_add_u32 s17, s17, 4096
s_add_u32 s18, s18, 4096
s_mov_b32 m0, s18
s_nop 0
buffer_load_dwordx4 v2, s[8:11], s17 offen offset:0 sc1 lds
v_mfma_f32_32x32x16_bf16 v[144:159], v[180:183], v[104:107], v[144:159]
ds_read_b128 v[176:179], v4 offset:10240
s_waitcnt vmcnt(9)
v_mfma_f32_32x32x16_bf16 v[128:143], v[184:187], v[108:111], v[128:143]
ds_read_b128 v[180:183], v4 offset:38912
buffer_load_dwordx4 v2, s[8:11], s17 offen offset:1024 sc1 lds
v_mfma_f32_32x32x16_bf16 v[144:159], v[188:191], v[108:111], v[144:159]
ds_read_b128 v[184:187], v4 offset:11264
s_waitcnt lgkmcnt(3)
s_waitcnt vmcnt(9)
v_mfma_f32_32x32x16_bf16 v[128:143], v[160:163], v[112:115], v[128:143]
ds_read_b128 v[188:191], v4 offset:39936
buffer_load_dwordx4 v2, s[8:11], s17 offen offset:2048 sc1 lds
v_mfma_f32_32x32x16_bf16 v[144:159], v[164:167], v[112:115], v[144:159]
ds_read_b128 v[160:163], v4 offset:40960
s_waitcnt vmcnt(9)
v_mfma_f32_32x32x16_bf16 v[128:143], v[168:171], v[116:119], v[128:143]
ds_read_b128 v[164:167], v4 offset:41984
v_mfma_f32_32x32x16_bf16 v[144:159], v[172:175], v[116:119], v[144:159]
ds_read_b128 v[168:171], v4 offset:43008
s_waitcnt lgkmcnt(3)
s_waitcnt vmcnt(8)
v_mfma_f32_32x32x16_bf16 v[128:143], v[176:179], v[120:123], v[128:143]
ds_read_b128 v[172:175], v4 offset:44032
v_mfma_f32_32x32x16_bf16 v[144:159], v[180:183], v[120:123], v[144:159]
ds_read_b128 v[176:179], v4 offset:45056
s_waitcnt vmcnt(7)
v_mfma_f32_32x32x16_bf16 v[128:143], v[184:187], v[124:127], v[128:143]
ds_read_b128 v[180:183], v4 offset:46080
v_mfma_f32_32x32x16_bf16 v[144:159], v[188:191], v[124:127], v[144:159]
ds_read_b128 v[184:187], v4 offset:47104
s_barrier
s_waitcnt lgkmcnt(3)
v_mfma_f32_32x32x16_bf16 v[212:227], v[160:163], v[16:19], 0
ds_read_b128 v[188:191], v4 offset:48128
s_mov_b32 m0, s16
s_nop 0
buffer_load_dwordx4 v2, s[8:11], s15 offen offset:0 sc1 lds
v_mfma_f32_32x32x16_bf16 v[212:227], v[164:167], v[20:23], v[212:227]
ds_read_b128 v[160:163], v4 offset:49152
v_mul_f32 v192, v128, v128
v_mul_f32 v193, v129, v129
v_mul_f32 v194, v130, v130
v_mul_f32 v195, v131, v131
v_mul_f32 v196, v132, v132
v_mfma_f32_32x32x16_bf16 v[212:227], v[168:171], v[24:27], v[212:227]
ds_read_b128 v[164:167], v4 offset:50176
buffer_load_dwordx4 v2, s[8:11], s15 offen offset:1024 sc1 lds
v_mul_f32 v197, v133, v133
v_mul_f32 v198, v134, v134
v_mul_f32 v199, v135, v135
v_fma_f32 v192, v192, s45, v14
v_mfma_f32_32x32x16_bf16 v[212:227], v[172:175], v[28:31], v[212:227]
ds_read_b128 v[168:171], v4 offset:51200
v_fma_f32 v193, v193, s45, v14
v_fma_f32 v194, v194, s45, v14
v_fma_f32 v195, v195, s45, v14
v_fma_f32 v196, v196, s45, v14
v_fma_f32 v197, v197, s45, v14
s_waitcnt lgkmcnt(3)
v_mfma_f32_32x32x16_bf16 v[212:227], v[176:179], v[32:35], v[212:227]
ds_read_b128 v[172:175], v4 offset:52224
buffer_load_dwordx4 v2, s[8:11], s15 offen offset:2048 sc1 lds
v_fma_f32 v198, v198, s45, v14
v_fma_f32 v199, v199, s45, v14
v_mul_f32 v192, v192, v128
v_mul_f32 v193, v193, v129
v_mfma_f32_32x32x16_bf16 v[212:227], v[180:183], v[36:39], v[212:227]
ds_read_b128 v[176:179], v4 offset:53248
v_mul_f32 v194, v194, v130
v_mul_f32 v195, v195, v131
v_mul_f32 v196, v196, v132
v_mul_f32 v197, v197, v133
v_mul_f32 v198, v198, v134
v_mfma_f32_32x32x16_bf16 v[212:227], v[184:187], v[40:43], v[212:227]
ds_read_b128 v[180:183], v4 offset:54272
buffer_load_dwordx4 v2, s[8:11], s15 offen offset:3072 sc1 lds
v_mul_f32 v199, v199, v135
v_exp_f32 v192, v192
v_mul_f32 v128, v128, v136
v_mfma_f32_32x32x16_bf16 v[212:227], v[188:191], v[44:47], v[212:227]
ds_read_b128 v[184:187], v4 offset:55296
v_exp_f32 v193, v193
v_mul_f32 v129, v129, v137
v_exp_f32 v194, v194
s_waitcnt lgkmcnt(3)
v_mfma_f32_32x32x16_bf16 v[212:227], v[160:163], v[48:51], v[212:227]
ds_read_b128 v[188:191], v4 offset:56320
s_add_u32 s15, s15, 4096
s_add_u32 s16, s16, 4096
s_mov_b32 m0, s16
s_nop 0
buffer_load_dwordx4 v2, s[8:11], s15 offen offset:0 sc1 lds
v_mul_f32 v130, v130, v138
v_exp_f32 v195, v195
v_mul_f32 v131, v131, v139
v_mfma_f32_32x32x16_bf16 v[212:227], v[164:167], v[52:55], v[212:227]
ds_read_b128 v[160:163], v4 offset:57344
v_exp_f32 v196, v196
v_mul_f32 v132, v132, v140
v_exp_f32 v197, v197
v_mfma_f32_32x32x16_bf16 v[212:227], v[168:171], v[56:59], v[212:227]
ds_read_b128 v[164:167], v4 offset:58368
buffer_load_dwordx4 v2, s[8:11], s15 offen offset:1024 sc1 lds
v_mul_f32 v133, v133, v141
v_exp_f32 v198, v198
v_mul_f32 v134, v134, v142
v_mfma_f32_32x32x16_bf16 v[212:227], v[172:175], v[60:63], v[212:227]
ds_read_b128 v[168:171], v4 offset:59392
v_exp_f32 v199, v199
v_mul_f32 v135, v135, v143
v_add_f32 v192, 1.0, v192
v_add_f32 v193, 1.0, v193
s_waitcnt lgkmcnt(3)
v_mfma_f32_32x32x16_bf16 v[212:227], v[176:179], v[64:67], v[212:227]
ds_read_b128 v[172:175], v4 offset:60416
buffer_load_dwordx4 v2, s[8:11], s15 offen offset:2048 sc1 lds
v_add_f32 v194, 1.0, v194
v_add_f32 v195, 1.0, v195
v_add_f32 v196, 1.0, v196
v_add_f32 v197, 1.0, v197
v_mfma_f32_32x32x16_bf16 v[212:227], v[180:183], v[68:71], v[212:227]
ds_read_b128 v[176:179], v4 offset:61440
v_add_f32 v198, 1.0, v198
v_add_f32 v199, 1.0, v199
v_rcp_f32 v192, v192
v_mfma_f32_32x32x16_bf16 v[212:227], v[184:187], v[72:75], v[212:227]
ds_read_b128 v[180:183], v4 offset:62464
s_add_u32 s15, s15, 24576
s_add_u32 s16, s16, 24576
s_mov_b32 m0, s16
s_nop 0
buffer_load_dwordx4 v2, s[8:11], s15 offen offset:0 sc1 lds
v_rcp_f32 v193, v193
v_rcp_f32 v194, v194
v_mfma_f32_32x32x16_bf16 v[212:227], v[188:191], v[76:79], v[212:227]
ds_read_b128 v[184:187], v4 offset:63488
v_rcp_f32 v195, v195
v_rcp_f32 v196, v196
s_waitcnt lgkmcnt(3)
v_mfma_f32_32x32x16_bf16 v[212:227], v[160:163], v[80:83], v[212:227]
ds_read_b128 v[188:191], v4 offset:64512
buffer_load_dwordx4 v2, s[8:11], s15 offen offset:1024 sc1 lds
v_rcp_f32 v197, v197
v_rcp_f32 v198, v198
v_mfma_f32_32x32x16_bf16 v[212:227], v[164:167], v[84:87], v[212:227]
ds_read_b128 v[160:163], v5 offset:0
v_rcp_f32 v199, v199
v_mul_f32 v128, v128, v192
v_mul_f32 v129, v129, v193
v_mul_f32 v130, v130, v194
v_mfma_f32_32x32x16_bf16 v[212:227], v[168:171], v[88:91], v[212:227]
ds_read_b128 v[164:167], v5 offset:1024
buffer_load_dwordx4 v2, s[8:11], s15 offen offset:2048 sc1 lds
v_mul_f32 v131, v131, v195
v_mul_f32 v132, v132, v196
v_mul_f32 v133, v133, v197
v_mul_f32 v134, v134, v198
v_mfma_f32_32x32x16_bf16 v[212:227], v[172:175], v[92:95], v[212:227]
ds_read_b128 v[168:171], v5 offset:2048
v_mul_f32 v135, v135, v199
v_cvt_pk_bf16_f32 v200, v128, v129
v_cvt_pk_bf16_f32 v201, v130, v131
v_cvt_pk_bf16_f32 v202, v132, v133
v_cvt_pk_bf16_f32 v203, v134, v135
s_waitcnt lgkmcnt(3)
v_mfma_f32_32x32x16_bf16 v[212:227], v[176:179], v[96:99], v[212:227]
ds_read_b128 v[172:175], v5 offset:3072
buffer_load_dwordx4 v2, s[8:11], s15 offen offset:3072 sc1 lds
s_add_u32 s28, s7, 0
buffer_store_dwordx4 v[200:203], v2, s[8:11], s28 offen sc1
v_mfma_f32_32x32x16_bf16 v[212:227], v[180:183], v[100:103], v[212:227]
ds_read_b128 v[176:179], v5 offset:4096
v_mul_f32 v192, v144, v144
v_mul_f32 v193, v145, v145
v_mul_f32 v194, v146, v146
v_mul_f32 v195, v147, v147
v_mul_f32 v196, v148, v148
v_mfma_f32_32x32x16_bf16 v[212:227], v[184:187], v[104:107], v[212:227]
ds_read_b128 v[180:183], v5 offset:5120
s_add_u32 s15, s15, 4096
s_add_u32 s16, s16, 4096
s_mov_b32 m0, s16
s_nop 0
buffer_load_dwordx4 v2, s[8:11], s15 offen offset:0 sc1 lds
v_mul_f32 v197, v149, v149
v_mul_f32 v198, v150, v150
v_mul_f32 v199, v151, v151
v_fma_f32 v192, v192, s45, v14
v_mfma_f32_32x32x16_bf16 v[212:227], v[188:191], v[108:111], v[212:227]
ds_read_b128 v[184:187], v5 offset:6144
v_fma_f32 v193, v193, s45, v14
v_fma_f32 v194, v194, s45, v14
v_fma_f32 v195, v195, s45, v14
v_fma_f32 v196, v196, s45, v14
v_fma_f32 v197, v197, s45, v14
s_waitcnt lgkmcnt(3)
v_mfma_f32_32x32x16_bf16 v[212:227], v[160:163], v[112:115], v[212:227]
ds_read_b128 v[188:191], v5 offset:7168
buffer_load_dwordx4 v2, s[8:11], s15 offen offset:1024 sc1 lds
v_fma_f32 v198, v198, s45, v14
v_fma_f32 v199, v199, s45, v14
v_mul_f32 v192, v192, v144
v_mul_f32 v193, v193, v145
v_mfma_f32_32x32x16_bf16 v[212:227], v[164:167], v[116:119], v[212:227]
ds_read_b128 v[160:163], v5 offset:8192
v_mul_f32 v194, v194, v146
v_mul_f32 v195, v195, v147
v_mul_f32 v196, v196, v148
v_mul_f32 v197, v197, v149
v_mul_f32 v198, v198, v150
v_mfma_f32_32x32x16_bf16 v[212:227], v[168:171], v[120:123], v[212:227]
ds_read_b128 v[164:167], v5 offset:9216
buffer_load_dwordx4 v2, s[8:11], s15 offen offset:2048 sc1 lds
v_mul_f32 v199, v199, v151
v_exp_f32 v192, v192
v_mul_f32 v144, v144, v152
v_mfma_f32_32x32x16_bf16 v[212:227], v[172:175], v[124:127], v[212:227]
ds_read_b128 v[168:171], v5 offset:10240
v_exp_f32 v193, v193
v_mul_f32 v145, v145, v153
v_exp_f32 v194, v194
s_waitcnt lgkmcnt(3)
v_mfma_f32_32x32x16_bf16 v[128:143], v[176:179], v[16:19], 0
ds_read_b128 v[172:175], v5 offset:11264
v_mul_f32 v146, v146, v154
v_exp_f32 v195, v195
v_mul_f32 v147, v147, v155
v_mfma_f32_32x32x16_bf16 v[128:143], v[180:183], v[20:23], v[128:143]
ds_read_b128 v[176:179], v5 offset:12288
v_exp_f32 v196, v196
v_mul_f32 v148, v148, v156
v_exp_f32 v197, v197
v_mfma_f32_32x32x16_bf16 v[128:143], v[184:187], v[24:27], v[128:143]
ds_read_b128 v[180:183], v5 offset:13312
v_mul_f32 v149, v149, v157
v_exp_f32 v198, v198
v_mul_f32 v150, v150, v158
v_mfma_f32_32x32x16_bf16 v[128:143], v[188:191], v[28:31], v[128:143]
ds_read_b128 v[184:187], v5 offset:14336
v_exp_f32 v199, v199
v_mul_f32 v151, v151, v159
v_add_f32 v192, 1.0, v192
v_add_f32 v193, 1.0, v193
s_waitcnt lgkmcnt(3)
v_mfma_f32_32x32x16_bf16 v[128:143], v[160:163], v[32:35], v[128:143]
ds_read_b128 v[188:191], v5 offset:15360
v_add_f32 v194, 1.0, v194
v_add_f32 v195, 1.0, v195
v_add_f32 v196, 1.0, v196
v_add_f32 v197, 1.0, v197
v_add_f32 v198, 1.0, v198
v_mfma_f32_32x32x16_bf16 v[128:143], v[164:167], v[36:39], v[128:143]
ds_read_b128 v[160:163], v5 offset:16384
v_add_f32 v199, 1.0, v199
v_rcp_f32 v192, v192
v_rcp_f32 v193, v193
v_mfma_f32_32x32x16_bf16 v[128:143], v[168:171], v[40:43], v[128:143]
ds_read_b128 v[164:167], v5 offset:17408
v_rcp_f32 v194, v194
v_rcp_f32 v195, v195
v_mfma_f32_32x32x16_bf16 v[128:143], v[172:175], v[44:47], v[128:143]
ds_read_b128 v[168:171], v5 offset:18432
v_rcp_f32 v196, v196
v_rcp_f32 v197, v197
s_waitcnt lgkmcnt(3)
v_mfma_f32_32x32x16_bf16 v[128:143], v[176:179], v[48:51], v[128:143]
ds_read_b128 v[172:175], v5 offset:19456
v_rcp_f32 v198, v198
v_rcp_f32 v199, v199
v_mul_f32 v144, v144, v192
v_mfma_f32_32x32x16_bf16 v[128:143], v[180:183], v[52:55], v[128:143]
ds_read_b128 v[176:179], v5 offset:20480
v_mul_f32 v145, v145, v193
v_mul_f32 v146, v146, v194
v_mul_f32 v147, v147, v195
v_mul_f32 v148, v148, v196
v_mul_f32 v149, v149, v197
v_mfma_f32_32x32x16_bf16 v[128:143], v[184:187], v[56:59], v[128:143]
ds_read_b128 v[180:183], v5 offset:21504
v_mul_f32 v150, v150, v198
v_mul_f32 v151, v151, v199
v_cvt_pk_bf16_f32 v200, v144, v145
v_cvt_pk_bf16_f32 v201, v146, v147
v_cvt_pk_bf16_f32 v202, v148, v149
v_mfma_f32_32x32x16_bf16 v[128:143], v[188:191], v[60:63], v[128:143]
ds_read_b128 v[184:187], v5 offset:22528
v_cvt_pk_bf16_f32 v203, v150, v151
s_add_u32 s28, s7, 1024
buffer_store_dwordx4 v[200:203], v2, s[8:11], s28 offen sc1
s_waitcnt lgkmcnt(3)
v_mfma_f32_32x32x16_bf16 v[128:143], v[160:163], v[64:67], v[128:143]
ds_read_b128 v[188:191], v5 offset:23552
v_mul_f32 v192, v212, v212
v_mul_f32 v193, v213, v213
v_mul_f32 v194, v214, v214
v_mul_f32 v195, v215, v215
v_mul_f32 v196, v216, v216
v_mfma_f32_32x32x16_bf16 v[128:143], v[164:167], v[68:71], v[128:143]
ds_read_b128 v[160:163], v5 offset:24576
v_mul_f32 v197, v217, v217
v_mul_f32 v198, v218, v218
v_mul_f32 v199, v219, v219
v_fma_f32 v192, v192, s45, v14
v_fma_f32 v193, v193, s45, v14
v_mfma_f32_32x32x16_bf16 v[128:143], v[168:171], v[72:75], v[128:143]
ds_read_b128 v[164:167], v5 offset:25600
v_fma_f32 v194, v194, s45, v14
v_fma_f32 v195, v195, s45, v14
v_fma_f32 v196, v196, s45, v14
v_fma_f32 v197, v197, s45, v14
v_fma_f32 v198, v198, s45, v14
v_mfma_f32_32x32x16_bf16 v[128:143], v[172:175], v[76:79], v[128:143]
ds_read_b128 v[168:171], v5 offset:26624
v_fma_f32 v199, v199, s45, v14
v_mul_f32 v192, v192, v212
v_mul_f32 v193, v193, v213
v_mul_f32 v194, v194, v214
v_mul_f32 v195, v195, v215
s_waitcnt lgkmcnt(3)
v_mfma_f32_32x32x16_bf16 v[128:143], v[176:179], v[80:83], v[128:143]
ds_read_b128 v[172:175], v5 offset:27648
v_mul_f32 v196, v196, v216
v_mul_f32 v197, v197, v217
v_mul_f32 v198, v198, v218
v_mul_f32 v199, v199, v219
v_mfma_f32_32x32x16_bf16 v[128:143], v[180:183], v[84:87], v[128:143]
ds_read_b128 v[176:179], v5 offset:28672
v_exp_f32 v192, v192
v_mul_f32 v212, v212, v220
v_exp_f32 v193, v193
v_mfma_f32_32x32x16_bf16 v[128:143], v[184:187], v[88:91], v[128:143]
ds_read_b128 v[180:183], v5 offset:29696
v_mul_f32 v213, v213, v221
v_exp_f32 v194, v194
v_mul_f32 v214, v214, v222
v_mfma_f32_32x32x16_bf16 v[128:143], v[188:191], v[92:95], v[128:143]
ds_read_b128 v[184:187], v5 offset:30720
v_exp_f32 v195, v195
v_mul_f32 v215, v215, v223
v_exp_f32 v196, v196
s_waitcnt vmcnt(16)
s_barrier
s_waitcnt lgkmcnt(3)
v_mfma_f32_32x32x16_bf16 v[128:143], v[160:163], v[96:99], v[128:143]
ds_read_b128 v[188:191], v5 offset:31744
v_mul_f32 v216, v216, v224
v_exp_f32 v197, v197
v_mul_f32 v217, v217, v225
v_mfma_f32_32x32x16_bf16 v[128:143], v[164:167], v[100:103], v[128:143]
ds_read_b128 v[160:163], v3 offset:0
v_exp_f32 v198, v198
v_mul_f32 v218, v218, v226
v_exp_f32 v199, v199
v_mfma_f32_32x32x16_bf16 v[128:143], v[168:171], v[104:107], v[128:143]
ds_read_b128 v[164:167], v3 offset:1024
v_mul_f32 v219, v219, v227
v_add_f32 v192, 1.0, v192
v_add_f32 v193, 1.0, v193
v_add_f32 v194, 1.0, v194
v_add_f32 v195, 1.0, v195
v_mfma_f32_32x32x16_bf16 v[128:143], v[172:175], v[108:111], v[128:143]
ds_read_b128 v[168:171], v3 offset:2048
v_add_f32 v196, 1.0, v196
v_add_f32 v197, 1.0, v197
v_add_f32 v198, 1.0, v198
v_add_f32 v199, 1.0, v199
s_waitcnt lgkmcnt(3)
v_mfma_f32_32x32x16_bf16 v[128:143], v[176:179], v[112:115], v[128:143]
ds_read_b128 v[172:175], v3 offset:3072
v_rcp_f32 v192, v192
v_rcp_f32 v193, v193
v_mfma_f32_32x32x16_bf16 v[128:143], v[180:183], v[116:119], v[128:143]
ds_read_b128 v[176:179], v3 offset:4096
v_rcp_f32 v194, v194
v_rcp_f32 v195, v195
v_mfma_f32_32x32x16_bf16 v[128:143], v[184:187], v[120:123], v[128:143]
ds_read_b128 v[180:183], v3 offset:5120
v_rcp_f32 v196, v196
v_rcp_f32 v197, v197
v_mfma_f32_32x32x16_bf16 v[128:143], v[188:191], v[124:127], v[128:143]
ds_read_b128 v[184:187], v3 offset:6144
v_rcp_f32 v198, v198
v_rcp_f32 v199, v199
v_mul_f32 v212, v212, v192
s_waitcnt lgkmcnt(3)
v_mfma_f32_32x32x16_bf16 v[144:159], v[160:163], v[16:19], 0
ds_read_b128 v[188:191], v3 offset:7168
v_mul_f32 v213, v213, v193
v_mul_f32 v214, v214, v194
v_mul_f32 v215, v215, v195
v_mul_f32 v216, v216, v196
v_mul_f32 v217, v217, v197
v_mfma_f32_32x32x16_bf16 v[144:159], v[164:167], v[20:23], v[144:159]
ds_read_b128 v[160:163], v3 offset:8192
v_mul_f32 v218, v218, v198
v_mul_f32 v219, v219, v199
v_cvt_pk_bf16_f32 v200, v212, v213
v_cvt_pk_bf16_f32 v201, v214, v215
v_cvt_pk_bf16_f32 v202, v216, v217
v_mfma_f32_32x32x16_bf16 v[144:159], v[168:171], v[24:27], v[144:159]
ds_read_b128 v[164:167], v3 offset:9216
v_cvt_pk_bf16_f32 v203, v218, v219
s_add_u32 s28, s7, 2048
buffer_store_dwordx4 v[200:203], v2, s[8:11], s28 offen sc1
v_mfma_f32_32x32x16_bf16 v[144:159], v[172:175], v[28:31], v[144:159]
ds_read_b128 v[168:171], v3 offset:10240
v_mul_f32 v192, v128, v128
v_mul_f32 v193, v129, v129
v_mul_f32 v194, v130, v130
v_mul_f32 v195, v131, v131
v_mul_f32 v196, v132, v132
s_waitcnt lgkmcnt(3)
v_mfma_f32_32x32x16_bf16 v[144:159], v[176:179], v[32:35], v[144:159]
ds_read_b128 v[172:175], v3 offset:11264
v_mul_f32 v197, v133, v133
v_mul_f32 v198, v134, v134
v_mul_f32 v199, v135, v135
v_fma_f32 v192, v192, s45, v14
v_fma_f32 v193, v193, s45, v14
v_mfma_f32_32x32x16_bf16 v[144:159], v[180:183], v[36:39], v[144:159]
ds_read_b128 v[176:179], v3 offset:12288
v_fma_f32 v194, v194, s45, v14
v_fma_f32 v195, v195, s45, v14
v_fma_f32 v196, v196, s45, v14
v_fma_f32 v197, v197, s45, v14
v_fma_f32 v198, v198, s45, v14
v_mfma_f32_32x32x16_bf16 v[144:159], v[184:187], v[40:43], v[144:159]
ds_read_b128 v[180:183], v3 offset:13312
v_fma_f32 v199, v199, s45, v14
v_mul_f32 v192, v192, v128
v_mul_f32 v193, v193, v129
v_mul_f32 v194, v194, v130
v_mul_f32 v195, v195, v131
v_mfma_f32_32x32x16_bf16 v[144:159], v[188:191], v[44:47], v[144:159]
ds_read_b128 v[184:187], v3 offset:14336
v_mul_f32 v196, v196, v132
v_mul_f32 v197, v197, v133
v_mul_f32 v198, v198, v134
v_mul_f32 v199, v199, v135
s_waitcnt lgkmcnt(3)
v_mfma_f32_32x32x16_bf16 v[144:159], v[160:163], v[48:51], v[144:159]
ds_read_b128 v[188:191], v3 offset:15360
v_exp_f32 v192, v192
v_mul_f32 v128, v128, v136
v_exp_f32 v193, v193
v_mfma_f32_32x32x16_bf16 v[144:159], v[164:167], v[52:55], v[144:159]
ds_read_b128 v[160:163], v3 offset:16384
v_mul_f32 v129, v129, v137
v_exp_f32 v194, v194
v_mul_f32 v130, v130, v138
v_mfma_f32_32x32x16_bf16 v[144:159], v[168:171], v[56:59], v[144:159]
ds_read_b128 v[164:167], v3 offset:17408
v_exp_f32 v195, v195
v_mul_f32 v131, v131, v139
v_exp_f32 v196, v196
v_mfma_f32_32x32x16_bf16 v[144:159], v[172:175], v[60:63], v[144:159]
ds_read_b128 v[168:171], v3 offset:18432
v_mul_f32 v132, v132, v140
v_exp_f32 v197, v197
v_mul_f32 v133, v133, v141
s_waitcnt lgkmcnt(3)
v_mfma_f32_32x32x16_bf16 v[144:159], v[176:179], v[64:67], v[144:159]
ds_read_b128 v[172:175], v3 offset:19456
v_exp_f32 v198, v198
v_mul_f32 v134, v134, v142
v_exp_f32 v199, v199
v_mfma_f32_32x32x16_bf16 v[144:159], v[180:183], v[68:71], v[144:159]
ds_read_b128 v[176:179], v3 offset:20480
v_mul_f32 v135, v135, v143
v_add_f32 v192, 1.0, v192
v_add_f32 v193, 1.0, v193
v_add_f32 v194, 1.0, v194
v_add_f32 v195, 1.0, v195
v_mfma_f32_32x32x16_bf16 v[144:159], v[184:187], v[72:75], v[144:159]
ds_read_b128 v[180:183], v3 offset:21504
v_add_f32 v196, 1.0, v196
v_add_f32 v197, 1.0, v197
v_add_f32 v198, 1.0, v198
v_add_f32 v199, 1.0, v199
v_mfma_f32_32x32x16_bf16 v[144:159], v[188:191], v[76:79], v[144:159]
ds_read_b128 v[184:187], v3 offset:22528
v_rcp_f32 v192, v192
v_rcp_f32 v193, v193
s_waitcnt lgkmcnt(3)
v_mfma_f32_32x32x16_bf16 v[144:159], v[160:163], v[80:83], v[144:159]
ds_read_b128 v[188:191], v3 offset:23552
v_rcp_f32 v194, v194
v_rcp_f32 v195, v195
v_mfma_f32_32x32x16_bf16 v[144:159], v[164:167], v[84:87], v[144:159]
ds_read_b128 v[160:163], v3 offset:24576
v_rcp_f32 v196, v196
v_rcp_f32 v197, v197
v_mfma_f32_32x32x16_bf16 v[144:159], v[168:171], v[88:91], v[144:159]
ds_read_b128 v[164:167], v3 offset:25600
v_rcp_f32 v198, v198
v_rcp_f32 v199, v199
v_mul_f32 v128, v128, v192
v_mfma_f32_32x32x16_bf16 v[144:159], v[172:175], v[92:95], v[144:159]
ds_read_b128 v[168:171], v3 offset:26624
v_mul_f32 v129, v129, v193
v_mul_f32 v130, v130, v194
v_mul_f32 v131, v131, v195
v_mul_f32 v132, v132, v196
v_mul_f32 v133, v133, v197
s_waitcnt vmcnt(2)
s_barrier
s_waitcnt lgkmcnt(3)
v_mfma_f32_32x32x16_bf16 v[144:159], v[176:179], v[96:99], v[144:159]
ds_read_b128 v[172:175], v3 offset:27648
v_mul_f32 v134, v134, v198
v_mul_f32 v135, v135, v199
v_cvt_pk_bf16_f32 v200, v128, v129
v_cvt_pk_bf16_f32 v201, v130, v131
v_cvt_pk_bf16_f32 v202, v132, v133
v_mfma_f32_32x32x16_bf16 v[144:159], v[180:183], v[100:103], v[144:159]
ds_read_b128 v[176:179], v3 offset:49152
v_cvt_pk_bf16_f32 v203, v134, v135
s_add_u32 s28, s7, 3072
buffer_store_dwordx4 v[200:203], v2, s[8:11], s28 offen sc1
v_mfma_f32_32x32x16_bf16 v[144:159], v[184:187], v[104:107], v[144:159]
ds_read_b128 v[180:183], v3 offset:50176
v_mfma_f32_32x32x16_bf16 v[144:159], v[188:191], v[108:111], v[144:159]
ds_read_b128 v[184:187], v3 offset:51200
s_waitcnt lgkmcnt(3)
v_mfma_f32_32x32x16_bf16 v[144:159], v[160:163], v[112:115], v[144:159]
ds_read_b128 v[188:191], v3 offset:52224
v_mfma_f32_32x32x16_bf16 v[144:159], v[164:167], v[116:119], v[144:159]
ds_read_b128 v[160:163], v3 offset:53248
v_mfma_f32_32x32x16_bf16 v[144:159], v[168:171], v[120:123], v[144:159]
ds_read_b128 v[164:167], v3 offset:54272
v_mfma_f32_32x32x16_bf16 v[144:159], v[172:175], v[124:127], v[144:159]
ds_read_b128 v[168:171], v3 offset:55296
s_waitcnt lgkmcnt(3)
v_mfma_f32_32x32x16_bf16 v[212:227], v[176:179], v[16:19], 0
ds_read_b128 v[172:175], v3 offset:56320
v_mfma_f32_32x32x16_bf16 v[212:227], v[180:183], v[20:23], v[212:227]
ds_read_b128 v[176:179], v3 offset:57344
v_mfma_f32_32x32x16_bf16 v[212:227], v[184:187], v[24:27], v[212:227]
ds_read_b128 v[180:183], v3 offset:58368
s_nop 3
v_mul_f32 v192, v144, v144
v_mul_f32 v193, v145, v145
v_mul_f32 v194, v146, v146
v_mul_f32 v195, v147, v147
v_mul_f32 v196, v148, v148
v_mfma_f32_32x32x16_bf16 v[212:227], v[188:191], v[28:31], v[212:227]
ds_read_b128 v[184:187], v3 offset:59392
v_mul_f32 v197, v149, v149
v_mul_f32 v198, v150, v150
v_mul_f32 v199, v151, v151
v_fma_f32 v192, v192, s45, v14
v_fma_f32 v193, v193, s45, v14
s_waitcnt lgkmcnt(3)
v_mfma_f32_32x32x16_bf16 v[212:227], v[160:163], v[32:35], v[212:227]
ds_read_b128 v[188:191], v3 offset:60416
v_fma_f32 v194, v194, s45, v14
v_fma_f32 v195, v195, s45, v14
v_fma_f32 v196, v196, s45, v14
v_fma_f32 v197, v197, s45, v14
v_fma_f32 v198, v198, s45, v14
v_mfma_f32_32x32x16_bf16 v[212:227], v[164:167], v[36:39], v[212:227]
ds_read_b128 v[160:163], v3 offset:61440
v_fma_f32 v199, v199, s45, v14
v_mul_f32 v192, v192, v144
v_mul_f32 v193, v193, v145
v_mul_f32 v194, v194, v146
v_mul_f32 v195, v195, v147
v_mfma_f32_32x32x16_bf16 v[212:227], v[168:171], v[40:43], v[212:227]
ds_read_b128 v[164:167], v3 offset:62464
v_mul_f32 v196, v196, v148
v_mul_f32 v197, v197, v149
v_mul_f32 v198, v198, v150
v_mul_f32 v199, v199, v151
v_mfma_f32_32x32x16_bf16 v[212:227], v[172:175], v[44:47], v[212:227]
ds_read_b128 v[168:171], v3 offset:63488
v_exp_f32 v192, v192
v_mul_f32 v144, v144, v152
v_exp_f32 v193, v193
s_waitcnt lgkmcnt(3)
v_mfma_f32_32x32x16_bf16 v[212:227], v[176:179], v[48:51], v[212:227]
ds_read_b128 v[172:175], v3 offset:64512
v_mul_f32 v145, v145, v153
v_exp_f32 v194, v194
v_mul_f32 v146, v146, v154
v_mfma_f32_32x32x16_bf16 v[212:227], v[180:183], v[52:55], v[212:227]
ds_read_b128 v[176:179], v4 offset:0
v_exp_f32 v195, v195
v_mul_f32 v147, v147, v155
v_exp_f32 v196, v196
v_mfma_f32_32x32x16_bf16 v[212:227], v[184:187], v[56:59], v[212:227]
ds_read_b128 v[180:183], v4 offset:1024
v_mul_f32 v148, v148, v156
v_exp_f32 v197, v197
v_mul_f32 v149, v149, v157
v_mfma_f32_32x32x16_bf16 v[212:227], v[188:191], v[60:63], v[212:227]
ds_read_b128 v[184:187], v4 offset:2048
v_exp_f32 v198, v198
v_mul_f32 v150, v150, v158
v_exp_f32 v199, v199
s_waitcnt lgkmcnt(3)
v_mfma_f32_32x32x16_bf16 v[212:227], v[160:163], v[64:67], v[212:227]
ds_read_b128 v[188:191], v4 offset:3072
v_mul_f32 v151, v151, v159
v_add_f32 v192, 1.0, v192
v_add_f32 v193, 1.0, v193
v_add_f32 v194, 1.0, v194
v_add_f32 v195, 1.0, v195
v_mfma_f32_32x32x16_bf16 v[212:227], v[164:167], v[68:71], v[212:227]
ds_read_b128 v[160:163], v4 offset:4096
v_add_f32 v196, 1.0, v196
v_add_f32 v197, 1.0, v197
v_add_f32 v198, 1.0, v198
v_add_f32 v199, 1.0, v199
v_mfma_f32_32x32x16_bf16 v[212:227], v[168:171], v[72:75], v[212:227]
ds_read_b128 v[164:167], v4 offset:5120
v_rcp_f32 v192, v192
v_rcp_f32 v193, v193
v_mfma_f32_32x32x16_bf16 v[212:227], v[172:175], v[76:79], v[212:227]
ds_read_b128 v[168:171], v4 offset:6144
v_rcp_f32 v194, v194
v_rcp_f32 v195, v195
s_waitcnt lgkmcnt(3)
v_mfma_f32_32x32x16_bf16 v[212:227], v[176:179], v[80:83], v[212:227]
ds_read_b128 v[172:175], v4 offset:7168
v_rcp_f32 v196, v196
v_rcp_f32 v197, v197
v_mfma_f32_32x32x16_bf16 v[212:227], v[180:183], v[84:87], v[212:227]
ds_read_b128 v[176:179], v4 offset:8192
v_rcp_f32 v198, v198
v_rcp_f32 v199, v199
v_mul_f32 v144, v144, v192
v_mfma_f32_32x32x16_bf16 v[212:227], v[184:187], v[88:91], v[212:227]
ds_read_b128 v[180:183], v4 offset:9216
v_mul_f32 v145, v145, v193
v_mul_f32 v146, v146, v194
v_mul_f32 v147, v147, v195
v_mul_f32 v148, v148, v196
v_mul_f32 v149, v149, v197
v_mfma_f32_32x32x16_bf16 v[212:227], v[188:191], v[92:95], v[212:227]
ds_read_b128 v[184:187], v4 offset:10240
v_mul_f32 v150, v150, v198
v_mul_f32 v151, v151, v199
v_cvt_pk_bf16_f32 v200, v144, v145
v_cvt_pk_bf16_f32 v201, v146, v147
v_cvt_pk_bf16_f32 v202, v148, v149
s_waitcnt lgkmcnt(3)
v_mfma_f32_32x32x16_bf16 v[212:227], v[160:163], v[96:99], v[212:227]
ds_read_b128 v[188:191], v4 offset:11264
v_cvt_pk_bf16_f32 v203, v150, v151
s_add_u32 s28, s7, 4096
buffer_store_dwordx4 v[200:203], v2, s[8:11], s28 offen sc1
v_mfma_f32_32x32x16_bf16 v[212:227], v[164:167], v[100:103], v[212:227]
ds_read_b128 v[160:163], v4 offset:12288
v_mfma_f32_32x32x16_bf16 v[212:227], v[168:171], v[104:107], v[212:227]
ds_read_b128 v[164:167], v4 offset:13312
v_mfma_f32_32x32x16_bf16 v[212:227], v[172:175], v[108:111], v[212:227]
ds_read_b128 v[168:171], v4 offset:14336
s_waitcnt lgkmcnt(3)
v_mfma_f32_32x32x16_bf16 v[212:227], v[176:179], v[112:115], v[212:227]
ds_read_b128 v[172:175], v4 offset:15360
s_mov_b32 s32, 13631488
buffer_load_dword v239, v238, s[8:11], s32 offen sc1
v_mfma_f32_32x32x16_bf16 v[212:227], v[180:183], v[116:119], v[212:227]
ds_read_b128 v[176:179], v4 offset:16384
v_mfma_f32_32x32x16_bf16 v[212:227], v[184:187], v[120:123], v[212:227]
ds_read_b128 v[180:183], v4 offset:17408
v_mfma_f32_32x32x16_bf16 v[212:227], v[188:191], v[124:127], v[212:227]
ds_read_b128 v[184:187], v4 offset:18432
s_waitcnt lgkmcnt(3)
v_mfma_f32_32x32x16_bf16 v[128:143], v[160:163], v[16:19], 0
ds_read_b128 v[188:191], v4 offset:19456
v_mfma_f32_32x32x16_bf16 v[128:143], v[164:167], v[20:23], v[128:143]
ds_read_b128 v[160:163], v4 offset:20480
v_mfma_f32_32x32x16_bf16 v[128:143], v[168:171], v[24:27], v[128:143]
ds_read_b128 v[164:167], v4 offset:21504
s_nop 3
v_mul_f32 v192, v212, v212
v_mul_f32 v193, v213, v213
v_mul_f32 v194, v214, v214
v_mul_f32 v195, v215, v215
v_mul_f32 v196, v216, v216
v_mfma_f32_32x32x16_bf16 v[128:143], v[172:175], v[28:31], v[128:143]
ds_read_b128 v[168:171], v4 offset:22528
v_mul_f32 v197, v217, v217
v_mul_f32 v198, v218, v218
v_mul_f32 v199, v219, v219
v_fma_f32 v192, v192, s45, v14
v_fma_f32 v193, v193, s45, v14
s_waitcnt lgkmcnt(3)
v_mfma_f32_32x32x16_bf16 v[128:143], v[176:179], v[32:35], v[128:143]
ds_read_b128 v[172:175], v4 offset:23552
v_fma_f32 v194, v194, s45, v14
v_fma_f32 v195, v195, s45, v14
v_fma_f32 v196, v196, s45, v14
v_fma_f32 v197, v197, s45, v14
v_fma_f32 v198, v198, s45, v14
v_mfma_f32_32x32x16_bf16 v[128:143], v[180:183], v[36:39], v[128:143]
ds_read_b128 v[176:179], v4 offset:24576
v_fma_f32 v199, v199, s45, v14
v_mul_f32 v192, v192, v212
v_mul_f32 v193, v193, v213
v_mul_f32 v194, v194, v214
v_mul_f32 v195, v195, v215
v_mfma_f32_32x32x16_bf16 v[128:143], v[184:187], v[40:43], v[128:143]
ds_read_b128 v[180:183], v4 offset:25600
v_mul_f32 v196, v196, v216
v_mul_f32 v197, v197, v217
v_mul_f32 v198, v198, v218
v_mul_f32 v199, v199, v219
v_mfma_f32_32x32x16_bf16 v[128:143], v[188:191], v[44:47], v[128:143]
ds_read_b128 v[184:187], v4 offset:26624
v_exp_f32 v192, v192
v_mul_f32 v212, v212, v220
v_exp_f32 v193, v193
s_waitcnt lgkmcnt(3)
v_mfma_f32_32x32x16_bf16 v[128:143], v[160:163], v[48:51], v[128:143]
ds_read_b128 v[188:191], v4 offset:27648
v_mul_f32 v213, v213, v221
v_exp_f32 v194, v194
v_mul_f32 v214, v214, v222
v_mfma_f32_32x32x16_bf16 v[128:143], v[164:167], v[52:55], v[128:143]
ds_read_b128 v[160:163], v4 offset:28672
v_exp_f32 v195, v195
v_mul_f32 v215, v215, v223
v_exp_f32 v196, v196
v_mfma_f32_32x32x16_bf16 v[128:143], v[168:171], v[56:59], v[128:143]
ds_read_b128 v[164:167], v4 offset:29696
v_mul_f32 v216, v216, v224
v_exp_f32 v197, v197
v_mul_f32 v217, v217, v225
v_mfma_f32_32x32x16_bf16 v[128:143], v[172:175], v[60:63], v[128:143]
ds_read_b128 v[168:171], v4 offset:30720
v_exp_f32 v198, v198
v_mul_f32 v218, v218, v226
v_exp_f32 v199, v199
s_waitcnt lgkmcnt(3)
v_mfma_f32_32x32x16_bf16 v[128:143], v[176:179], v[64:67], v[128:143]
ds_read_b128 v[172:175], v4 offset:31744
v_mul_f32 v219, v219, v227
v_add_f32 v192, 1.0, v192
v_add_f32 v193, 1.0, v193
v_add_f32 v194, 1.0, v194
v_add_f32 v195, 1.0, v195
v_mfma_f32_32x32x16_bf16 v[128:143], v[180:183], v[68:71], v[128:143]
ds_read_b128 v[176:179], v4 offset:32768
v_add_f32 v196, 1.0, v196
v_add_f32 v197, 1.0, v197
v_add_f32 v198, 1.0, v198
v_add_f32 v199, 1.0, v199
v_mfma_f32_32x32x16_bf16 v[128:143], v[184:187], v[72:75], v[128:143]
ds_read_b128 v[180:183], v4 offset:33792
v_rcp_f32 v192, v192
v_rcp_f32 v193, v193
v_mfma_f32_32x32x16_bf16 v[128:143], v[188:191], v[76:79], v[128:143]
ds_read_b128 v[184:187], v4 offset:34816
v_rcp_f32 v194, v194
v_rcp_f32 v195, v195
s_waitcnt lgkmcnt(3)
v_mfma_f32_32x32x16_bf16 v[128:143], v[160:163], v[80:83], v[128:143]
ds_read_b128 v[188:191], v4 offset:35840
v_rcp_f32 v196, v196
v_rcp_f32 v197, v197
v_mfma_f32_32x32x16_bf16 v[128:143], v[164:167], v[84:87], v[128:143]
ds_read_b128 v[160:163], v4 offset:36864
v_rcp_f32 v198, v198
v_rcp_f32 v199, v199
v_mul_f32 v212, v212, v192
v_mfma_f32_32x32x16_bf16 v[128:143], v[168:171], v[88:91], v[128:143]
ds_read_b128 v[164:167], v4 offset:37888
v_mul_f32 v213, v213, v193
v_mul_f32 v214, v214, v194
v_mul_f32 v215, v215, v195
v_mul_f32 v216, v216, v196
v_mul_f32 v217, v217, v197
v_mfma_f32_32x32x16_bf16 v[128:143], v[172:175], v[92:95], v[128:143]
ds_read_b128 v[168:171], v4 offset:38912
v_mul_f32 v218, v218, v198
v_mul_f32 v219, v219, v199
v_cvt_pk_bf16_f32 v204, v212, v213
v_cvt_pk_bf16_f32 v205, v214, v215
v_cvt_pk_bf16_f32 v206, v216, v217
s_waitcnt lgkmcnt(3)
v_mfma_f32_32x32x16_bf16 v[128:143], v[176:179], v[96:99], v[128:143]
ds_read_b128 v[172:175], v4 offset:39936
v_cvt_pk_bf16_f32 v207, v218, v219
v_mfma_f32_32x32x16_bf16 v[128:143], v[180:183], v[100:103], v[128:143]
v_mfma_f32_32x32x16_bf16 v[128:143], v[184:187], v[104:107], v[128:143]
v_mfma_f32_32x32x16_bf16 v[128:143], v[188:191], v[108:111], v[128:143]
s_waitcnt lgkmcnt(0)
v_mfma_f32_32x32x16_bf16 v[128:143], v[160:163], v[112:115], v[128:143]
s_waitcnt vmcnt(1)
s_lshl_b32 s32, s4, 9
s_lshl_b32 s33, s5, 4
s_add_u32 s32, s32, s33
s_lshl_b32 s33, s3, 2
s_add_u32 s32, s32, s33
s_add_u32 s32, s32, 368640
v_mov_b32 v236, 0
v_mov_b32 v237, s88
s_mov_b64 exec, 1
s_cmp_eq_u32 s47, 1
s_cbranch_scc1 pub_loc_93
buffer_store_dword v237, v236, s[8:11], s32 offen sc1
s_branch pub_end_94
pub_loc_93:
buffer_store_dword v237, v236, s[8:11], s32 offen
pub_end_94:
s_mov_b64 exec, -1
s_mov_b32 s39, 368640
buffer_load_dword v233, v232, s[8:11], s39 offen sc1
v_mfma_f32_32x32x16_bf16 v[128:143], v[164:167], v[116:119], v[128:143]
v_mfma_f32_32x32x16_bf16 v[128:143], v[168:171], v[120:123], v[128:143]
v_mfma_f32_32x32x16_bf16 v[128:143], v[172:175], v[124:127], v[128:143]
s_nop 15
v_mul_f32 v192, v128, v128
v_mul_f32 v193, v129, v129
v_mul_f32 v194, v130, v130
v_mul_f32 v195, v131, v131
v_mul_f32 v196, v132, v132
v_mul_f32 v197, v133, v133
v_mul_f32 v198, v134, v134
v_mul_f32 v199, v135, v135
v_fma_f32 v192, v192, s45, v14
v_fma_f32 v193, v193, s45, v14
v_fma_f32 v194, v194, s45, v14
v_fma_f32 v195, v195, s45, v14
v_fma_f32 v196, v196, s45, v14
v_fma_f32 v197, v197, s45, v14
v_fma_f32 v198, v198, s45, v14
v_fma_f32 v199, v199, s45, v14
v_mul_f32 v192, v192, v128
v_mul_f32 v193, v193, v129
v_mul_f32 v194, v194, v130
v_mul_f32 v195, v195, v131
v_mul_f32 v196, v196, v132
v_mul_f32 v197, v197, v133
v_mul_f32 v198, v198, v134
v_mul_f32 v199, v199, v135
v_exp_f32 v192, v192
v_mul_f32 v128, v128, v136
v_exp_f32 v193, v193
v_mul_f32 v129, v129, v137
v_exp_f32 v194, v194
v_mul_f32 v130, v130, v138
v_exp_f32 v195, v195
v_mul_f32 v131, v131, v139
v_exp_f32 v196, v196
v_mul_f32 v132, v132, v140
v_exp_f32 v197, v197
v_mul_f32 v133, v133, v141
v_exp_f32 v198, v198
v_mul_f32 v134, v134, v142
v_exp_f32 v199, v199
v_mul_f32 v135, v135, v143
v_add_f32 v192, 1.0, v192
v_add_f32 v193, 1.0, v193
v_add_f32 v194, 1.0, v194
v_add_f32 v195, 1.0, v195
v_add_f32 v196, 1.0, v196
v_add_f32 v197, 1.0, v197
v_add_f32 v198, 1.0, v198
v_add_f32 v199, 1.0, v199
v_rcp_f32 v192, v192
v_rcp_f32 v193, v193
v_rcp_f32 v194, v194
v_rcp_f32 v195, v195
v_rcp_f32 v196, v196
v_rcp_f32 v197, v197
v_rcp_f32 v198, v198
v_rcp_f32 v199, v199
v_mul_f32 v128, v128, v192
v_mul_f32 v129, v129, v193
v_mul_f32 v130, v130, v194
v_mul_f32 v131, v131, v195
v_mul_f32 v132, v132, v196
v_mul_f32 v133, v133, v197
v_mul_f32 v134, v134, v198
v_mul_f32 v135, v135, v199
v_cvt_pk_bf16_f32 v208, v128, v129
v_cvt_pk_bf16_f32 v209, v130, v131
v_cvt_pk_bf16_f32 v210, v132, v133
v_cvt_pk_bf16_f32 v211, v134, v135
s_mov_b32 s91, s7
s_cmp_lt_u32 s5, 28
s_cbranch_scc1 p5_95
s_add_u32 s32, s91, 4096
buffer_store_dwordx4 v[204:207], v2, s[8:11], s32 offen offset:1024 sc1
buffer_store_dwordx4 v[208:211], v2, s[8:11], s32 offen offset:2048 sc1
s_waitcnt vmcnt(0)
s_lshl_b32 s32, s4, 9
s_lshl_b32 s33, s5, 4
s_add_u32 s32, s32, s33
s_lshl_b32 s33, s3, 2
s_add_u32 s32, s32, s33
s_add_u32 s32, s32, 372736
v_mov_b32 v236, 0
v_mov_b32 v237, s88
s_mov_b64 exec, 1
s_cmp_eq_u32 s47, 1
s_cbranch_scc1 pub_loc_96
buffer_store_dword v237, v236, s[8:11], s32 offen sc1
s_branch pub_end_97
pub_loc_96:
buffer_store_dword v237, v236, s[8:11], s32 offen
pub_end_97:
s_mov_b64 exec, -1
s_branch adaLN_cond__softmax_full_mha__glu_gated_geglu__prompt_kernel_fin
p5_95:
s_barrier
s_mul_hi_u32 s6, s5, 613566757
s_mul_i32 s28, s6, 7
s_sub_u32 s7, s5, s28
s_lshl_b32 s28, s4, 3
s_lshl_b32 s29, s6, 1
s_add_u32 s28, s28, s29
s_lshr_b32 s29, s3, 1
s_add_u32 s34, s28, s29
s_xor_b32 s29, s29, 1
s_add_u32 s35, s28, s29
s_lshl_b32 s28, s7, 1
s_and_b32 s29, s3, 1
s_add_u32 s36, s28, s29
s_xor_b32 s29, s29, 1
s_add_u32 s37, s28, s29
s_waitcnt vmcnt(0)
s_mov_b32 s38, 0
s_mov_b32 s39, 368640
wf_98:
v_cmp_ne_u32 vcc, s88, v233
s_cbranch_vccz wf_99
s_add_u32 s38, s38, 1
s_cmp_ge_u32 s38, 131072
s_cbranch_scc1 wf_99
buffer_load_dword v233, v232, s[8:11], s39 offen sc1
s_waitcnt vmcnt(0)
s_branch wf_98
wf_99:
s_waitcnt lgkmcnt(0)
v_lshlrev_b32 v2, 4, v1
s_mul_i32 s28, s3, 28672
s_mul_i32 s40, s34, 114688
s_add_u32 s40, s40, s28
s_add_u32 s40, s40, 13631488
s_mul_i32 s41, s35, 114688
s_add_u32 s41, s41, s28
s_add_u32 s41, s41, 13631488
s_add_u32 s32, s91, 4096
buffer_store_dwordx4 v[204:207], v2, s[8:11], s32 offen offset:1024 sc1
buffer_store_dwordx4 v[208:211], v2, s[8:11], s32 offen offset:2048 sc1
v_lshrrev_b32 v3, 5, v1
v_lshlrev_b32 v4, 4, v3
s_lshl_b32 s28, s36, 7
s_add_u32 s28, s28, 8960
buffer_load_dwordx4 v[216:219], v4, s[8:11], s28 offen offset:0 sc1
buffer_load_dwordx4 v[220:223], v4, s[8:11], s28 offen offset:32 sc1
buffer_load_dwordx4 v[224:227], v4, s[8:11], s28 offen offset:64 sc1
buffer_load_dwordx4 v[228:231], v4, s[8:11], s28 offen offset:96 sc1
s_add_u32 s42, s40, 0
buffer_load_dwordx4 v[80:83], v2, s[8:11], s42 offen offset:0 sc1
s_add_u32 s43, s41, 0
buffer_load_dwordx4 v[84:87], v2, s[8:11], s43 offen offset:0 sc1
s_add_u32 s42, s40, 0
buffer_load_dwordx4 v[88:91], v2, s[8:11], s42 offen offset:1024 sc1
s_add_u32 s43, s41, 0
buffer_load_dwordx4 v[92:95], v2, s[8:11], s43 offen offset:1024 sc1
s_add_u32 s42, s40, 0
buffer_load_dwordx4 v[96:99], v2, s[8:11], s42 offen offset:2048 sc1
s_add_u32 s43, s41, 0
buffer_load_dwordx4 v[100:103], v2, s[8:11], s43 offen offset:2048 sc1
s_add_u32 s42, s40, 0
buffer_load_dwordx4 v[104:107], v2, s[8:11], s42 offen offset:3072 sc1
s_add_u32 s43, s41, 0
buffer_load_dwordx4 v[108:111], v2, s[8:11], s43 offen offset:3072 sc1
s_add_u32 s42, s40, 4096
buffer_load_dwordx4 v[112:115], v2, s[8:11], s42 offen offset:0 sc1
s_add_u32 s43, s41, 4096
buffer_load_dwordx4 v[116:119], v2, s[8:11], s43 offen offset:0 sc1
s_add_u32 s42, s40, 4096
buffer_load_dwordx4 v[120:123], v2, s[8:11], s42 offen offset:3072 sc1
s_add_u32 s43, s41, 4096
buffer_load_dwordx4 v[124:127], v2, s[8:11], s43 offen offset:3072 sc1
s_add_u32 s42, s40, 8192
buffer_load_dwordx4 v[128:131], v2, s[8:11], s42 offen offset:0 sc1
s_add_u32 s43, s41, 8192
buffer_load_dwordx4 v[132:135], v2, s[8:11], s43 offen offset:0 sc1
s_add_u32 s42, s40, 8192
buffer_load_dwordx4 v[136:139], v2, s[8:11], s42 offen offset:1024 sc1
s_add_u32 s43, s41, 8192
buffer_load_dwordx4 v[140:143], v2, s[8:11], s43 offen offset:1024 sc1
s_waitcnt vmcnt(15)
s_lshl_b32 s32, s4, 9
s_lshl_b32 s33, s5, 4
s_add_u32 s32, s32, s33
s_lshl_b32 s33, s3, 2
s_add_u32 s32, s32, s33
s_add_u32 s32, s32, 372736
v_mov_b32 v236, 0
v_mov_b32 v237, s88
s_mov_b64 exec, 1
s_cmp_eq_u32 s47, 1
s_cbranch_scc1 pub_loc_100
buffer_store_dword v237, v236, s[8:11], s32 offen sc1
s_branch pub_end_101
pub_loc_100:
buffer_store_dword v237, v236, s[8:11], s32 offen
pub_end_101:
s_mov_b64 exec, -1
v_mfma_f32_32x32x16_bf16 v[16:31], a[0:3], v[80:83], 0
v_mfma_f32_32x32x16_bf16 v[32:47], a[112:115], v[80:83], 0
s_add_u32 s42, s40, 8192
buffer_load_dwordx4 v[80:83], v2, s[8:11], s42 offen offset:2048 sc1
s_waitcnt vmcnt(15)
v_mfma_f32_32x32x16_bf16 v[48:63], a[0:3], v[84:87], 0
v_mfma_f32_32x32x16_bf16 v[64:79], a[112:115], v[84:87], 0
s_add_u32 s43, s41, 8192
buffer_load_dwordx4 v[84:87], v2, s[8:11], s43 offen offset:2048 sc1
s_waitcnt vmcnt(15)
v_mfma_f32_32x32x16_bf16 v[16:31], a[4:7], v[88:91], v[16:31]
v_mfma_f32_32x32x16_bf16 v[32:47], a[116:119], v[88:91], v[32:47]
s_add_u32 s42, s40, 8192
buffer_load_dwordx4 v[88:91], v2, s[8:11], s42 offen offset:3072 sc1
s_waitcnt vmcnt(15)
v_mfma_f32_32x32x16_bf16 v[48:63], a[4:7], v[92:95], v[48:63]
v_mfma_f32_32x32x16_bf16 v[64:79], a[116:119], v[92:95], v[64:79]
s_add_u32 s43, s41, 8192
buffer_load_dwordx4 v[92:95], v2, s[8:11], s43 offen offset:3072 sc1
s_waitcnt vmcnt(15)
v_mfma_f32_32x32x16_bf16 v[16:31], a[8:11], v[96:99], v[16:31]
v_mfma_f32_32x32x16_bf16 v[32:47], a[120:123], v[96:99], v[32:47]
s_add_u32 s42, s40, 12288
buffer_load_dwordx4 v[96:99], v2, s[8:11], s42 offen offset:2048 sc1
s_waitcnt vmcnt(15)
v_mfma_f32_32x32x16_bf16 v[48:63], a[8:11], v[100:103], v[48:63]
v_mfma_f32_32x32x16_bf16 v[64:79], a[120:123], v[100:103], v[64:79]
s_add_u32 s43, s41, 12288
buffer_load_dwordx4 v[100:103], v2, s[8:11], s43 offen offset:2048 sc1
s_waitcnt vmcnt(15)
v_mfma_f32_32x32x16_bf16 v[16:31], a[12:15], v[104:107], v[16:31]
v_mfma_f32_32x32x16_bf16 v[32:47], a[124:127], v[104:107], v[32:47]
s_add_u32 s42, s40, 12288
buffer_load_dwordx4 v[104:107], v2, s[8:11], s42 offen offset:3072 sc1
s_waitcnt vmcnt(15)
v_mfma_f32_32x32x16_bf16 v[48:63], a[12:15], v[108:111], v[48:63]
v_mfma_f32_32x32x16_bf16 v[64:79], a[124:127], v[108:111], v[64:79]
s_add_u32 s43, s41, 12288
buffer_load_dwordx4 v[108:111], v2, s[8:11], s43 offen offset:3072 sc1
s_waitcnt vmcnt(15)
v_mfma_f32_32x32x16_bf16 v[16:31], a[16:19], v[112:115], v[16:31]
v_mfma_f32_32x32x16_bf16 v[32:47], a[128:131], v[112:115], v[32:47]
s_add_u32 s42, s40, 16384
buffer_load_dwordx4 v[112:115], v2, s[8:11], s42 offen offset:0 sc1
s_waitcnt vmcnt(15)
v_mfma_f32_32x32x16_bf16 v[48:63], a[16:19], v[116:119], v[48:63]
v_mfma_f32_32x32x16_bf16 v[64:79], a[128:131], v[116:119], v[64:79]
s_add_u32 s43, s41, 16384
buffer_load_dwordx4 v[116:119], v2, s[8:11], s43 offen offset:0 sc1
s_waitcnt vmcnt(15)
v_mfma_f32_32x32x16_bf16 v[16:31], a[28:31], v[120:123], v[16:31]
v_mfma_f32_32x32x16_bf16 v[32:47], a[140:143], v[120:123], v[32:47]
s_add_u32 s42, s40, 16384
buffer_load_dwordx4 v[120:123], v2, s[8:11], s42 offen offset:1024 sc1
s_waitcnt vmcnt(15)
v_mfma_f32_32x32x16_bf16 v[48:63], a[28:31], v[124:127], v[48:63]
v_mfma_f32_32x32x16_bf16 v[64:79], a[140:143], v[124:127], v[64:79]
s_add_u32 s43, s41, 16384
buffer_load_dwordx4 v[124:127], v2, s[8:11], s43 offen offset:1024 sc1
s_waitcnt vmcnt(15)
v_mfma_f32_32x32x16_bf16 v[16:31], a[32:35], v[128:131], v[16:31]
v_mfma_f32_32x32x16_bf16 v[32:47], a[144:147], v[128:131], v[32:47]
s_add_u32 s42, s40, 16384
buffer_load_dwordx4 v[128:131], v2, s[8:11], s42 offen offset:2048 sc1
s_waitcnt vmcnt(15)
v_mfma_f32_32x32x16_bf16 v[48:63], a[32:35], v[132:135], v[48:63]
v_mfma_f32_32x32x16_bf16 v[64:79], a[144:147], v[132:135], v[64:79]
s_add_u32 s43, s41, 16384
buffer_load_dwordx4 v[132:135], v2, s[8:11], s43 offen offset:2048 sc1
s_waitcnt vmcnt(15)
v_mfma_f32_32x32x16_bf16 v[16:31], a[36:39], v[136:139], v[16:31]
v_mfma_f32_32x32x16_bf16 v[32:47], a[148:151], v[136:139], v[32:47]
s_add_u32 s42, s40, 20480
buffer_load_dwordx4 v[136:139], v2, s[8:11], s42 offen offset:1024 sc1
s_waitcnt vmcnt(15)
v_mfma_f32_32x32x16_bf16 v[48:63], a[36:39], v[140:143], v[48:63]
v_mfma_f32_32x32x16_bf16 v[64:79], a[148:151], v[140:143], v[64:79]
s_add_u32 s43, s41, 20480
buffer_load_dwordx4 v[140:143], v2, s[8:11], s43 offen offset:1024 sc1
s_waitcnt vmcnt(15)
v_mfma_f32_32x32x16_bf16 v[16:31], a[40:43], v[80:83], v[16:31]
v_mfma_f32_32x32x16_bf16 v[32:47], a[152:155], v[80:83], v[32:47]
s_add_u32 s42, s40, 20480
buffer_load_dwordx4 v[80:83], v2, s[8:11], s42 offen offset:2048 sc1
s_waitcnt vmcnt(15)
v_mfma_f32_32x32x16_bf16 v[48:63], a[40:43], v[84:87], v[48:63]
v_mfma_f32_32x32x16_bf16 v[64:79], a[152:155], v[84:87], v[64:79]
s_add_u32 s43, s41, 20480
buffer_load_dwordx4 v[84:87], v2, s[8:11], s43 offen offset:2048 sc1
s_mov_b32 s39, 372736
buffer_load_dword v233, v232, s[8:11], s39 offen sc1
s_waitcnt vmcnt(16)
v_mfma_f32_32x32x16_bf16 v[16:31], a[44:47], v[88:91], v[16:31]
v_mfma_f32_32x32x16_bf16 v[32:47], a[156:159], v[88:91], v[32:47]
s_add_u32 s42, s40, 20480
buffer_load_dwordx4 v[88:91], v2, s[8:11], s42 offen offset:3072 sc1
s_waitcnt vmcnt(16)
v_mfma_f32_32x32x16_bf16 v[48:63], a[44:47], v[92:95], v[48:63]
v_mfma_f32_32x32x16_bf16 v[64:79], a[156:159], v[92:95], v[64:79]
s_add_u32 s43, s41, 20480
buffer_load_dwordx4 v[92:95], v2, s[8:11], s43 offen offset:3072 sc1
s_waitcnt vmcnt(16)
v_mfma_f32_32x32x16_bf16 v[16:31], a[56:59], v[96:99], v[16:31]
v_mfma_f32_32x32x16_bf16 v[32:47], a[168:171], v[96:99], v[32:47]
s_add_u32 s42, s40, 24576
buffer_load_dwordx4 v[96:99], v2, s[8:11], s42 offen offset:0 sc1
s_waitcnt vmcnt(16)
v_mfma_f32_32x32x16_bf16 v[48:63], a[56:59], v[100:103], v[48:63]
v_mfma_f32_32x32x16_bf16 v[64:79], a[168:171], v[100:103], v[64:79]
s_add_u32 s43, s41, 24576
buffer_load_dwordx4 v[100:103], v2, s[8:11], s43 offen offset:0 sc1
s_waitcnt vmcnt(16)
v_mfma_f32_32x32x16_bf16 v[16:31], a[60:63], v[104:107], v[16:31]
v_mfma_f32_32x32x16_bf16 v[32:47], a[172:175], v[104:107], v[32:47]
s_add_u32 s42, s40, 24576
buffer_load_dwordx4 v[104:107], v2, s[8:11], s42 offen offset:1024 sc1
s_waitcnt vmcnt(16)
v_mfma_f32_32x32x16_bf16 v[48:63], a[60:63], v[108:111], v[48:63]
v_mfma_f32_32x32x16_bf16 v[64:79], a[172:175], v[108:111], v[64:79]
s_add_u32 s43, s41, 24576
buffer_load_dwordx4 v[108:111], v2, s[8:11], s43 offen offset:1024 sc1
s_waitcnt vmcnt(6)
s_mov_b32 s38, 0
s_mov_b32 s39, 372736
wf_102:
v_cmp_ne_u32 vcc, s88, v233
s_cbranch_vccz wf_103
s_add_u32 s38, s38, 1
s_cmp_ge_u32 s38, 131072
s_cbranch_scc1 wf_103
buffer_load_dword v233, v232, s[8:11], s39 offen sc1
s_waitcnt vmcnt(0)
s_branch wf_102
wf_103:
s_waitcnt vmcnt(16)
v_mfma_f32_32x32x16_bf16 v[16:31], a[64:67], v[112:115], v[16:31]
v_mfma_f32_32x32x16_bf16 v[32:47], a[176:179], v[112:115], v[32:47]
s_add_u32 s42, s40, 4096
buffer_load_dwordx4 v[112:115], v2, s[8:11], s42 offen offset:1024 sc1
s_waitcnt vmcnt(16)
v_mfma_f32_32x32x16_bf16 v[48:63], a[64:67], v[116:119], v[48:63]
v_mfma_f32_32x32x16_bf16 v[64:79], a[176:179], v[116:119], v[64:79]
s_add_u32 s43, s41, 4096
buffer_load_dwordx4 v[116:119], v2, s[8:11], s43 offen offset:1024 sc1
s_waitcnt vmcnt(16)
v_mfma_f32_32x32x16_bf16 v[16:31], a[68:71], v[120:123], v[16:31]
v_mfma_f32_32x32x16_bf16 v[32:47], a[180:183], v[120:123], v[32:47]
s_add_u32 s42, s40, 12288
buffer_load_dwordx4 v[120:123], v2, s[8:11], s42 offen offset:0 sc1
s_waitcnt vmcnt(16)
v_mfma_f32_32x32x16_bf16 v[48:63], a[68:71], v[124:127], v[48:63]
v_mfma_f32_32x32x16_bf16 v[64:79], a[180:183], v[124:127], v[64:79]
s_add_u32 s43, s41, 12288
buffer_load_dwordx4 v[124:127], v2, s[8:11], s43 offen offset:0 sc1
s_waitcnt vmcnt(16)
v_mfma_f32_32x32x16_bf16 v[16:31], a[72:75], v[128:131], v[16:31]
v_mfma_f32_32x32x16_bf16 v[32:47], a[184:187], v[128:131], v[32:47]
s_add_u32 s42, s40, 16384
buffer_load_dwordx4 v[128:131], v2, s[8:11], s42 offen offset:3072 sc1
s_waitcnt vmcnt(16)
v_mfma_f32_32x32x16_bf16 v[48:63], a[72:75], v[132:135], v[48:63]
v_mfma_f32_32x32x16_bf16 v[64:79], a[184:187], v[132:135], v[64:79]
s_add_u32 s43, s41, 16384
buffer_load_dwordx4 v[132:135], v2, s[8:11], s43 offen offset:3072 sc1
s_waitcnt vmcnt(16)
v_mfma_f32_32x32x16_bf16 v[16:31], a[84:87], v[136:139], v[16:31]
v_mfma_f32_32x32x16_bf16 v[32:47], a[196:199], v[136:139], v[32:47]
s_add_u32 s42, s40, 24576
buffer_load_dwordx4 v[136:139], v2, s[8:11], s42 offen offset:2048 sc1
s_waitcnt vmcnt(16)
v_mfma_f32_32x32x16_bf16 v[48:63], a[84:87], v[140:143], v[48:63]
v_mfma_f32_32x32x16_bf16 v[64:79], a[196:199], v[140:143], v[64:79]
s_add_u32 s43, s41, 24576
buffer_load_dwordx4 v[140:143], v2, s[8:11], s43 offen offset:2048 sc1
s_waitcnt vmcnt(16)
v_mfma_f32_32x32x16_bf16 v[16:31], a[88:91], v[80:83], v[16:31]
v_mfma_f32_32x32x16_bf16 v[32:47], a[200:203], v[80:83], v[32:47]
s_add_u32 s42, s40, 4096
buffer_load_dwordx4 v[80:83], v2, s[8:11], s42 offen offset:2048 sc1
s_waitcnt vmcnt(16)
v_mfma_f32_32x32x16_bf16 v[48:63], a[88:91], v[84:87], v[48:63]
v_mfma_f32_32x32x16_bf16 v[64:79], a[200:203], v[84:87], v[64:79]
s_add_u32 s43, s41, 4096
buffer_load_dwordx4 v[84:87], v2, s[8:11], s43 offen offset:2048 sc1
s_waitcnt vmcnt(15)
v_mfma_f32_32x32x16_bf16 v[16:31], a[92:95], v[88:91], v[16:31]
v_mfma_f32_32x32x16_bf16 v[32:47], a[204:207], v[88:91], v[32:47]
s_add_u32 s42, s40, 12288
buffer_load_dwordx4 v[88:91], v2, s[8:11], s42 offen offset:1024 sc1
s_waitcnt vmcnt(15)
v_mfma_f32_32x32x16_bf16 v[48:63], a[92:95], v[92:95], v[48:63]
v_mfma_f32_32x32x16_bf16 v[64:79], a[204:207], v[92:95], v[64:79]
s_add_u32 s43, s41, 12288
buffer_load_dwordx4 v[92:95], v2, s[8:11], s43 offen offset:1024 sc1
s_waitcnt vmcnt(15)
v_mfma_f32_32x32x16_bf16 v[16:31], a[96:99], v[96:99], v[16:31]
v_mfma_f32_32x32x16_bf16 v[32:47], a[208:211], v[96:99], v[32:47]
s_add_u32 s42, s40, 20480
buffer_load_dwordx4 v[96:99], v2, s[8:11], s42 offen offset:0 sc1
s_waitcnt vmcnt(15)
v_mfma_f32_32x32x16_bf16 v[48:63], a[96:99], v[100:103], v[48:63]
v_mfma_f32_32x32x16_bf16 v[64:79], a[208:211], v[100:103], v[64:79]
s_add_u32 s43, s41, 20480
buffer_load_dwordx4 v[100:103], v2, s[8:11], s43 offen offset:0 sc1
s_waitcnt vmcnt(15)
v_mfma_f32_32x32x16_bf16 v[16:31], a[100:103], v[104:107], v[16:31]
v_mfma_f32_32x32x16_bf16 v[32:47], a[212:215], v[104:107], v[32:47]
s_add_u32 s42, s40, 24576
buffer_load_dwordx4 v[104:107], v2, s[8:11], s42 offen offset:3072 sc1
s_waitcnt vmcnt(15)
v_mfma_f32_32x32x16_bf16 v[48:63], a[100:103], v[108:111], v[48:63]
v_mfma_f32_32x32x16_bf16 v[64:79], a[212:215], v[108:111], v[64:79]
s_add_u32 s43, s41, 24576
buffer_load_dwordx4 v[108:111], v2, s[8:11], s43 offen offset:3072 sc1
s_waitcnt vmcnt(15)
v_mfma_f32_32x32x16_bf16 v[16:31], a[20:23], v[112:115], v[16:31]
v_mfma_f32_32x32x16_bf16 v[32:47], a[132:135], v[112:115], v[32:47]
s_waitcnt vmcnt(14)
v_mfma_f32_32x32x16_bf16 v[48:63], a[20:23], v[116:119], v[48:63]
v_mfma_f32_32x32x16_bf16 v[64:79], a[132:135], v[116:119], v[64:79]
s_waitcnt vmcnt(13)
v_mfma_f32_32x32x16_bf16 v[16:31], a[48:51], v[120:123], v[16:31]
v_mfma_f32_32x32x16_bf16 v[32:47], a[160:163], v[120:123], v[32:47]
s_waitcnt vmcnt(12)
v_mfma_f32_32x32x16_bf16 v[48:63], a[48:51], v[124:127], v[48:63]
v_mfma_f32_32x32x16_bf16 v[64:79], a[160:163], v[124:127], v[64:79]
s_waitcnt vmcnt(11)
v_mfma_f32_32x32x16_bf16 v[16:31], a[76:79], v[128:131], v[16:31]
v_mfma_f32_32x32x16_bf16 v[32:47], a[188:191], v[128:131], v[32:47]
s_waitcnt vmcnt(10)
v_mfma_f32_32x32x16_bf16 v[48:63], a[76:79], v[132:135], v[48:63]
v_mfma_f32_32x32x16_bf16 v[64:79], a[188:191], v[132:135], v[64:79]
s_waitcnt vmcnt(9)
v_mfma_f32_32x32x16_bf16 v[16:31], a[104:107], v[136:139], v[16:31]
v_mfma_f32_32x32x16_bf16 v[32:47], a[216:219], v[136:139], v[32:47]
s_waitcnt vmcnt(8)
v_mfma_f32_32x32x16_bf16 v[48:63], a[104:107], v[140:143], v[48:63]
v_mfma_f32_32x32x16_bf16 v[64:79], a[216:219], v[140:143], v[64:79]
s_waitcnt vmcnt(0)
v_lshlrev_b32 v2, 4, v1
s_xor_b32 s28, s3, 1
s_mul_i32 s28, s28, 12288
s_add_u32 s28, s28, 0
v_add_u32 v8, s28, v2
s_xor_b32 s28, s3, 2
s_mul_i32 s28, s28, 12288
s_add_u32 s28, s28, 4096
v_add_u32 v9, s28, v2
s_xor_b32 s28, s3, 3
s_mul_i32 s28, s28, 12288
s_add_u32 s28, s28, 8192
v_add_u32 v10, s28, v2
s_mul_i32 s28, s3, 12288
s_add_u32 s28, s28, 0
v_add_u32 v11, s28, v2
v_mfma_f32_32x32x16_bf16 v[64:79], a[136:139], v[84:87], v[64:79]
v_mfma_f32_32x32x16_bf16 v[64:79], a[164:167], v[92:95], v[64:79]
v_mfma_f32_32x32x16_bf16 v[64:79], a[192:195], v[100:103], v[64:79]
v_mfma_f32_32x32x16_bf16 v[64:79], a[220:223], v[108:111], v[64:79]
v_mfma_f32_32x32x16_bf16 v[48:63], a[24:27], v[84:87], v[48:63]
v_mfma_f32_32x32x16_bf16 v[48:63], a[52:55], v[92:95], v[48:63]
v_mfma_f32_32x32x16_bf16 v[48:63], a[80:83], v[100:103], v[48:63]
v_mfma_f32_32x32x16_bf16 v[48:63], a[108:111], v[108:111], v[48:63]
s_nop 7
ds_write_b128 v10, v[64:67] offset:0
ds_write_b128 v10, v[68:71] offset:1024
ds_write_b128 v10, v[72:75] offset:2048
ds_write_b128 v10, v[76:79] offset:3072
v_mfma_f32_32x32x16_bf16 v[32:47], a[136:139], v[80:83], v[32:47]
v_mfma_f32_32x32x16_bf16 v[32:47], a[164:167], v[88:91], v[32:47]
v_mfma_f32_32x32x16_bf16 v[32:47], a[192:195], v[96:99], v[32:47]
v_mfma_f32_32x32x16_bf16 v[32:47], a[220:223], v[104:107], v[32:47]
ds_write_b128 v9, v[48:51] offset:0
ds_write_b128 v9, v[52:55] offset:1024
ds_write_b128 v9, v[56:59] offset:2048
ds_write_b128 v9, v[60:63] offset:3072
v_mfma_f32_32x32x16_bf16 v[16:31], a[24:27], v[80:83], v[16:31]
v_mfma_f32_32x32x16_bf16 v[16:31], a[52:55], v[88:91], v[16:31]
v_mfma_f32_32x32x16_bf16 v[16:31], a[80:83], v[96:99], v[16:31]
v_mfma_f32_32x32x16_bf16 v[16:31], a[108:111], v[104:107], v[16:31]
s_nop 3
ds_write_b128 v8, v[32:35] offset:0
ds_write_b128 v8, v[36:39] offset:1024
ds_write_b128 v8, v[40:43] offset:2048
ds_write_b128 v8, v[44:47] offset:3072
s_waitcnt lgkmcnt(0)
s_barrier
ds_read_b128 v[32:35], v11 offset:0
ds_read_b128 v[36:39], v11 offset:1024
ds_read_b128 v[40:43], v11 offset:2048
ds_read_b128 v[44:47], v11 offset:3072
ds_read_b128 v[48:51], v11 offset:4096
ds_read_b128 v[52:55], v11 offset:5120
ds_read_b128 v[56:59], v11 offset:6144
ds_read_b128 v[60:63], v11 offset:7168
ds_read_b128 v[64:67], v11 offset:8192
ds_read_b128 v[68:71], v11 offset:9216
ds_read_b128 v[72:75], v11 offset:10240
ds_read_b128 v[76:79], v11 offset:11264
s_waitcnt lgkmcnt(8)
v_add_f32 v16, v16, v32
v_add_f32 v17, v17, v33
v_add_f32 v18, v18, v34
v_add_f32 v19, v19, v35
v_add_f32 v20, v20, v36
v_add_f32 v21, v21, v37
v_add_f32 v22, v22, v38
v_add_f32 v23, v23, v39
v_add_f32 v24, v24, v40
v_add_f32 v25, v25, v41
v_add_f32 v26, v26, v42
v_add_f32 v27, v27, v43
v_add_f32 v28, v28, v44
v_add_f32 v29, v29, v45
v_add_f32 v30, v30, v46
v_add_f32 v31, v31, v47
s_waitcnt lgkmcnt(4)
v_add_f32 v16, v16, v48
v_add_f32 v17, v17, v49
v_add_f32 v18, v18, v50
v_add_f32 v19, v19, v51
v_add_f32 v20, v20, v52
v_add_f32 v21, v21, v53
v_add_f32 v22, v22, v54
v_add_f32 v23, v23, v55
v_add_f32 v24, v24, v56
v_add_f32 v25, v25, v57
v_add_f32 v26, v26, v58
v_add_f32 v27, v27, v59
v_add_f32 v28, v28, v60
v_add_f32 v29, v29, v61
v_add_f32 v30, v30, v62
v_add_f32 v31, v31, v63
s_waitcnt lgkmcnt(0)
v_add_f32 v16, v16, v64
v_add_f32 v17, v17, v65
v_add_f32 v18, v18, v66
v_add_f32 v19, v19, v67
v_add_f32 v20, v20, v68
v_add_f32 v21, v21, v69
v_add_f32 v22, v22, v70
v_add_f32 v23, v23, v71
v_add_f32 v24, v24, v72
v_add_f32 v25, v25, v73
v_add_f32 v26, v26, v74
v_add_f32 v27, v27, v75
v_add_f32 v28, v28, v76
v_add_f32 v29, v29, v77
v_add_f32 v30, v30, v78
v_add_f32 v31, v31, v79
v_lshlrev_b32 v32, 16, v244
v_and_b32 v33, 0xffff0000, v244
v_lshlrev_b32 v34, 16, v245
v_and_b32 v35, 0xffff0000, v245
v_lshlrev_b32 v36, 16, v246
v_and_b32 v37, 0xffff0000, v246
v_lshlrev_b32 v38, 16, v247
v_and_b32 v39, 0xffff0000, v247
v_lshlrev_b32 v40, 16, v248
v_and_b32 v41, 0xffff0000, v248
v_lshlrev_b32 v42, 16, v249
v_and_b32 v43, 0xffff0000, v249
v_lshlrev_b32 v44, 16, v250
v_and_b32 v45, 0xffff0000, v250
v_lshlrev_b32 v46, 16, v251
v_and_b32 v47, 0xffff0000, v251
v_fmac_f32 v32, v216, v16
v_fmac_f32 v33, v217, v17
v_fmac_f32 v34, v218, v18
v_fmac_f32 v35, v219, v19
v_fmac_f32 v36, v220, v20
v_fmac_f32 v37, v221, v21
v_fmac_f32 v38, v222, v22
v_fmac_f32 v39, v223, v23
v_fmac_f32 v40, v224, v24
v_fmac_f32 v41, v225, v25
v_fmac_f32 v42, v226, v26
v_fmac_f32 v43, v227, v27
v_fmac_f32 v44, v228, v28
v_fmac_f32 v45, v229, v29
v_fmac_f32 v46, v230, v30
v_fmac_f32 v47, v231, v31
v_cvt_pk_bf16_f32 v48, v32, v33
v_cvt_pk_bf16_f32 v49, v34, v35
v_cvt_pk_bf16_f32 v50, v36, v37
v_cvt_pk_bf16_f32 v51, v38, v39
v_cvt_pk_bf16_f32 v52, v40, v41
v_cvt_pk_bf16_f32 v53, v42, v43
v_cvt_pk_bf16_f32 v54, v44, v45
v_cvt_pk_bf16_f32 v55, v46, v47
v_permlane32_swap_b32 v48, v50
v_permlane32_swap_b32 v49, v51
v_permlane32_swap_b32 v52, v54
v_permlane32_swap_b32 v53, v55
v_lshrrev_b32 v3, 5, v1
v_and_b32 v5, 31, v1
v_mul_u32_u24 v5, 896, v5
v_lshl_add_u32 v5, v3, 4, v5
s_mul_i32 s28, s34, 28672
s_lshl_b32 s29, s36, 6
s_add_u32 s28, s28, s29
buffer_store_dwordx4 v[48:51], v5, s[24:27], s28 offen
buffer_store_dwordx4 v[52:55], v5, s[24:27], s28 offen offset:32
adaLN_cond__softmax_full_mha__glu_gated_geglu__prompt_kernel_fin:
s_waitcnt vmcnt(0)
adaLN_cond__softmax_full_mha__glu_gated_geglu__prompt_kernel_exit:
s_endpgm
adaLN_cond__softmax_full_mha__glu_gated_geglu__prompt_kernel_exact:
s_barrier
s_and_b32 s6, s5, 1
s_lshl_b32 s28, s4, 1
s_add_u32 s6, s6, s28
s_lshr_b32 s7, s5, 1
s_lshl_b32 s28, s6, 6
s_lshl_b32 s29, s3, 4
s_add_u32 s29, s29, s28
s_lshl_b32 s29, s29, 11
s_add_u32 s40, s29, 3145728
s_add_u32 s41, s29, 5242880
s_lshl_b32 s19, s7, 2
s_add_u32 s19, s19, s28
v_lshlrev_b32 v2, 4, v1
s_add_u32 s42, s40, 0
buffer_load_dwordx4 v[152:155], v2, s[8:11], s42 offen offset:0 sc1
buffer_load_dwordx4 v[156:159], v2, s[8:11], s42 offen offset:1024 sc1
s_add_u32 s43, s41, 0
buffer_load_dwordx4 v[160:163], v2, s[8:11], s43 offen offset:0 sc1
buffer_load_dwordx4 v[164:167], v2, s[8:11], s43 offen offset:1024 sc1
s_xor_b32 s31, s3, 0
s_add_u32 s31, s31, s19
s_lshl_b32 s31, s31, 11
s_add_u32 s31, s31, 1048576
buffer_load_dwordx4 v[16:19], v2, s[8:11], s31 offen sc1
buffer_load_dwordx4 v[20:23], v2, s[8:11], s31 offen offset:1024 sc1
s_xor_b32 s31, s3, 1
s_add_u32 s31, s31, s19
s_lshl_b32 s31, s31, 11
s_add_u32 s31, s31, 1048576
buffer_load_dwordx4 v[24:27], v2, s[8:11], s31 offen sc1
buffer_load_dwordx4 v[28:31], v2, s[8:11], s31 offen offset:1024 sc1
s_xor_b32 s31, s3, 2
s_add_u32 s31, s31, s19
s_lshl_b32 s31, s31, 11
s_add_u32 s31, s31, 1048576
buffer_load_dwordx4 v[32:35], v2, s[8:11], s31 offen sc1
buffer_load_dwordx4 v[36:39], v2, s[8:11], s31 offen offset:1024 sc1
s_xor_b32 s31, s3, 3
s_add_u32 s31, s31, s19
s_lshl_b32 s31, s31, 11
s_add_u32 s31, s31, 1048576
buffer_load_dwordx4 v[40:43], v2, s[8:11], s31 offen sc1
buffer_load_dwordx4 v[44:47], v2, s[8:11], s31 offen offset:1024 sc1
v_lshlrev_b32 v3, 7, v1
s_lshl_b32 s31, s6, 13
s_add_u32 s31, s31, 31981568
buffer_load_dword v15, v3, s[8:11], s31 offen sc1
s_add_u32 s42, s40, 2048
buffer_load_dwordx4 v[168:171], v2, s[8:11], s42 offen offset:0 sc1
buffer_load_dwordx4 v[172:175], v2, s[8:11], s42 offen offset:1024 sc1
s_add_u32 s43, s41, 2048
buffer_load_dwordx4 v[176:179], v2, s[8:11], s43 offen offset:0 sc1
buffer_load_dwordx4 v[180:183], v2, s[8:11], s43 offen offset:1024 sc1
s_add_u32 s42, s40, 4096
buffer_load_dwordx4 v[184:187], v2, s[8:11], s42 offen offset:0 sc1
buffer_load_dwordx4 v[188:191], v2, s[8:11], s42 offen offset:1024 sc1
s_add_u32 s43, s41, 4096
buffer_load_dwordx4 v[192:195], v2, s[8:11], s43 offen offset:0 sc1
buffer_load_dwordx4 v[196:199], v2, s[8:11], s43 offen offset:1024 sc1
s_add_u32 s42, s40, 6144
buffer_load_dwordx4 v[200:203], v2, s[8:11], s42 offen offset:0 sc1
buffer_load_dwordx4 v[204:207], v2, s[8:11], s42 offen offset:1024 sc1
s_add_u32 s43, s41, 6144
buffer_load_dwordx4 v[208:211], v2, s[8:11], s43 offen offset:0 sc1
buffer_load_dwordx4 v[212:215], v2, s[8:11], s43 offen offset:1024 sc1
s_waitcnt vmcnt(0)
v_mov_b32 v8, 0xff800000
v_mov_b32 v9, 0xff800000
v_mov_b32 v10, 0xff800000
v_mov_b32 v11, 0xff800000
s_mov_b32 s14, s40
s_mov_b32 s15, 0
mx_104:
buffer_load_dwordx4 v[48:51], v2, s[8:11], s14 offen sc1
buffer_load_dwordx4 v[52:55], v2, s[8:11], s14 offen offset:1024 sc1
s_waitcnt vmcnt(0)
v_mfma_f32_32x32x16_bf16 v[112:127], v[48:51], v[16:19], 0
v_mfma_f32_32x32x16_bf16 v[112:127], v[52:55], v[20:23], v[112:127]
s_nop 11
v_max3_f32 v8, v112, v113, v8
v_max3_f32 v8, v114, v115, v8
v_max3_f32 v8, v116, v117, v8
v_max3_f32 v8, v118, v119, v8
v_max3_f32 v8, v120, v121, v8
v_max3_f32 v8, v122, v123, v8
v_max3_f32 v8, v124, v125, v8
v_max3_f32 v8, v126, v127, v8
v_mfma_f32_32x32x16_bf16 v[128:143], v[48:51], v[24:27], 0
v_mfma_f32_32x32x16_bf16 v[128:143], v[52:55], v[28:31], v[128:143]
s_nop 11
v_max3_f32 v9, v128, v129, v9
v_max3_f32 v9, v130, v131, v9
v_max3_f32 v9, v132, v133, v9
v_max3_f32 v9, v134, v135, v9
v_max3_f32 v9, v136, v137, v9
v_max3_f32 v9, v138, v139, v9
v_max3_f32 v9, v140, v141, v9
v_max3_f32 v9, v142, v143, v9
v_mfma_f32_32x32x16_bf16 v[112:127], v[48:51], v[32:35], 0
v_mfma_f32_32x32x16_bf16 v[112:127], v[52:55], v[36:39], v[112:127]
s_nop 11
v_max3_f32 v10, v112, v113, v10
v_max3_f32 v10, v114, v115, v10
v_max3_f32 v10, v116, v117, v10
v_max3_f32 v10, v118, v119, v10
v_max3_f32 v10, v120, v121, v10
v_max3_f32 v10, v122, v123, v10
v_max3_f32 v10, v124, v125, v10
v_max3_f32 v10, v126, v127, v10
v_mfma_f32_32x32x16_bf16 v[128:143], v[48:51], v[40:43], 0
v_mfma_f32_32x32x16_bf16 v[128:143], v[52:55], v[44:47], v[128:143]
s_nop 11
v_max3_f32 v11, v128, v129, v11
v_max3_f32 v11, v130, v131, v11
v_max3_f32 v11, v132, v133, v11
v_max3_f32 v11, v134, v135, v11
v_max3_f32 v11, v136, v137, v11
v_max3_f32 v11, v138, v139, v11
v_max3_f32 v11, v140, v141, v11
v_max3_f32 v11, v142, v143, v11
s_add_u32 s14, s14, 2048
s_add_u32 s15, s15, 1
s_cmp_lt_u32 s15, 16
s_cbranch_scc1 mx_104
v_mov_b32 v12, v8
s_nop 1
v_permlane32_swap_b32 v8, v12
v_max_f32 v8, v8, v12
v_mov_b32 v12, v9
s_nop 1
v_permlane32_swap_b32 v9, v12
v_max_f32 v9, v9, v12
v_mov_b32 v12, v10
s_nop 1
v_permlane32_swap_b32 v10, v12
v_max_f32 v10, v10, v12
v_mov_b32 v12, v11
s_nop 1
v_permlane32_swap_b32 v11, v12
v_max_f32 v11, v11, v12
v_lshlrev_b32 v12, 2, v1
s_barrier
s_xor_b32 s28, s3, 0
s_lshl_b32 s28, s28, 10
s_lshl_b32 s29, s3, 8
s_add_u32 s28, s28, s29
s_add_u32 s28, s28, 0
v_add_u32 v13, s28, v12
ds_write_b32 v13, v8
s_xor_b32 s28, s3, 1
s_lshl_b32 s28, s28, 10
s_lshl_b32 s29, s3, 8
s_add_u32 s28, s28, s29
s_add_u32 s28, s28, 0
v_add_u32 v13, s28, v12
ds_write_b32 v13, v9
s_xor_b32 s28, s3, 2
s_lshl_b32 s28, s28, 10
s_lshl_b32 s29, s3, 8
s_add_u32 s28, s28, s29
s_add_u32 s28, s28, 0
v_add_u32 v13, s28, v12
ds_write_b32 v13, v10
s_xor_b32 s28, s3, 3
s_lshl_b32 s28, s28, 10
s_lshl_b32 s29, s3, 8
s_add_u32 s28, s28, s29
s_add_u32 s28, s28, 0
v_add_u32 v13, s28, v12
ds_write_b32 v13, v11
s_waitcnt lgkmcnt(0)
s_barrier
v_cmp_lt_u32 vcc, 31, v1
s_xor_b32 s28, s3, 0
s_lshl_b32 s28, s28, 10
s_add_u32 s28, s28, 0
v_add_u32 v13, s28, v12
ds_read_b32 v48, v13 offset:0
ds_read_b32 v49, v13 offset:256
ds_read_b32 v50, v13 offset:512
ds_read_b32 v51, v13 offset:768
s_waitcnt lgkmcnt(0)
v_max_f32 v48, v48, v49
v_max_f32 v50, v50, v51
v_max_f32 v48, v48, v50
v_sub_f32 v48, 0, v48
v_cvt_pk_bf16_f32 v49, v48, v48
v_and_b32 v49, 0xffff0000, v49
v_sub_f32 v50, v48, v49
v_cvt_pk_bf16_f32 v49, v49, v50
v_cndmask_b32 v22, v22, v49, vcc
s_xor_b32 s28, s3, 1
s_lshl_b32 s28, s28, 10
s_add_u32 s28, s28, 0
v_add_u32 v13, s28, v12
ds_read_b32 v48, v13 offset:0
ds_read_b32 v49, v13 offset:256
ds_read_b32 v50, v13 offset:512
ds_read_b32 v51, v13 offset:768
s_waitcnt lgkmcnt(0)
v_max_f32 v48, v48, v49
v_max_f32 v50, v50, v51
v_max_f32 v48, v48, v50
v_sub_f32 v48, 0, v48
v_cvt_pk_bf16_f32 v49, v48, v48
v_and_b32 v49, 0xffff0000, v49
v_sub_f32 v50, v48, v49
v_cvt_pk_bf16_f32 v49, v49, v50
v_cndmask_b32 v30, v30, v49, vcc
s_xor_b32 s28, s3, 2
s_lshl_b32 s28, s28, 10
s_add_u32 s28, s28, 0
v_add_u32 v13, s28, v12
ds_read_b32 v48, v13 offset:0
ds_read_b32 v49, v13 offset:256
ds_read_b32 v50, v13 offset:512
ds_read_b32 v51, v13 offset:768
s_waitcnt lgkmcnt(0)
v_max_f32 v48, v48, v49
v_max_f32 v50, v50, v51
v_max_f32 v48, v48, v50
v_sub_f32 v48, 0, v48
v_cvt_pk_bf16_f32 v49, v48, v48
v_and_b32 v49, 0xffff0000, v49
v_sub_f32 v50, v48, v49
v_cvt_pk_bf16_f32 v49, v49, v50
v_cndmask_b32 v38, v38, v49, vcc
s_xor_b32 s28, s3, 3
s_lshl_b32 s28, s28, 10
s_add_u32 s28, s28, 0
v_add_u32 v13, s28, v12
ds_read_b32 v48, v13 offset:0
ds_read_b32 v49, v13 offset:256
ds_read_b32 v50, v13 offset:512
ds_read_b32 v51, v13 offset:768
s_waitcnt lgkmcnt(0)
v_max_f32 v48, v48, v49
v_max_f32 v50, v50, v51
v_max_f32 v48, v48, v50
v_sub_f32 v48, 0, v48
v_cvt_pk_bf16_f32 v49, v48, v48
v_and_b32 v49, 0xffff0000, v49
v_sub_f32 v50, v48, v49
v_cvt_pk_bf16_f32 v49, v49, v50
v_cndmask_b32 v46, v46, v49, vcc
s_barrier
s_xor_b32 s28, s3, 1
s_mul_i32 s28, s28, 12288
s_add_u32 s28, s28, 0
v_add_u32 v8, s28, v2
s_xor_b32 s28, s3, 2
s_mul_i32 s28, s28, 12288
s_add_u32 s28, s28, 4096
v_add_u32 v9, s28, v2
s_xor_b32 s28, s3, 3
s_mul_i32 s28, s28, 12288
s_add_u32 s28, s28, 8192
v_add_u32 v10, s28, v2
s_mul_i32 s28, s3, 12288
s_add_u32 s28, s28, 0
v_add_u32 v11, s28, v2
s_waitcnt vmcnt(21)
v_mfma_f32_32x32x16_bf16 v[112:127], v[152:155], v[16:19], 0
v_mfma_f32_32x32x16_bf16 v[112:127], v[156:159], v[20:23], v[112:127]
s_nop 11
v_exp_f32 v112, v112
v_exp_f32 v113, v113
s_add_u32 s42, s40, 8192
buffer_load_dwordx4 v[216:219], v2, s[8:11], s42 offen offset:0 sc1
v_exp_f32 v114, v114
v_exp_f32 v115, v115
v_cvt_pk_bf16_f32 v144, v112, v113
v_cvt_pk_bf16_f32 v145, v114, v115
v_mfma_f32_32x32x16_bf16 v[128:143], v[152:155], v[24:27], 0
buffer_load_dwordx4 v[220:223], v2, s[8:11], s42 offen offset:1024 sc1
v_exp_f32 v116, v116
v_exp_f32 v117, v117
v_exp_f32 v118, v118
v_exp_f32 v119, v119
v_cvt_pk_bf16_f32 v146, v116, v117
v_cvt_pk_bf16_f32 v147, v118, v119
v_mfma_f32_32x32x16_bf16 v[128:143], v[156:159], v[28:31], v[128:143]
s_add_u32 s43, s41, 8192
buffer_load_dwordx4 v[224:227], v2, s[8:11], s43 offen offset:0 sc1
v_exp_f32 v120, v120
v_exp_f32 v121, v121
v_exp_f32 v122, v122
v_exp_f32 v123, v123
v_cvt_pk_bf16_f32 v148, v120, v121
v_cvt_pk_bf16_f32 v149, v122, v123
v_mfma_f32_32x32x16_bf16 v[48:63], v[160:163], v[144:147], 0
buffer_load_dwordx4 v[228:231], v2, s[8:11], s43 offen offset:1024 sc1
v_exp_f32 v124, v124
v_exp_f32 v125, v125
v_exp_f32 v126, v126
v_exp_f32 v127, v127
v_cvt_pk_bf16_f32 v150, v124, v125
v_cvt_pk_bf16_f32 v151, v126, v127
v_exp_f32 v128, v128
v_exp_f32 v129, v129
v_mfma_f32_32x32x16_bf16 v[48:63], v[164:167], v[148:151], v[48:63]
v_exp_f32 v130, v130
v_exp_f32 v131, v131
v_cvt_pk_bf16_f32 v144, v128, v129
v_cvt_pk_bf16_f32 v145, v130, v131
v_mfma_f32_32x32x16_bf16 v[112:127], v[152:155], v[32:35], 0
v_exp_f32 v132, v132
v_exp_f32 v133, v133
v_exp_f32 v134, v134
v_exp_f32 v135, v135
v_cvt_pk_bf16_f32 v146, v132, v133
v_cvt_pk_bf16_f32 v147, v134, v135
v_mfma_f32_32x32x16_bf16 v[112:127], v[156:159], v[36:39], v[112:127]
v_exp_f32 v136, v136
v_exp_f32 v137, v137
v_exp_f32 v138, v138
v_exp_f32 v139, v139
v_cvt_pk_bf16_f32 v148, v136, v137
v_cvt_pk_bf16_f32 v149, v138, v139
v_mfma_f32_32x32x16_bf16 v[64:79], v[160:163], v[144:147], 0
v_exp_f32 v140, v140
v_exp_f32 v141, v141
v_exp_f32 v142, v142
v_exp_f32 v143, v143
v_cvt_pk_bf16_f32 v150, v140, v141
v_cvt_pk_bf16_f32 v151, v142, v143
v_exp_f32 v112, v112
v_exp_f32 v113, v113
v_mfma_f32_32x32x16_bf16 v[64:79], v[164:167], v[148:151], v[64:79]
v_exp_f32 v114, v114
v_exp_f32 v115, v115
v_cvt_pk_bf16_f32 v144, v112, v113
v_cvt_pk_bf16_f32 v145, v114, v115
v_mfma_f32_32x32x16_bf16 v[128:143], v[152:155], v[40:43], 0
v_exp_f32 v116, v116
v_exp_f32 v117, v117
v_exp_f32 v118, v118
v_exp_f32 v119, v119
v_cvt_pk_bf16_f32 v146, v116, v117
v_cvt_pk_bf16_f32 v147, v118, v119
v_mfma_f32_32x32x16_bf16 v[128:143], v[156:159], v[44:47], v[128:143]
v_exp_f32 v120, v120
v_exp_f32 v121, v121
v_exp_f32 v122, v122
v_exp_f32 v123, v123
v_cvt_pk_bf16_f32 v148, v120, v121
v_cvt_pk_bf16_f32 v149, v122, v123
v_mfma_f32_32x32x16_bf16 v[80:95], v[160:163], v[144:147], 0
v_exp_f32 v124, v124
v_exp_f32 v125, v125
v_exp_f32 v126, v126
v_exp_f32 v127, v127
v_cvt_pk_bf16_f32 v150, v124, v125
v_cvt_pk_bf16_f32 v151, v126, v127
v_exp_f32 v128, v128
v_exp_f32 v129, v129
s_waitcnt vmcnt(12)
v_mfma_f32_32x32x16_bf16 v[80:95], v[164:167], v[148:151], v[80:95]
v_exp_f32 v130, v130
v_exp_f32 v131, v131
v_cvt_pk_bf16_f32 v144, v128, v129
v_cvt_pk_bf16_f32 v145, v130, v131
v_mfma_f32_32x32x16_bf16 v[112:127], v[168:171], v[16:19], 0
v_exp_f32 v132, v132
v_exp_f32 v133, v133
v_exp_f32 v134, v134
v_exp_f32 v135, v135
v_cvt_pk_bf16_f32 v146, v132, v133
v_cvt_pk_bf16_f32 v147, v134, v135
v_mfma_f32_32x32x16_bf16 v[112:127], v[172:175], v[20:23], v[112:127]
v_exp_f32 v136, v136
v_exp_f32 v137, v137
v_exp_f32 v138, v138
v_exp_f32 v139, v139
v_cvt_pk_bf16_f32 v148, v136, v137
v_cvt_pk_bf16_f32 v149, v138, v139
v_mfma_f32_32x32x16_bf16 v[96:111], v[160:163], v[144:147], 0
v_exp_f32 v140, v140
v_exp_f32 v141, v141
v_exp_f32 v142, v142
v_exp_f32 v143, v143
v_cvt_pk_bf16_f32 v150, v140, v141
v_cvt_pk_bf16_f32 v151, v142, v143
v_exp_f32 v112, v112
v_exp_f32 v113, v113
v_mfma_f32_32x32x16_bf16 v[96:111], v[164:167], v[148:151], v[96:111]
s_add_u32 s42, s40, 10240
buffer_load_dwordx4 v[152:155], v2, s[8:11], s42 offen offset:0 sc1
v_exp_f32 v114, v114
v_exp_f32 v115, v115
v_cvt_pk_bf16_f32 v144, v112, v113
v_cvt_pk_bf16_f32 v145, v114, v115
v_mfma_f32_32x32x16_bf16 v[128:143], v[168:171], v[24:27], 0
buffer_load_dwordx4 v[156:159], v2, s[8:11], s42 offen offset:1024 sc1
v_exp_f32 v116, v116
v_exp_f32 v117, v117
v_exp_f32 v118, v118
v_exp_f32 v119, v119
v_cvt_pk_bf16_f32 v146, v116, v117
v_cvt_pk_bf16_f32 v147, v118, v119
v_mfma_f32_32x32x16_bf16 v[128:143], v[172:175], v[28:31], v[128:143]
s_add_u32 s43, s41, 10240
buffer_load_dwordx4 v[160:163], v2, s[8:11], s43 offen offset:0 sc1
v_exp_f32 v120, v120
v_exp_f32 v121, v121
v_exp_f32 v122, v122
v_exp_f32 v123, v123
v_cvt_pk_bf16_f32 v148, v120, v121
v_cvt_pk_bf16_f32 v149, v122, v123
v_mfma_f32_32x32x16_bf16 v[48:63], v[176:179], v[144:147], v[48:63]
buffer_load_dwordx4 v[164:167], v2, s[8:11], s43 offen offset:1024 sc1
v_exp_f32 v124, v124
v_exp_f32 v125, v125
v_exp_f32 v126, v126
v_exp_f32 v127, v127
v_cvt_pk_bf16_f32 v150, v124, v125
v_cvt_pk_bf16_f32 v151, v126, v127
v_exp_f32 v128, v128
v_exp_f32 v129, v129
v_mfma_f32_32x32x16_bf16 v[48:63], v[180:183], v[148:151], v[48:63]
v_exp_f32 v130, v130
v_exp_f32 v131, v131
v_cvt_pk_bf16_f32 v144, v128, v129
v_cvt_pk_bf16_f32 v145, v130, v131
v_mfma_f32_32x32x16_bf16 v[112:127], v[168:171], v[32:35], 0
v_exp_f32 v132, v132
v_exp_f32 v133, v133
v_exp_f32 v134, v134
v_exp_f32 v135, v135
v_cvt_pk_bf16_f32 v146, v132, v133
v_cvt_pk_bf16_f32 v147, v134, v135
v_mfma_f32_32x32x16_bf16 v[112:127], v[172:175], v[36:39], v[112:127]
v_exp_f32 v136, v136
v_exp_f32 v137, v137
v_exp_f32 v138, v138
v_exp_f32 v139, v139
v_cvt_pk_bf16_f32 v148, v136, v137
v_cvt_pk_bf16_f32 v149, v138, v139
v_mfma_f32_32x32x16_bf16 v[64:79], v[176:179], v[144:147], v[64:79]
v_exp_f32 v140, v140
v_exp_f32 v141, v141
v_exp_f32 v142, v142
v_exp_f32 v143, v143
v_cvt_pk_bf16_f32 v150, v140, v141
v_cvt_pk_bf16_f32 v151, v142, v143
v_exp_f32 v112, v112
v_exp_f32 v113, v113
v_mfma_f32_32x32x16_bf16 v[64:79], v[180:183], v[148:151], v[64:79]
v_exp_f32 v114, v114
v_exp_f32 v115, v115
v_cvt_pk_bf16_f32 v144, v112, v113
v_cvt_pk_bf16_f32 v145, v114, v115
v_mfma_f32_32x32x16_bf16 v[128:143], v[168:171], v[40:43], 0
v_exp_f32 v116, v116
v_exp_f32 v117, v117
v_exp_f32 v118, v118
v_exp_f32 v119, v119
v_cvt_pk_bf16_f32 v146, v116, v117
v_cvt_pk_bf16_f32 v147, v118, v119
v_mfma_f32_32x32x16_bf16 v[128:143], v[172:175], v[44:47], v[128:143]
v_exp_f32 v120, v120
v_exp_f32 v121, v121
v_exp_f32 v122, v122
v_exp_f32 v123, v123
v_cvt_pk_bf16_f32 v148, v120, v121
v_cvt_pk_bf16_f32 v149, v122, v123
v_mfma_f32_32x32x16_bf16 v[80:95], v[176:179], v[144:147], v[80:95]
v_exp_f32 v124, v124
v_exp_f32 v125, v125
v_exp_f32 v126, v126
v_exp_f32 v127, v127
v_cvt_pk_bf16_f32 v150, v124, v125
v_cvt_pk_bf16_f32 v151, v126, v127
v_exp_f32 v128, v128
v_exp_f32 v129, v129
s_waitcnt vmcnt(12)
v_mfma_f32_32x32x16_bf16 v[80:95], v[180:183], v[148:151], v[80:95]
v_exp_f32 v130, v130
v_exp_f32 v131, v131
v_cvt_pk_bf16_f32 v144, v128, v129
v_cvt_pk_bf16_f32 v145, v130, v131
v_mfma_f32_32x32x16_bf16 v[112:127], v[184:187], v[16:19], 0
v_exp_f32 v132, v132
v_exp_f32 v133, v133
v_exp_f32 v134, v134
v_exp_f32 v135, v135
v_cvt_pk_bf16_f32 v146, v132, v133
v_cvt_pk_bf16_f32 v147, v134, v135
v_mfma_f32_32x32x16_bf16 v[112:127], v[188:191], v[20:23], v[112:127]
v_exp_f32 v136, v136
v_exp_f32 v137, v137
v_exp_f32 v138, v138
v_exp_f32 v139, v139
v_cvt_pk_bf16_f32 v148, v136, v137
v_cvt_pk_bf16_f32 v149, v138, v139
v_mfma_f32_32x32x16_bf16 v[96:111], v[176:179], v[144:147], v[96:111]
v_exp_f32 v140, v140
v_exp_f32 v141, v141
v_exp_f32 v142, v142
v_exp_f32 v143, v143
v_cvt_pk_bf16_f32 v150, v140, v141
v_cvt_pk_bf16_f32 v151, v142, v143
v_exp_f32 v112, v112
v_exp_f32 v113, v113
v_mfma_f32_32x32x16_bf16 v[96:111], v[180:183], v[148:151], v[96:111]
s_add_u32 s42, s40, 12288
buffer_load_dwordx4 v[168:171], v2, s[8:11], s42 offen offset:0 sc1
v_exp_f32 v114, v114
v_exp_f32 v115, v115
v_cvt_pk_bf16_f32 v144, v112, v113
v_cvt_pk_bf16_f32 v145, v114, v115
v_mfma_f32_32x32x16_bf16 v[128:143], v[184:187], v[24:27], 0
buffer_load_dwordx4 v[172:175], v2, s[8:11], s42 offen offset:1024 sc1
v_exp_f32 v116, v116
v_exp_f32 v117, v117
v_exp_f32 v118, v118
v_exp_f32 v119, v119
v_cvt_pk_bf16_f32 v146, v116, v117
v_cvt_pk_bf16_f32 v147, v118, v119
v_mfma_f32_32x32x16_bf16 v[128:143], v[188:191], v[28:31], v[128:143]
s_add_u32 s43, s41, 12288
buffer_load_dwordx4 v[176:179], v2, s[8:11], s43 offen offset:0 sc1
v_exp_f32 v120, v120
v_exp_f32 v121, v121
v_exp_f32 v122, v122
v_exp_f32 v123, v123
v_cvt_pk_bf16_f32 v148, v120, v121
v_cvt_pk_bf16_f32 v149, v122, v123
v_mfma_f32_32x32x16_bf16 v[48:63], v[192:195], v[144:147], v[48:63]
buffer_load_dwordx4 v[180:183], v2, s[8:11], s43 offen offset:1024 sc1
v_exp_f32 v124, v124
v_exp_f32 v125, v125
v_exp_f32 v126, v126
v_exp_f32 v127, v127
v_cvt_pk_bf16_f32 v150, v124, v125
v_cvt_pk_bf16_f32 v151, v126, v127
v_exp_f32 v128, v128
v_exp_f32 v129, v129
v_mfma_f32_32x32x16_bf16 v[48:63], v[196:199], v[148:151], v[48:63]
v_exp_f32 v130, v130
v_exp_f32 v131, v131
v_cvt_pk_bf16_f32 v144, v128, v129
v_cvt_pk_bf16_f32 v145, v130, v131
v_mfma_f32_32x32x16_bf16 v[112:127], v[184:187], v[32:35], 0
v_exp_f32 v132, v132
v_exp_f32 v133, v133
v_exp_f32 v134, v134
v_exp_f32 v135, v135
v_cvt_pk_bf16_f32 v146, v132, v133
v_cvt_pk_bf16_f32 v147, v134, v135
v_mfma_f32_32x32x16_bf16 v[112:127], v[188:191], v[36:39], v[112:127]
v_exp_f32 v136, v136
v_exp_f32 v137, v137
v_exp_f32 v138, v138
v_exp_f32 v139, v139
v_cvt_pk_bf16_f32 v148, v136, v137
v_cvt_pk_bf16_f32 v149, v138, v139
v_mfma_f32_32x32x16_bf16 v[64:79], v[192:195], v[144:147], v[64:79]
v_exp_f32 v140, v140
v_exp_f32 v141, v141
v_exp_f32 v142, v142
v_exp_f32 v143, v143
v_cvt_pk_bf16_f32 v150, v140, v141
v_cvt_pk_bf16_f32 v151, v142, v143
v_exp_f32 v112, v112
v_exp_f32 v113, v113
v_mfma_f32_32x32x16_bf16 v[64:79], v[196:199], v[148:151], v[64:79]
v_exp_f32 v114, v114
v_exp_f32 v115, v115
v_cvt_pk_bf16_f32 v144, v112, v113
v_cvt_pk_bf16_f32 v145, v114, v115
v_mfma_f32_32x32x16_bf16 v[128:143], v[184:187], v[40:43], 0
v_exp_f32 v116, v116
v_exp_f32 v117, v117
v_exp_f32 v118, v118
v_exp_f32 v119, v119
v_cvt_pk_bf16_f32 v146, v116, v117
v_cvt_pk_bf16_f32 v147, v118, v119
v_mfma_f32_32x32x16_bf16 v[128:143], v[188:191], v[44:47], v[128:143]
v_exp_f32 v120, v120
v_exp_f32 v121, v121
v_exp_f32 v122, v122
v_exp_f32 v123, v123
v_cvt_pk_bf16_f32 v148, v120, v121
v_cvt_pk_bf16_f32 v149, v122, v123
v_mfma_f32_32x32x16_bf16 v[80:95], v[192:195], v[144:147], v[80:95]
v_exp_f32 v124, v124
v_exp_f32 v125, v125
v_exp_f32 v126, v126
v_exp_f32 v127, v127
v_cvt_pk_bf16_f32 v150, v124, v125
v_cvt_pk_bf16_f32 v151, v126, v127
v_exp_f32 v128, v128
v_exp_f32 v129, v129
s_waitcnt vmcnt(12)
v_mfma_f32_32x32x16_bf16 v[80:95], v[196:199], v[148:151], v[80:95]
v_exp_f32 v130, v130
v_exp_f32 v131, v131
v_cvt_pk_bf16_f32 v144, v128, v129
v_cvt_pk_bf16_f32 v145, v130, v131
v_mfma_f32_32x32x16_bf16 v[112:127], v[200:203], v[16:19], 0
v_exp_f32 v132, v132
v_exp_f32 v133, v133
v_exp_f32 v134, v134
v_exp_f32 v135, v135
v_cvt_pk_bf16_f32 v146, v132, v133
v_cvt_pk_bf16_f32 v147, v134, v135
v_mfma_f32_32x32x16_bf16 v[112:127], v[204:207], v[20:23], v[112:127]
v_exp_f32 v136, v136
v_exp_f32 v137, v137
v_exp_f32 v138, v138
v_exp_f32 v139, v139
v_cvt_pk_bf16_f32 v148, v136, v137
v_cvt_pk_bf16_f32 v149, v138, v139
v_mfma_f32_32x32x16_bf16 v[96:111], v[192:195], v[144:147], v[96:111]
v_exp_f32 v140, v140
v_exp_f32 v141, v141
v_exp_f32 v142, v142
v_exp_f32 v143, v143
v_cvt_pk_bf16_f32 v150, v140, v141
v_cvt_pk_bf16_f32 v151, v142, v143
v_exp_f32 v112, v112
v_exp_f32 v113, v113
v_mfma_f32_32x32x16_bf16 v[96:111], v[196:199], v[148:151], v[96:111]
s_add_u32 s42, s40, 14336
buffer_load_dwordx4 v[184:187], v2, s[8:11], s42 offen offset:0 sc1
v_exp_f32 v114, v114
v_exp_f32 v115, v115
v_cvt_pk_bf16_f32 v144, v112, v113
v_cvt_pk_bf16_f32 v145, v114, v115
v_mfma_f32_32x32x16_bf16 v[128:143], v[200:203], v[24:27], 0
buffer_load_dwordx4 v[188:191], v2, s[8:11], s42 offen offset:1024 sc1
v_exp_f32 v116, v116
v_exp_f32 v117, v117
v_exp_f32 v118, v118
v_exp_f32 v119, v119
v_cvt_pk_bf16_f32 v146, v116, v117
v_cvt_pk_bf16_f32 v147, v118, v119
v_mfma_f32_32x32x16_bf16 v[128:143], v[204:207], v[28:31], v[128:143]
s_add_u32 s43, s41, 14336
buffer_load_dwordx4 v[192:195], v2, s[8:11], s43 offen offset:0 sc1
v_exp_f32 v120, v120
v_exp_f32 v121, v121
v_exp_f32 v122, v122
v_exp_f32 v123, v123
v_cvt_pk_bf16_f32 v148, v120, v121
v_cvt_pk_bf16_f32 v149, v122, v123
v_mfma_f32_32x32x16_bf16 v[48:63], v[208:211], v[144:147], v[48:63]
buffer_load_dwordx4 v[196:199], v2, s[8:11], s43 offen offset:1024 sc1
v_exp_f32 v124, v124
v_exp_f32 v125, v125
v_exp_f32 v126, v126
v_exp_f32 v127, v127
v_cvt_pk_bf16_f32 v150, v124, v125
v_cvt_pk_bf16_f32 v151, v126, v127
v_exp_f32 v128, v128
v_exp_f32 v129, v129
v_mfma_f32_32x32x16_bf16 v[48:63], v[212:215], v[148:151], v[48:63]
v_exp_f32 v130, v130
v_exp_f32 v131, v131
v_cvt_pk_bf16_f32 v144, v128, v129
v_cvt_pk_bf16_f32 v145, v130, v131
v_mfma_f32_32x32x16_bf16 v[112:127], v[200:203], v[32:35], 0
v_exp_f32 v132, v132
v_exp_f32 v133, v133
v_exp_f32 v134, v134
v_exp_f32 v135, v135
v_cvt_pk_bf16_f32 v146, v132, v133
v_cvt_pk_bf16_f32 v147, v134, v135
v_mfma_f32_32x32x16_bf16 v[112:127], v[204:207], v[36:39], v[112:127]
v_exp_f32 v136, v136
v_exp_f32 v137, v137
v_exp_f32 v138, v138
v_exp_f32 v139, v139
v_cvt_pk_bf16_f32 v148, v136, v137
v_cvt_pk_bf16_f32 v149, v138, v139
v_mfma_f32_32x32x16_bf16 v[64:79], v[208:211], v[144:147], v[64:79]
v_exp_f32 v140, v140
v_exp_f32 v141, v141
v_exp_f32 v142, v142
v_exp_f32 v143, v143
v_cvt_pk_bf16_f32 v150, v140, v141
v_cvt_pk_bf16_f32 v151, v142, v143
v_exp_f32 v112, v112
v_exp_f32 v113, v113
v_mfma_f32_32x32x16_bf16 v[64:79], v[212:215], v[148:151], v[64:79]
v_exp_f32 v114, v114
v_exp_f32 v115, v115
v_cvt_pk_bf16_f32 v144, v112, v113
v_cvt_pk_bf16_f32 v145, v114, v115
v_mfma_f32_32x32x16_bf16 v[128:143], v[200:203], v[40:43], 0
v_exp_f32 v116, v116
v_exp_f32 v117, v117
v_exp_f32 v118, v118
v_exp_f32 v119, v119
v_cvt_pk_bf16_f32 v146, v116, v117
v_cvt_pk_bf16_f32 v147, v118, v119
v_mfma_f32_32x32x16_bf16 v[128:143], v[204:207], v[44:47], v[128:143]
v_exp_f32 v120, v120
v_exp_f32 v121, v121
v_exp_f32 v122, v122
v_exp_f32 v123, v123
v_cvt_pk_bf16_f32 v148, v120, v121
v_cvt_pk_bf16_f32 v149, v122, v123
v_mfma_f32_32x32x16_bf16 v[80:95], v[208:211], v[144:147], v[80:95]
v_exp_f32 v124, v124
v_exp_f32 v125, v125
v_exp_f32 v126, v126
v_exp_f32 v127, v127
v_cvt_pk_bf16_f32 v150, v124, v125
v_cvt_pk_bf16_f32 v151, v126, v127
v_exp_f32 v128, v128
v_exp_f32 v129, v129
s_waitcnt vmcnt(12)
v_mfma_f32_32x32x16_bf16 v[80:95], v[212:215], v[148:151], v[80:95]
v_exp_f32 v130, v130
v_exp_f32 v131, v131
v_cvt_pk_bf16_f32 v144, v128, v129
v_cvt_pk_bf16_f32 v145, v130, v131
v_mfma_f32_32x32x16_bf16 v[112:127], v[216:219], v[16:19], 0
v_exp_f32 v132, v132
v_exp_f32 v133, v133
v_exp_f32 v134, v134
v_exp_f32 v135, v135
v_cvt_pk_bf16_f32 v146, v132, v133
v_cvt_pk_bf16_f32 v147, v134, v135
v_mfma_f32_32x32x16_bf16 v[112:127], v[220:223], v[20:23], v[112:127]
v_exp_f32 v136, v136
v_exp_f32 v137, v137
v_exp_f32 v138, v138
v_exp_f32 v139, v139
v_cvt_pk_bf16_f32 v148, v136, v137
v_cvt_pk_bf16_f32 v149, v138, v139
v_mfma_f32_32x32x16_bf16 v[96:111], v[208:211], v[144:147], v[96:111]
v_exp_f32 v140, v140
v_exp_f32 v141, v141
v_exp_f32 v142, v142
v_exp_f32 v143, v143
v_cvt_pk_bf16_f32 v150, v140, v141
v_cvt_pk_bf16_f32 v151, v142, v143
v_exp_f32 v112, v112
v_exp_f32 v113, v113
v_mfma_f32_32x32x16_bf16 v[96:111], v[212:215], v[148:151], v[96:111]
s_add_u32 s42, s40, 16384
buffer_load_dwordx4 v[200:203], v2, s[8:11], s42 offen offset:0 sc1
v_exp_f32 v114, v114
v_exp_f32 v115, v115
v_cvt_pk_bf16_f32 v144, v112, v113
v_cvt_pk_bf16_f32 v145, v114, v115
v_mfma_f32_32x32x16_bf16 v[128:143], v[216:219], v[24:27], 0
buffer_load_dwordx4 v[204:207], v2, s[8:11], s42 offen offset:1024 sc1
v_exp_f32 v116, v116
v_exp_f32 v117, v117
v_exp_f32 v118, v118
v_exp_f32 v119, v119
v_cvt_pk_bf16_f32 v146, v116, v117
v_cvt_pk_bf16_f32 v147, v118, v119
v_mfma_f32_32x32x16_bf16 v[128:143], v[220:223], v[28:31], v[128:143]
s_add_u32 s43, s41, 16384
buffer_load_dwordx4 v[208:211], v2, s[8:11], s43 offen offset:0 sc1
v_exp_f32 v120, v120
v_exp_f32 v121, v121
v_exp_f32 v122, v122
v_exp_f32 v123, v123
v_cvt_pk_bf16_f32 v148, v120, v121
v_cvt_pk_bf16_f32 v149, v122, v123
v_mfma_f32_32x32x16_bf16 v[48:63], v[224:227], v[144:147], v[48:63]
buffer_load_dwordx4 v[212:215], v2, s[8:11], s43 offen offset:1024 sc1
v_exp_f32 v124, v124
v_exp_f32 v125, v125
v_exp_f32 v126, v126
v_exp_f32 v127, v127
v_cvt_pk_bf16_f32 v150, v124, v125
v_cvt_pk_bf16_f32 v151, v126, v127
v_exp_f32 v128, v128
v_exp_f32 v129, v129
v_mfma_f32_32x32x16_bf16 v[48:63], v[228:231], v[148:151], v[48:63]
v_exp_f32 v130, v130
v_exp_f32 v131, v131
v_cvt_pk_bf16_f32 v144, v128, v129
v_cvt_pk_bf16_f32 v145, v130, v131
v_mfma_f32_32x32x16_bf16 v[112:127], v[216:219], v[32:35], 0
v_exp_f32 v132, v132
v_exp_f32 v133, v133
v_exp_f32 v134, v134
v_exp_f32 v135, v135
v_cvt_pk_bf16_f32 v146, v132, v133
v_cvt_pk_bf16_f32 v147, v134, v135
v_mfma_f32_32x32x16_bf16 v[112:127], v[220:223], v[36:39], v[112:127]
v_exp_f32 v136, v136
v_exp_f32 v137, v137
v_exp_f32 v138, v138
v_exp_f32 v139, v139
v_cvt_pk_bf16_f32 v148, v136, v137
v_cvt_pk_bf16_f32 v149, v138, v139
v_mfma_f32_32x32x16_bf16 v[64:79], v[224:227], v[144:147], v[64:79]
v_exp_f32 v140, v140
v_exp_f32 v141, v141
v_exp_f32 v142, v142
v_exp_f32 v143, v143
v_cvt_pk_bf16_f32 v150, v140, v141
v_cvt_pk_bf16_f32 v151, v142, v143
v_exp_f32 v112, v112
v_exp_f32 v113, v113
v_mfma_f32_32x32x16_bf16 v[64:79], v[228:231], v[148:151], v[64:79]
v_exp_f32 v114, v114
v_exp_f32 v115, v115
v_cvt_pk_bf16_f32 v144, v112, v113
v_cvt_pk_bf16_f32 v145, v114, v115
v_mfma_f32_32x32x16_bf16 v[128:143], v[216:219], v[40:43], 0
v_exp_f32 v116, v116
v_exp_f32 v117, v117
v_exp_f32 v118, v118
v_exp_f32 v119, v119
v_cvt_pk_bf16_f32 v146, v116, v117
v_cvt_pk_bf16_f32 v147, v118, v119
v_mfma_f32_32x32x16_bf16 v[128:143], v[220:223], v[44:47], v[128:143]
v_exp_f32 v120, v120
v_exp_f32 v121, v121
v_exp_f32 v122, v122
v_exp_f32 v123, v123
v_cvt_pk_bf16_f32 v148, v120, v121
v_cvt_pk_bf16_f32 v149, v122, v123
v_mfma_f32_32x32x16_bf16 v[80:95], v[224:227], v[144:147], v[80:95]
v_exp_f32 v124, v124
v_exp_f32 v125, v125
v_exp_f32 v126, v126
v_exp_f32 v127, v127
v_cvt_pk_bf16_f32 v150, v124, v125
v_cvt_pk_bf16_f32 v151, v126, v127
v_exp_f32 v128, v128
v_exp_f32 v129, v129
s_waitcnt vmcnt(12)
v_mfma_f32_32x32x16_bf16 v[80:95], v[228:231], v[148:151], v[80:95]
v_exp_f32 v130, v130
v_exp_f32 v131, v131
v_cvt_pk_bf16_f32 v144, v128, v129
v_cvt_pk_bf16_f32 v145, v130, v131
v_mfma_f32_32x32x16_bf16 v[112:127], v[152:155], v[16:19], 0
v_exp_f32 v132, v132
v_exp_f32 v133, v133
v_exp_f32 v134, v134
v_exp_f32 v135, v135
v_cvt_pk_bf16_f32 v146, v132, v133
v_cvt_pk_bf16_f32 v147, v134, v135
v_mfma_f32_32x32x16_bf16 v[112:127], v[156:159], v[20:23], v[112:127]
v_exp_f32 v136, v136
v_exp_f32 v137, v137
v_exp_f32 v138, v138
v_exp_f32 v139, v139
v_cvt_pk_bf16_f32 v148, v136, v137
v_cvt_pk_bf16_f32 v149, v138, v139
v_mfma_f32_32x32x16_bf16 v[96:111], v[224:227], v[144:147], v[96:111]
v_exp_f32 v140, v140
v_exp_f32 v141, v141
v_exp_f32 v142, v142
v_exp_f32 v143, v143
v_cvt_pk_bf16_f32 v150, v140, v141
v_cvt_pk_bf16_f32 v151, v142, v143
v_exp_f32 v112, v112
v_exp_f32 v113, v113
v_mfma_f32_32x32x16_bf16 v[96:111], v[228:231], v[148:151], v[96:111]
s_add_u32 s42, s40, 18432
buffer_load_dwordx4 v[216:219], v2, s[8:11], s42 offen offset:0 sc1
v_exp_f32 v114, v114
v_exp_f32 v115, v115
v_cvt_pk_bf16_f32 v144, v112, v113
v_cvt_pk_bf16_f32 v145, v114, v115
v_mfma_f32_32x32x16_bf16 v[128:143], v[152:155], v[24:27], 0
buffer_load_dwordx4 v[220:223], v2, s[8:11], s42 offen offset:1024 sc1
v_exp_f32 v116, v116
v_exp_f32 v117, v117
v_exp_f32 v118, v118
v_exp_f32 v119, v119
v_cvt_pk_bf16_f32 v146, v116, v117
v_cvt_pk_bf16_f32 v147, v118, v119
v_mfma_f32_32x32x16_bf16 v[128:143], v[156:159], v[28:31], v[128:143]
s_add_u32 s43, s41, 18432
buffer_load_dwordx4 v[224:227], v2, s[8:11], s43 offen offset:0 sc1
v_exp_f32 v120, v120
v_exp_f32 v121, v121
v_exp_f32 v122, v122
v_exp_f32 v123, v123
v_cvt_pk_bf16_f32 v148, v120, v121
v_cvt_pk_bf16_f32 v149, v122, v123
v_mfma_f32_32x32x16_bf16 v[48:63], v[160:163], v[144:147], v[48:63]
buffer_load_dwordx4 v[228:231], v2, s[8:11], s43 offen offset:1024 sc1
v_exp_f32 v124, v124
v_exp_f32 v125, v125
v_exp_f32 v126, v126
v_exp_f32 v127, v127
v_cvt_pk_bf16_f32 v150, v124, v125
v_cvt_pk_bf16_f32 v151, v126, v127
v_exp_f32 v128, v128
v_exp_f32 v129, v129
v_mfma_f32_32x32x16_bf16 v[48:63], v[164:167], v[148:151], v[48:63]
v_exp_f32 v130, v130
v_exp_f32 v131, v131
v_cvt_pk_bf16_f32 v144, v128, v129
v_cvt_pk_bf16_f32 v145, v130, v131
v_mfma_f32_32x32x16_bf16 v[112:127], v[152:155], v[32:35], 0
v_exp_f32 v132, v132
v_exp_f32 v133, v133
v_exp_f32 v134, v134
v_exp_f32 v135, v135
v_cvt_pk_bf16_f32 v146, v132, v133
v_cvt_pk_bf16_f32 v147, v134, v135
v_mfma_f32_32x32x16_bf16 v[112:127], v[156:159], v[36:39], v[112:127]
v_exp_f32 v136, v136
v_exp_f32 v137, v137
v_exp_f32 v138, v138
v_exp_f32 v139, v139
v_cvt_pk_bf16_f32 v148, v136, v137
v_cvt_pk_bf16_f32 v149, v138, v139
v_mfma_f32_32x32x16_bf16 v[64:79], v[160:163], v[144:147], v[64:79]
v_exp_f32 v140, v140
v_exp_f32 v141, v141
v_exp_f32 v142, v142
v_exp_f32 v143, v143
v_cvt_pk_bf16_f32 v150, v140, v141
v_cvt_pk_bf16_f32 v151, v142, v143
v_exp_f32 v112, v112
v_exp_f32 v113, v113
v_mfma_f32_32x32x16_bf16 v[64:79], v[164:167], v[148:151], v[64:79]
v_exp_f32 v114, v114
v_exp_f32 v115, v115
v_cvt_pk_bf16_f32 v144, v112, v113
v_cvt_pk_bf16_f32 v145, v114, v115
v_mfma_f32_32x32x16_bf16 v[128:143], v[152:155], v[40:43], 0
v_exp_f32 v116, v116
v_exp_f32 v117, v117
v_exp_f32 v118, v118
v_exp_f32 v119, v119
v_cvt_pk_bf16_f32 v146, v116, v117
v_cvt_pk_bf16_f32 v147, v118, v119
v_mfma_f32_32x32x16_bf16 v[128:143], v[156:159], v[44:47], v[128:143]
v_exp_f32 v120, v120
v_exp_f32 v121, v121
v_exp_f32 v122, v122
v_exp_f32 v123, v123
v_cvt_pk_bf16_f32 v148, v120, v121
v_cvt_pk_bf16_f32 v149, v122, v123
v_mfma_f32_32x32x16_bf16 v[80:95], v[160:163], v[144:147], v[80:95]
v_exp_f32 v124, v124
v_exp_f32 v125, v125
v_exp_f32 v126, v126
v_exp_f32 v127, v127
v_cvt_pk_bf16_f32 v150, v124, v125
v_cvt_pk_bf16_f32 v151, v126, v127
v_exp_f32 v128, v128
v_exp_f32 v129, v129
s_waitcnt vmcnt(12)
v_mfma_f32_32x32x16_bf16 v[80:95], v[164:167], v[148:151], v[80:95]
v_exp_f32 v130, v130
v_exp_f32 v131, v131
v_cvt_pk_bf16_f32 v144, v128, v129
v_cvt_pk_bf16_f32 v145, v130, v131
v_mfma_f32_32x32x16_bf16 v[112:127], v[168:171], v[16:19], 0
v_exp_f32 v132, v132
v_exp_f32 v133, v133
v_exp_f32 v134, v134
v_exp_f32 v135, v135
v_cvt_pk_bf16_f32 v146, v132, v133
v_cvt_pk_bf16_f32 v147, v134, v135
v_mfma_f32_32x32x16_bf16 v[112:127], v[172:175], v[20:23], v[112:127]
v_exp_f32 v136, v136
v_exp_f32 v137, v137
v_exp_f32 v138, v138
v_exp_f32 v139, v139
v_cvt_pk_bf16_f32 v148, v136, v137
v_cvt_pk_bf16_f32 v149, v138, v139
v_mfma_f32_32x32x16_bf16 v[96:111], v[160:163], v[144:147], v[96:111]
v_exp_f32 v140, v140
v_exp_f32 v141, v141
v_exp_f32 v142, v142
v_exp_f32 v143, v143
v_cvt_pk_bf16_f32 v150, v140, v141
v_cvt_pk_bf16_f32 v151, v142, v143
v_exp_f32 v112, v112
v_exp_f32 v113, v113
v_mfma_f32_32x32x16_bf16 v[96:111], v[164:167], v[148:151], v[96:111]
s_add_u32 s42, s40, 20480
buffer_load_dwordx4 v[152:155], v2, s[8:11], s42 offen offset:0 sc1
v_exp_f32 v114, v114
v_exp_f32 v115, v115
v_cvt_pk_bf16_f32 v144, v112, v113
v_cvt_pk_bf16_f32 v145, v114, v115
v_mfma_f32_32x32x16_bf16 v[128:143], v[168:171], v[24:27], 0
buffer_load_dwordx4 v[156:159], v2, s[8:11], s42 offen offset:1024 sc1
v_exp_f32 v116, v116
v_exp_f32 v117, v117
v_exp_f32 v118, v118
v_exp_f32 v119, v119
v_cvt_pk_bf16_f32 v146, v116, v117
v_cvt_pk_bf16_f32 v147, v118, v119
v_mfma_f32_32x32x16_bf16 v[128:143], v[172:175], v[28:31], v[128:143]
s_add_u32 s43, s41, 20480
buffer_load_dwordx4 v[160:163], v2, s[8:11], s43 offen offset:0 sc1
v_exp_f32 v120, v120
v_exp_f32 v121, v121
v_exp_f32 v122, v122
v_exp_f32 v123, v123
v_cvt_pk_bf16_f32 v148, v120, v121
v_cvt_pk_bf16_f32 v149, v122, v123
v_mfma_f32_32x32x16_bf16 v[48:63], v[176:179], v[144:147], v[48:63]
buffer_load_dwordx4 v[164:167], v2, s[8:11], s43 offen offset:1024 sc1
v_exp_f32 v124, v124
v_exp_f32 v125, v125
v_exp_f32 v126, v126
v_exp_f32 v127, v127
v_cvt_pk_bf16_f32 v150, v124, v125
v_cvt_pk_bf16_f32 v151, v126, v127
v_exp_f32 v128, v128
v_exp_f32 v129, v129
v_mfma_f32_32x32x16_bf16 v[48:63], v[180:183], v[148:151], v[48:63]
v_exp_f32 v130, v130
v_exp_f32 v131, v131
v_cvt_pk_bf16_f32 v144, v128, v129
v_cvt_pk_bf16_f32 v145, v130, v131
v_mfma_f32_32x32x16_bf16 v[112:127], v[168:171], v[32:35], 0
v_exp_f32 v132, v132
v_exp_f32 v133, v133
v_exp_f32 v134, v134
v_exp_f32 v135, v135
v_cvt_pk_bf16_f32 v146, v132, v133
v_cvt_pk_bf16_f32 v147, v134, v135
v_mfma_f32_32x32x16_bf16 v[112:127], v[172:175], v[36:39], v[112:127]
v_exp_f32 v136, v136
v_exp_f32 v137, v137
v_exp_f32 v138, v138
v_exp_f32 v139, v139
v_cvt_pk_bf16_f32 v148, v136, v137
v_cvt_pk_bf16_f32 v149, v138, v139
v_mfma_f32_32x32x16_bf16 v[64:79], v[176:179], v[144:147], v[64:79]
v_exp_f32 v140, v140
v_exp_f32 v141, v141
v_exp_f32 v142, v142
v_exp_f32 v143, v143
v_cvt_pk_bf16_f32 v150, v140, v141
v_cvt_pk_bf16_f32 v151, v142, v143
v_exp_f32 v112, v112
v_exp_f32 v113, v113
v_mfma_f32_32x32x16_bf16 v[64:79], v[180:183], v[148:151], v[64:79]
v_exp_f32 v114, v114
v_exp_f32 v115, v115
v_cvt_pk_bf16_f32 v144, v112, v113
v_cvt_pk_bf16_f32 v145, v114, v115
v_mfma_f32_32x32x16_bf16 v[128:143], v[168:171], v[40:43], 0
v_exp_f32 v116, v116
v_exp_f32 v117, v117
v_exp_f32 v118, v118
v_exp_f32 v119, v119
v_cvt_pk_bf16_f32 v146, v116, v117
v_cvt_pk_bf16_f32 v147, v118, v119
v_mfma_f32_32x32x16_bf16 v[128:143], v[172:175], v[44:47], v[128:143]
v_exp_f32 v120, v120
v_exp_f32 v121, v121
v_exp_f32 v122, v122
v_exp_f32 v123, v123
v_cvt_pk_bf16_f32 v148, v120, v121
v_cvt_pk_bf16_f32 v149, v122, v123
v_mfma_f32_32x32x16_bf16 v[80:95], v[176:179], v[144:147], v[80:95]
v_exp_f32 v124, v124
v_exp_f32 v125, v125
v_exp_f32 v126, v126
v_exp_f32 v127, v127
v_cvt_pk_bf16_f32 v150, v124, v125
v_cvt_pk_bf16_f32 v151, v126, v127
v_exp_f32 v128, v128
v_exp_f32 v129, v129
s_waitcnt vmcnt(12)
v_mfma_f32_32x32x16_bf16 v[80:95], v[180:183], v[148:151], v[80:95]
v_exp_f32 v130, v130
v_exp_f32 v131, v131
v_cvt_pk_bf16_f32 v144, v128, v129
v_cvt_pk_bf16_f32 v145, v130, v131
v_mfma_f32_32x32x16_bf16 v[112:127], v[184:187], v[16:19], 0
v_exp_f32 v132, v132
v_exp_f32 v133, v133
v_exp_f32 v134, v134
v_exp_f32 v135, v135
v_cvt_pk_bf16_f32 v146, v132, v133
v_cvt_pk_bf16_f32 v147, v134, v135
v_mfma_f32_32x32x16_bf16 v[112:127], v[188:191], v[20:23], v[112:127]
v_exp_f32 v136, v136
v_exp_f32 v137, v137
v_exp_f32 v138, v138
v_exp_f32 v139, v139
v_cvt_pk_bf16_f32 v148, v136, v137
v_cvt_pk_bf16_f32 v149, v138, v139
v_mfma_f32_32x32x16_bf16 v[96:111], v[176:179], v[144:147], v[96:111]
v_exp_f32 v140, v140
v_exp_f32 v141, v141
v_exp_f32 v142, v142
v_exp_f32 v143, v143
v_cvt_pk_bf16_f32 v150, v140, v141
v_cvt_pk_bf16_f32 v151, v142, v143
v_exp_f32 v112, v112
v_exp_f32 v113, v113
v_mfma_f32_32x32x16_bf16 v[96:111], v[180:183], v[148:151], v[96:111]
s_add_u32 s42, s40, 22528
buffer_load_dwordx4 v[168:171], v2, s[8:11], s42 offen offset:0 sc1
v_exp_f32 v114, v114
v_exp_f32 v115, v115
v_cvt_pk_bf16_f32 v144, v112, v113
v_cvt_pk_bf16_f32 v145, v114, v115
v_mfma_f32_32x32x16_bf16 v[128:143], v[184:187], v[24:27], 0
buffer_load_dwordx4 v[172:175], v2, s[8:11], s42 offen offset:1024 sc1
v_exp_f32 v116, v116
v_exp_f32 v117, v117
v_exp_f32 v118, v118
v_exp_f32 v119, v119
v_cvt_pk_bf16_f32 v146, v116, v117
v_cvt_pk_bf16_f32 v147, v118, v119
v_mfma_f32_32x32x16_bf16 v[128:143], v[188:191], v[28:31], v[128:143]
s_add_u32 s43, s41, 22528
buffer_load_dwordx4 v[176:179], v2, s[8:11], s43 offen offset:0 sc1
v_exp_f32 v120, v120
v_exp_f32 v121, v121
v_exp_f32 v122, v122
v_exp_f32 v123, v123
v_cvt_pk_bf16_f32 v148, v120, v121
v_cvt_pk_bf16_f32 v149, v122, v123
v_mfma_f32_32x32x16_bf16 v[48:63], v[192:195], v[144:147], v[48:63]
buffer_load_dwordx4 v[180:183], v2, s[8:11], s43 offen offset:1024 sc1
v_exp_f32 v124, v124
v_exp_f32 v125, v125
v_exp_f32 v126, v126
v_exp_f32 v127, v127
v_cvt_pk_bf16_f32 v150, v124, v125
v_cvt_pk_bf16_f32 v151, v126, v127
v_exp_f32 v128, v128
v_exp_f32 v129, v129
v_mfma_f32_32x32x16_bf16 v[48:63], v[196:199], v[148:151], v[48:63]
v_exp_f32 v130, v130
v_exp_f32 v131, v131
v_cvt_pk_bf16_f32 v144, v128, v129
v_cvt_pk_bf16_f32 v145, v130, v131
v_mfma_f32_32x32x16_bf16 v[112:127], v[184:187], v[32:35], 0
v_exp_f32 v132, v132
v_exp_f32 v133, v133
v_exp_f32 v134, v134
v_exp_f32 v135, v135
v_cvt_pk_bf16_f32 v146, v132, v133
v_cvt_pk_bf16_f32 v147, v134, v135
v_mfma_f32_32x32x16_bf16 v[112:127], v[188:191], v[36:39], v[112:127]
v_exp_f32 v136, v136
v_exp_f32 v137, v137
v_exp_f32 v138, v138
v_exp_f32 v139, v139
v_cvt_pk_bf16_f32 v148, v136, v137
v_cvt_pk_bf16_f32 v149, v138, v139
v_mfma_f32_32x32x16_bf16 v[64:79], v[192:195], v[144:147], v[64:79]
v_exp_f32 v140, v140
v_exp_f32 v141, v141
v_exp_f32 v142, v142
v_exp_f32 v143, v143
v_cvt_pk_bf16_f32 v150, v140, v141
v_cvt_pk_bf16_f32 v151, v142, v143
v_exp_f32 v112, v112
v_exp_f32 v113, v113
v_mfma_f32_32x32x16_bf16 v[64:79], v[196:199], v[148:151], v[64:79]
v_exp_f32 v114, v114
v_exp_f32 v115, v115
v_cvt_pk_bf16_f32 v144, v112, v113
v_cvt_pk_bf16_f32 v145, v114, v115
v_mfma_f32_32x32x16_bf16 v[128:143], v[184:187], v[40:43], 0
v_exp_f32 v116, v116
v_exp_f32 v117, v117
v_exp_f32 v118, v118
v_exp_f32 v119, v119
v_cvt_pk_bf16_f32 v146, v116, v117
v_cvt_pk_bf16_f32 v147, v118, v119
v_mfma_f32_32x32x16_bf16 v[128:143], v[188:191], v[44:47], v[128:143]
v_exp_f32 v120, v120
v_exp_f32 v121, v121
v_exp_f32 v122, v122
v_exp_f32 v123, v123
v_cvt_pk_bf16_f32 v148, v120, v121
v_cvt_pk_bf16_f32 v149, v122, v123
v_mfma_f32_32x32x16_bf16 v[80:95], v[192:195], v[144:147], v[80:95]
v_exp_f32 v124, v124
v_exp_f32 v125, v125
v_exp_f32 v126, v126
v_exp_f32 v127, v127
v_cvt_pk_bf16_f32 v150, v124, v125
v_cvt_pk_bf16_f32 v151, v126, v127
v_exp_f32 v128, v128
v_exp_f32 v129, v129
s_waitcnt vmcnt(12)
v_mfma_f32_32x32x16_bf16 v[80:95], v[196:199], v[148:151], v[80:95]
v_exp_f32 v130, v130
v_exp_f32 v131, v131
v_cvt_pk_bf16_f32 v144, v128, v129
v_cvt_pk_bf16_f32 v145, v130, v131
v_mfma_f32_32x32x16_bf16 v[112:127], v[200:203], v[16:19], 0
v_exp_f32 v132, v132
v_exp_f32 v133, v133
v_exp_f32 v134, v134
v_exp_f32 v135, v135
v_cvt_pk_bf16_f32 v146, v132, v133
v_cvt_pk_bf16_f32 v147, v134, v135
v_mfma_f32_32x32x16_bf16 v[112:127], v[204:207], v[20:23], v[112:127]
v_exp_f32 v136, v136
v_exp_f32 v137, v137
v_exp_f32 v138, v138
v_exp_f32 v139, v139
v_cvt_pk_bf16_f32 v148, v136, v137
v_cvt_pk_bf16_f32 v149, v138, v139
v_mfma_f32_32x32x16_bf16 v[96:111], v[192:195], v[144:147], v[96:111]
v_exp_f32 v140, v140
v_exp_f32 v141, v141
v_exp_f32 v142, v142
v_exp_f32 v143, v143
v_cvt_pk_bf16_f32 v150, v140, v141
v_cvt_pk_bf16_f32 v151, v142, v143
v_exp_f32 v112, v112
v_exp_f32 v113, v113
v_mfma_f32_32x32x16_bf16 v[96:111], v[196:199], v[148:151], v[96:111]
s_add_u32 s42, s40, 24576
buffer_load_dwordx4 v[184:187], v2, s[8:11], s42 offen offset:0 sc1
v_exp_f32 v114, v114
v_exp_f32 v115, v115
v_cvt_pk_bf16_f32 v144, v112, v113
v_cvt_pk_bf16_f32 v145, v114, v115
v_mfma_f32_32x32x16_bf16 v[128:143], v[200:203], v[24:27], 0
buffer_load_dwordx4 v[188:191], v2, s[8:11], s42 offen offset:1024 sc1
v_exp_f32 v116, v116
v_exp_f32 v117, v117
v_exp_f32 v118, v118
v_exp_f32 v119, v119
v_cvt_pk_bf16_f32 v146, v116, v117
v_cvt_pk_bf16_f32 v147, v118, v119
v_mfma_f32_32x32x16_bf16 v[128:143], v[204:207], v[28:31], v[128:143]
s_add_u32 s43, s41, 24576
buffer_load_dwordx4 v[192:195], v2, s[8:11], s43 offen offset:0 sc1
v_exp_f32 v120, v120
v_exp_f32 v121, v121
v_exp_f32 v122, v122
v_exp_f32 v123, v123
v_cvt_pk_bf16_f32 v148, v120, v121
v_cvt_pk_bf16_f32 v149, v122, v123
v_mfma_f32_32x32x16_bf16 v[48:63], v[208:211], v[144:147], v[48:63]
buffer_load_dwordx4 v[196:199], v2, s[8:11], s43 offen offset:1024 sc1
v_exp_f32 v124, v124
v_exp_f32 v125, v125
v_exp_f32 v126, v126
v_exp_f32 v127, v127
v_cvt_pk_bf16_f32 v150, v124, v125
v_cvt_pk_bf16_f32 v151, v126, v127
v_exp_f32 v128, v128
v_exp_f32 v129, v129
v_mfma_f32_32x32x16_bf16 v[48:63], v[212:215], v[148:151], v[48:63]
v_exp_f32 v130, v130
v_exp_f32 v131, v131
v_cvt_pk_bf16_f32 v144, v128, v129
v_cvt_pk_bf16_f32 v145, v130, v131
v_mfma_f32_32x32x16_bf16 v[112:127], v[200:203], v[32:35], 0
v_exp_f32 v132, v132
v_exp_f32 v133, v133
v_exp_f32 v134, v134
v_exp_f32 v135, v135
v_cvt_pk_bf16_f32 v146, v132, v133
v_cvt_pk_bf16_f32 v147, v134, v135
v_mfma_f32_32x32x16_bf16 v[112:127], v[204:207], v[36:39], v[112:127]
v_exp_f32 v136, v136
v_exp_f32 v137, v137
v_exp_f32 v138, v138
v_exp_f32 v139, v139
v_cvt_pk_bf16_f32 v148, v136, v137
v_cvt_pk_bf16_f32 v149, v138, v139
v_mfma_f32_32x32x16_bf16 v[64:79], v[208:211], v[144:147], v[64:79]
v_exp_f32 v140, v140
v_exp_f32 v141, v141
v_exp_f32 v142, v142
v_exp_f32 v143, v143
v_cvt_pk_bf16_f32 v150, v140, v141
v_cvt_pk_bf16_f32 v151, v142, v143
v_exp_f32 v112, v112
v_exp_f32 v113, v113
v_mfma_f32_32x32x16_bf16 v[64:79], v[212:215], v[148:151], v[64:79]
v_exp_f32 v114, v114
v_exp_f32 v115, v115
v_cvt_pk_bf16_f32 v144, v112, v113
v_cvt_pk_bf16_f32 v145, v114, v115
v_mfma_f32_32x32x16_bf16 v[128:143], v[200:203], v[40:43], 0
v_exp_f32 v116, v116
v_exp_f32 v117, v117
v_exp_f32 v118, v118
v_exp_f32 v119, v119
v_cvt_pk_bf16_f32 v146, v116, v117
v_cvt_pk_bf16_f32 v147, v118, v119
v_mfma_f32_32x32x16_bf16 v[128:143], v[204:207], v[44:47], v[128:143]
v_exp_f32 v120, v120
v_exp_f32 v121, v121
v_exp_f32 v122, v122
v_exp_f32 v123, v123
v_cvt_pk_bf16_f32 v148, v120, v121
v_cvt_pk_bf16_f32 v149, v122, v123
v_mfma_f32_32x32x16_bf16 v[80:95], v[208:211], v[144:147], v[80:95]
v_exp_f32 v124, v124
v_exp_f32 v125, v125
v_exp_f32 v126, v126
v_exp_f32 v127, v127
v_cvt_pk_bf16_f32 v150, v124, v125
v_cvt_pk_bf16_f32 v151, v126, v127
v_exp_f32 v128, v128
v_exp_f32 v129, v129
s_waitcnt vmcnt(12)
v_mfma_f32_32x32x16_bf16 v[80:95], v[212:215], v[148:151], v[80:95]
v_exp_f32 v130, v130
v_exp_f32 v131, v131
v_cvt_pk_bf16_f32 v144, v128, v129
v_cvt_pk_bf16_f32 v145, v130, v131
v_mfma_f32_32x32x16_bf16 v[112:127], v[216:219], v[16:19], 0
v_exp_f32 v132, v132
v_exp_f32 v133, v133
v_exp_f32 v134, v134
v_exp_f32 v135, v135
v_cvt_pk_bf16_f32 v146, v132, v133
v_cvt_pk_bf16_f32 v147, v134, v135
v_mfma_f32_32x32x16_bf16 v[112:127], v[220:223], v[20:23], v[112:127]
v_exp_f32 v136, v136
v_exp_f32 v137, v137
v_exp_f32 v138, v138
v_exp_f32 v139, v139
v_cvt_pk_bf16_f32 v148, v136, v137
v_cvt_pk_bf16_f32 v149, v138, v139
v_mfma_f32_32x32x16_bf16 v[96:111], v[208:211], v[144:147], v[96:111]
v_exp_f32 v140, v140
v_exp_f32 v141, v141
v_exp_f32 v142, v142
v_exp_f32 v143, v143
v_cvt_pk_bf16_f32 v150, v140, v141
v_cvt_pk_bf16_f32 v151, v142, v143
v_exp_f32 v112, v112
v_exp_f32 v113, v113
v_mfma_f32_32x32x16_bf16 v[96:111], v[212:215], v[148:151], v[96:111]
s_add_u32 s42, s40, 26624
buffer_load_dwordx4 v[200:203], v2, s[8:11], s42 offen offset:0 sc1
v_exp_f32 v114, v114
v_exp_f32 v115, v115
v_cvt_pk_bf16_f32 v144, v112, v113
v_cvt_pk_bf16_f32 v145, v114, v115
v_mfma_f32_32x32x16_bf16 v[128:143], v[216:219], v[24:27], 0
buffer_load_dwordx4 v[204:207], v2, s[8:11], s42 offen offset:1024 sc1
v_exp_f32 v116, v116
v_exp_f32 v117, v117
v_exp_f32 v118, v118
v_exp_f32 v119, v119
v_cvt_pk_bf16_f32 v146, v116, v117
v_cvt_pk_bf16_f32 v147, v118, v119
v_mfma_f32_32x32x16_bf16 v[128:143], v[220:223], v[28:31], v[128:143]
s_add_u32 s43, s41, 26624
buffer_load_dwordx4 v[208:211], v2, s[8:11], s43 offen offset:0 sc1
v_exp_f32 v120, v120
v_exp_f32 v121, v121
v_exp_f32 v122, v122
v_exp_f32 v123, v123
v_cvt_pk_bf16_f32 v148, v120, v121
v_cvt_pk_bf16_f32 v149, v122, v123
v_mfma_f32_32x32x16_bf16 v[48:63], v[224:227], v[144:147], v[48:63]
buffer_load_dwordx4 v[212:215], v2, s[8:11], s43 offen offset:1024 sc1
v_exp_f32 v124, v124
v_exp_f32 v125, v125
v_exp_f32 v126, v126
v_exp_f32 v127, v127
v_cvt_pk_bf16_f32 v150, v124, v125
v_cvt_pk_bf16_f32 v151, v126, v127
v_exp_f32 v128, v128
v_exp_f32 v129, v129
v_mfma_f32_32x32x16_bf16 v[48:63], v[228:231], v[148:151], v[48:63]
v_exp_f32 v130, v130
v_exp_f32 v131, v131
v_cvt_pk_bf16_f32 v144, v128, v129
v_cvt_pk_bf16_f32 v145, v130, v131
v_mfma_f32_32x32x16_bf16 v[112:127], v[216:219], v[32:35], 0
v_exp_f32 v132, v132
v_exp_f32 v133, v133
v_exp_f32 v134, v134
v_exp_f32 v135, v135
v_cvt_pk_bf16_f32 v146, v132, v133
v_cvt_pk_bf16_f32 v147, v134, v135
v_mfma_f32_32x32x16_bf16 v[112:127], v[220:223], v[36:39], v[112:127]
v_exp_f32 v136, v136
v_exp_f32 v137, v137
v_exp_f32 v138, v138
v_exp_f32 v139, v139
v_cvt_pk_bf16_f32 v148, v136, v137
v_cvt_pk_bf16_f32 v149, v138, v139
v_mfma_f32_32x32x16_bf16 v[64:79], v[224:227], v[144:147], v[64:79]
v_exp_f32 v140, v140
v_exp_f32 v141, v141
v_exp_f32 v142, v142
v_exp_f32 v143, v143
v_cvt_pk_bf16_f32 v150, v140, v141
v_cvt_pk_bf16_f32 v151, v142, v143
v_exp_f32 v112, v112
v_exp_f32 v113, v113
v_mfma_f32_32x32x16_bf16 v[64:79], v[228:231], v[148:151], v[64:79]
v_exp_f32 v114, v114
v_exp_f32 v115, v115
v_cvt_pk_bf16_f32 v144, v112, v113
v_cvt_pk_bf16_f32 v145, v114, v115
v_mfma_f32_32x32x16_bf16 v[128:143], v[216:219], v[40:43], 0
v_exp_f32 v116, v116
v_exp_f32 v117, v117
v_exp_f32 v118, v118
v_exp_f32 v119, v119
v_cvt_pk_bf16_f32 v146, v116, v117
v_cvt_pk_bf16_f32 v147, v118, v119
v_mfma_f32_32x32x16_bf16 v[128:143], v[220:223], v[44:47], v[128:143]
v_exp_f32 v120, v120
v_exp_f32 v121, v121
v_exp_f32 v122, v122
v_exp_f32 v123, v123
v_cvt_pk_bf16_f32 v148, v120, v121
v_cvt_pk_bf16_f32 v149, v122, v123
v_mfma_f32_32x32x16_bf16 v[80:95], v[224:227], v[144:147], v[80:95]
v_exp_f32 v124, v124
v_exp_f32 v125, v125
v_exp_f32 v126, v126
v_exp_f32 v127, v127
v_cvt_pk_bf16_f32 v150, v124, v125
v_cvt_pk_bf16_f32 v151, v126, v127
v_exp_f32 v128, v128
v_exp_f32 v129, v129
s_waitcnt vmcnt(12)
v_mfma_f32_32x32x16_bf16 v[80:95], v[228:231], v[148:151], v[80:95]
v_exp_f32 v130, v130
v_exp_f32 v131, v131
v_cvt_pk_bf16_f32 v144, v128, v129
v_cvt_pk_bf16_f32 v145, v130, v131
v_mfma_f32_32x32x16_bf16 v[112:127], v[152:155], v[16:19], 0
v_exp_f32 v132, v132
v_exp_f32 v133, v133
v_exp_f32 v134, v134
v_exp_f32 v135, v135
v_cvt_pk_bf16_f32 v146, v132, v133
v_cvt_pk_bf16_f32 v147, v134, v135
v_mfma_f32_32x32x16_bf16 v[112:127], v[156:159], v[20:23], v[112:127]
v_exp_f32 v136, v136
v_exp_f32 v137, v137
v_exp_f32 v138, v138
v_exp_f32 v139, v139
v_cvt_pk_bf16_f32 v148, v136, v137
v_cvt_pk_bf16_f32 v149, v138, v139
v_mfma_f32_32x32x16_bf16 v[96:111], v[224:227], v[144:147], v[96:111]
v_exp_f32 v140, v140
v_exp_f32 v141, v141
v_exp_f32 v142, v142
v_exp_f32 v143, v143
v_cvt_pk_bf16_f32 v150, v140, v141
v_cvt_pk_bf16_f32 v151, v142, v143
v_exp_f32 v112, v112
v_exp_f32 v113, v113
v_mfma_f32_32x32x16_bf16 v[96:111], v[228:231], v[148:151], v[96:111]
s_add_u32 s42, s40, 28672
buffer_load_dwordx4 v[216:219], v2, s[8:11], s42 offen offset:0 sc1
v_exp_f32 v114, v114
v_exp_f32 v115, v115
v_cvt_pk_bf16_f32 v144, v112, v113
v_cvt_pk_bf16_f32 v145, v114, v115
v_mfma_f32_32x32x16_bf16 v[128:143], v[152:155], v[24:27], 0
buffer_load_dwordx4 v[220:223], v2, s[8:11], s42 offen offset:1024 sc1
v_exp_f32 v116, v116
v_exp_f32 v117, v117
v_exp_f32 v118, v118
v_exp_f32 v119, v119
v_cvt_pk_bf16_f32 v146, v116, v117
v_cvt_pk_bf16_f32 v147, v118, v119
v_mfma_f32_32x32x16_bf16 v[128:143], v[156:159], v[28:31], v[128:143]
s_add_u32 s43, s41, 28672
buffer_load_dwordx4 v[224:227], v2, s[8:11], s43 offen offset:0 sc1
v_exp_f32 v120, v120
v_exp_f32 v121, v121
v_exp_f32 v122, v122
v_exp_f32 v123, v123
v_cvt_pk_bf16_f32 v148, v120, v121
v_cvt_pk_bf16_f32 v149, v122, v123
v_mfma_f32_32x32x16_bf16 v[48:63], v[160:163], v[144:147], v[48:63]
buffer_load_dwordx4 v[228:231], v2, s[8:11], s43 offen offset:1024 sc1
v_exp_f32 v124, v124
v_exp_f32 v125, v125
v_exp_f32 v126, v126
v_exp_f32 v127, v127
v_cvt_pk_bf16_f32 v150, v124, v125
v_cvt_pk_bf16_f32 v151, v126, v127
v_exp_f32 v128, v128
v_exp_f32 v129, v129
v_mfma_f32_32x32x16_bf16 v[48:63], v[164:167], v[148:151], v[48:63]
v_exp_f32 v130, v130
v_exp_f32 v131, v131
v_cvt_pk_bf16_f32 v144, v128, v129
v_cvt_pk_bf16_f32 v145, v130, v131
v_mfma_f32_32x32x16_bf16 v[112:127], v[152:155], v[32:35], 0
v_exp_f32 v132, v132
v_exp_f32 v133, v133
v_exp_f32 v134, v134
v_exp_f32 v135, v135
v_cvt_pk_bf16_f32 v146, v132, v133
v_cvt_pk_bf16_f32 v147, v134, v135
v_mfma_f32_32x32x16_bf16 v[112:127], v[156:159], v[36:39], v[112:127]
v_exp_f32 v136, v136
v_exp_f32 v137, v137
v_exp_f32 v138, v138
v_exp_f32 v139, v139
v_cvt_pk_bf16_f32 v148, v136, v137
v_cvt_pk_bf16_f32 v149, v138, v139
v_mfma_f32_32x32x16_bf16 v[64:79], v[160:163], v[144:147], v[64:79]
v_exp_f32 v140, v140
v_exp_f32 v141, v141
v_exp_f32 v142, v142
v_exp_f32 v143, v143
v_cvt_pk_bf16_f32 v150, v140, v141
v_cvt_pk_bf16_f32 v151, v142, v143
v_exp_f32 v112, v112
v_exp_f32 v113, v113
v_mfma_f32_32x32x16_bf16 v[64:79], v[164:167], v[148:151], v[64:79]
v_exp_f32 v114, v114
v_exp_f32 v115, v115
v_cvt_pk_bf16_f32 v144, v112, v113
v_cvt_pk_bf16_f32 v145, v114, v115
v_mfma_f32_32x32x16_bf16 v[128:143], v[152:155], v[40:43], 0
v_exp_f32 v116, v116
v_exp_f32 v117, v117
v_exp_f32 v118, v118
v_exp_f32 v119, v119
v_cvt_pk_bf16_f32 v146, v116, v117
v_cvt_pk_bf16_f32 v147, v118, v119
v_mfma_f32_32x32x16_bf16 v[128:143], v[156:159], v[44:47], v[128:143]
v_exp_f32 v120, v120
v_exp_f32 v121, v121
v_exp_f32 v122, v122
v_exp_f32 v123, v123
v_cvt_pk_bf16_f32 v148, v120, v121
v_cvt_pk_bf16_f32 v149, v122, v123
v_mfma_f32_32x32x16_bf16 v[80:95], v[160:163], v[144:147], v[80:95]
v_exp_f32 v124, v124
v_exp_f32 v125, v125
v_exp_f32 v126, v126
v_exp_f32 v127, v127
v_cvt_pk_bf16_f32 v150, v124, v125
v_cvt_pk_bf16_f32 v151, v126, v127
v_exp_f32 v128, v128
v_exp_f32 v129, v129
s_waitcnt vmcnt(12)
v_mfma_f32_32x32x16_bf16 v[80:95], v[164:167], v[148:151], v[80:95]
v_exp_f32 v130, v130
v_exp_f32 v131, v131
v_cvt_pk_bf16_f32 v144, v128, v129
v_cvt_pk_bf16_f32 v145, v130, v131
v_mfma_f32_32x32x16_bf16 v[112:127], v[168:171], v[16:19], 0
v_exp_f32 v132, v132
v_exp_f32 v133, v133
v_exp_f32 v134, v134
v_exp_f32 v135, v135
v_cvt_pk_bf16_f32 v146, v132, v133
v_cvt_pk_bf16_f32 v147, v134, v135
v_mfma_f32_32x32x16_bf16 v[112:127], v[172:175], v[20:23], v[112:127]
v_exp_f32 v136, v136
v_exp_f32 v137, v137
v_exp_f32 v138, v138
v_exp_f32 v139, v139
v_cvt_pk_bf16_f32 v148, v136, v137
v_cvt_pk_bf16_f32 v149, v138, v139
v_mfma_f32_32x32x16_bf16 v[96:111], v[160:163], v[144:147], v[96:111]
v_exp_f32 v140, v140
v_exp_f32 v141, v141
v_exp_f32 v142, v142
v_exp_f32 v143, v143
v_cvt_pk_bf16_f32 v150, v140, v141
v_cvt_pk_bf16_f32 v151, v142, v143
v_exp_f32 v112, v112
v_exp_f32 v113, v113
v_mfma_f32_32x32x16_bf16 v[96:111], v[164:167], v[148:151], v[96:111]
s_add_u32 s42, s40, 30720
buffer_load_dwordx4 v[152:155], v2, s[8:11], s42 offen offset:0 sc1
v_exp_f32 v114, v114
v_exp_f32 v115, v115
v_cvt_pk_bf16_f32 v144, v112, v113
v_cvt_pk_bf16_f32 v145, v114, v115
v_mfma_f32_32x32x16_bf16 v[128:143], v[168:171], v[24:27], 0
buffer_load_dwordx4 v[156:159], v2, s[8:11], s42 offen offset:1024 sc1
v_exp_f32 v116, v116
v_exp_f32 v117, v117
v_exp_f32 v118, v118
v_exp_f32 v119, v119
v_cvt_pk_bf16_f32 v146, v116, v117
v_cvt_pk_bf16_f32 v147, v118, v119
v_mfma_f32_32x32x16_bf16 v[128:143], v[172:175], v[28:31], v[128:143]
s_add_u32 s43, s41, 30720
buffer_load_dwordx4 v[160:163], v2, s[8:11], s43 offen offset:0 sc1
v_exp_f32 v120, v120
v_exp_f32 v121, v121
v_exp_f32 v122, v122
v_exp_f32 v123, v123
v_cvt_pk_bf16_f32 v148, v120, v121
v_cvt_pk_bf16_f32 v149, v122, v123
v_mfma_f32_32x32x16_bf16 v[48:63], v[176:179], v[144:147], v[48:63]
buffer_load_dwordx4 v[164:167], v2, s[8:11], s43 offen offset:1024 sc1
v_exp_f32 v124, v124
v_exp_f32 v125, v125
v_exp_f32 v126, v126
v_exp_f32 v127, v127
v_cvt_pk_bf16_f32 v150, v124, v125
v_cvt_pk_bf16_f32 v151, v126, v127
v_exp_f32 v128, v128
v_exp_f32 v129, v129
v_mfma_f32_32x32x16_bf16 v[48:63], v[180:183], v[148:151], v[48:63]
v_exp_f32 v130, v130
v_exp_f32 v131, v131
v_cvt_pk_bf16_f32 v144, v128, v129
v_cvt_pk_bf16_f32 v145, v130, v131
v_mfma_f32_32x32x16_bf16 v[112:127], v[168:171], v[32:35], 0
v_exp_f32 v132, v132
v_exp_f32 v133, v133
v_exp_f32 v134, v134
v_exp_f32 v135, v135
v_cvt_pk_bf16_f32 v146, v132, v133
v_cvt_pk_bf16_f32 v147, v134, v135
v_mfma_f32_32x32x16_bf16 v[112:127], v[172:175], v[36:39], v[112:127]
v_exp_f32 v136, v136
v_exp_f32 v137, v137
v_exp_f32 v138, v138
v_exp_f32 v139, v139
v_cvt_pk_bf16_f32 v148, v136, v137
v_cvt_pk_bf16_f32 v149, v138, v139
v_mfma_f32_32x32x16_bf16 v[64:79], v[176:179], v[144:147], v[64:79]
v_exp_f32 v140, v140
v_exp_f32 v141, v141
v_exp_f32 v142, v142
v_exp_f32 v143, v143
v_cvt_pk_bf16_f32 v150, v140, v141
v_cvt_pk_bf16_f32 v151, v142, v143
v_exp_f32 v112, v112
v_exp_f32 v113, v113
v_mfma_f32_32x32x16_bf16 v[64:79], v[180:183], v[148:151], v[64:79]
v_exp_f32 v114, v114
v_exp_f32 v115, v115
v_cvt_pk_bf16_f32 v144, v112, v113
v_cvt_pk_bf16_f32 v145, v114, v115
v_mfma_f32_32x32x16_bf16 v[128:143], v[168:171], v[40:43], 0
v_exp_f32 v116, v116
v_exp_f32 v117, v117
v_exp_f32 v118, v118
v_exp_f32 v119, v119
v_cvt_pk_bf16_f32 v146, v116, v117
v_cvt_pk_bf16_f32 v147, v118, v119
v_mfma_f32_32x32x16_bf16 v[128:143], v[172:175], v[44:47], v[128:143]
v_exp_f32 v120, v120
v_exp_f32 v121, v121
v_exp_f32 v122, v122
v_exp_f32 v123, v123
v_cvt_pk_bf16_f32 v148, v120, v121
v_cvt_pk_bf16_f32 v149, v122, v123
v_mfma_f32_32x32x16_bf16 v[80:95], v[176:179], v[144:147], v[80:95]
v_exp_f32 v124, v124
v_exp_f32 v125, v125
v_exp_f32 v126, v126
v_exp_f32 v127, v127
v_cvt_pk_bf16_f32 v150, v124, v125
v_cvt_pk_bf16_f32 v151, v126, v127
v_exp_f32 v128, v128
v_exp_f32 v129, v129
s_waitcnt vmcnt(12)
v_mfma_f32_32x32x16_bf16 v[80:95], v[180:183], v[148:151], v[80:95]
v_exp_f32 v130, v130
v_exp_f32 v131, v131
v_cvt_pk_bf16_f32 v144, v128, v129
v_cvt_pk_bf16_f32 v145, v130, v131
v_mfma_f32_32x32x16_bf16 v[112:127], v[184:187], v[16:19], 0
v_exp_f32 v132, v132
v_exp_f32 v133, v133
v_exp_f32 v134, v134
v_exp_f32 v135, v135
v_cvt_pk_bf16_f32 v146, v132, v133
v_cvt_pk_bf16_f32 v147, v134, v135
v_mfma_f32_32x32x16_bf16 v[112:127], v[188:191], v[20:23], v[112:127]
v_exp_f32 v136, v136
v_exp_f32 v137, v137
v_exp_f32 v138, v138
v_exp_f32 v139, v139
v_cvt_pk_bf16_f32 v148, v136, v137
v_cvt_pk_bf16_f32 v149, v138, v139
v_mfma_f32_32x32x16_bf16 v[96:111], v[176:179], v[144:147], v[96:111]
v_exp_f32 v140, v140
v_exp_f32 v141, v141
v_exp_f32 v142, v142
v_exp_f32 v143, v143
v_cvt_pk_bf16_f32 v150, v140, v141
v_cvt_pk_bf16_f32 v151, v142, v143
v_exp_f32 v112, v112
v_exp_f32 v113, v113
v_mfma_f32_32x32x16_bf16 v[96:111], v[180:183], v[148:151], v[96:111]
v_exp_f32 v114, v114
v_exp_f32 v115, v115
v_cvt_pk_bf16_f32 v144, v112, v113
v_cvt_pk_bf16_f32 v145, v114, v115
v_mfma_f32_32x32x16_bf16 v[128:143], v[184:187], v[24:27], 0
v_exp_f32 v116, v116
v_exp_f32 v117, v117
v_exp_f32 v118, v118
v_exp_f32 v119, v119
v_cvt_pk_bf16_f32 v146, v116, v117
v_cvt_pk_bf16_f32 v147, v118, v119
v_mfma_f32_32x32x16_bf16 v[128:143], v[188:191], v[28:31], v[128:143]
v_exp_f32 v120, v120
v_exp_f32 v121, v121
v_exp_f32 v122, v122
v_exp_f32 v123, v123
v_cvt_pk_bf16_f32 v148, v120, v121
v_cvt_pk_bf16_f32 v149, v122, v123
v_mfma_f32_32x32x16_bf16 v[48:63], v[192:195], v[144:147], v[48:63]
v_exp_f32 v124, v124
v_exp_f32 v125, v125
v_exp_f32 v126, v126
v_exp_f32 v127, v127
v_cvt_pk_bf16_f32 v150, v124, v125
v_cvt_pk_bf16_f32 v151, v126, v127
v_exp_f32 v128, v128
v_exp_f32 v129, v129
v_mfma_f32_32x32x16_bf16 v[48:63], v[196:199], v[148:151], v[48:63]
v_exp_f32 v130, v130
v_exp_f32 v131, v131
v_cvt_pk_bf16_f32 v144, v128, v129
v_cvt_pk_bf16_f32 v145, v130, v131
v_mfma_f32_32x32x16_bf16 v[112:127], v[184:187], v[32:35], 0
v_exp_f32 v132, v132
v_exp_f32 v133, v133
v_exp_f32 v134, v134
v_exp_f32 v135, v135
v_cvt_pk_bf16_f32 v146, v132, v133
v_cvt_pk_bf16_f32 v147, v134, v135
v_mfma_f32_32x32x16_bf16 v[112:127], v[188:191], v[36:39], v[112:127]
v_exp_f32 v136, v136
v_exp_f32 v137, v137
v_exp_f32 v138, v138
v_exp_f32 v139, v139
v_cvt_pk_bf16_f32 v148, v136, v137
v_cvt_pk_bf16_f32 v149, v138, v139
v_mfma_f32_32x32x16_bf16 v[64:79], v[192:195], v[144:147], v[64:79]
v_exp_f32 v140, v140
v_exp_f32 v141, v141
v_exp_f32 v142, v142
v_exp_f32 v143, v143
v_cvt_pk_bf16_f32 v150, v140, v141
v_cvt_pk_bf16_f32 v151, v142, v143
v_exp_f32 v112, v112
v_exp_f32 v113, v113
v_mfma_f32_32x32x16_bf16 v[64:79], v[196:199], v[148:151], v[64:79]
v_exp_f32 v114, v114
v_exp_f32 v115, v115
v_cvt_pk_bf16_f32 v144, v112, v113
v_cvt_pk_bf16_f32 v145, v114, v115
v_mfma_f32_32x32x16_bf16 v[128:143], v[184:187], v[40:43], 0
v_exp_f32 v116, v116
v_exp_f32 v117, v117
v_exp_f32 v118, v118
v_exp_f32 v119, v119
v_cvt_pk_bf16_f32 v146, v116, v117
v_cvt_pk_bf16_f32 v147, v118, v119
v_mfma_f32_32x32x16_bf16 v[128:143], v[188:191], v[44:47], v[128:143]
v_exp_f32 v120, v120
v_exp_f32 v121, v121
v_exp_f32 v122, v122
v_exp_f32 v123, v123
v_cvt_pk_bf16_f32 v148, v120, v121
v_cvt_pk_bf16_f32 v149, v122, v123
v_mfma_f32_32x32x16_bf16 v[80:95], v[192:195], v[144:147], v[80:95]
v_exp_f32 v124, v124
v_exp_f32 v125, v125
v_exp_f32 v126, v126
v_exp_f32 v127, v127
v_cvt_pk_bf16_f32 v150, v124, v125
v_cvt_pk_bf16_f32 v151, v126, v127
v_exp_f32 v128, v128
v_exp_f32 v129, v129
s_waitcnt vmcnt(8)
v_mfma_f32_32x32x16_bf16 v[80:95], v[196:199], v[148:151], v[80:95]
v_exp_f32 v130, v130
v_exp_f32 v131, v131
v_cvt_pk_bf16_f32 v144, v128, v129
v_cvt_pk_bf16_f32 v145, v130, v131
v_mfma_f32_32x32x16_bf16 v[112:127], v[200:203], v[16:19], 0
v_exp_f32 v132, v132
v_exp_f32 v133, v133
v_exp_f32 v134, v134
v_exp_f32 v135, v135
v_cvt_pk_bf16_f32 v146, v132, v133
v_cvt_pk_bf16_f32 v147, v134, v135
v_mfma_f32_32x32x16_bf16 v[112:127], v[204:207], v[20:23], v[112:127]
v_exp_f32 v136, v136
v_exp_f32 v137, v137
v_exp_f32 v138, v138
v_exp_f32 v139, v139
v_cvt_pk_bf16_f32 v148, v136, v137
v_cvt_pk_bf16_f32 v149, v138, v139
v_mfma_f32_32x32x16_bf16 v[96:111], v[192:195], v[144:147], v[96:111]
v_exp_f32 v140, v140
v_exp_f32 v141, v141
v_exp_f32 v142, v142
v_exp_f32 v143, v143
v_cvt_pk_bf16_f32 v150, v140, v141
v_cvt_pk_bf16_f32 v151, v142, v143
v_exp_f32 v112, v112
v_exp_f32 v113, v113
v_mfma_f32_32x32x16_bf16 v[96:111], v[196:199], v[148:151], v[96:111]
v_exp_f32 v114, v114
v_exp_f32 v115, v115
v_cvt_pk_bf16_f32 v144, v112, v113
v_cvt_pk_bf16_f32 v145, v114, v115
v_mfma_f32_32x32x16_bf16 v[128:143], v[200:203], v[24:27], 0
v_exp_f32 v116, v116
v_exp_f32 v117, v117
v_exp_f32 v118, v118
v_exp_f32 v119, v119
v_cvt_pk_bf16_f32 v146, v116, v117
v_cvt_pk_bf16_f32 v147, v118, v119
v_mfma_f32_32x32x16_bf16 v[128:143], v[204:207], v[28:31], v[128:143]
v_exp_f32 v120, v120
v_exp_f32 v121, v121
v_exp_f32 v122, v122
v_exp_f32 v123, v123
v_cvt_pk_bf16_f32 v148, v120, v121
v_cvt_pk_bf16_f32 v149, v122, v123
v_mfma_f32_32x32x16_bf16 v[48:63], v[208:211], v[144:147], v[48:63]
v_exp_f32 v124, v124
v_exp_f32 v125, v125
v_exp_f32 v126, v126
v_exp_f32 v127, v127
v_cvt_pk_bf16_f32 v150, v124, v125
v_cvt_pk_bf16_f32 v151, v126, v127
v_exp_f32 v128, v128
v_exp_f32 v129, v129
v_mfma_f32_32x32x16_bf16 v[48:63], v[212:215], v[148:151], v[48:63]
v_exp_f32 v130, v130
v_exp_f32 v131, v131
v_cvt_pk_bf16_f32 v144, v128, v129
v_cvt_pk_bf16_f32 v145, v130, v131
v_mfma_f32_32x32x16_bf16 v[112:127], v[200:203], v[32:35], 0
v_exp_f32 v132, v132
v_exp_f32 v133, v133
v_exp_f32 v134, v134
v_exp_f32 v135, v135
v_cvt_pk_bf16_f32 v146, v132, v133
v_cvt_pk_bf16_f32 v147, v134, v135
v_mfma_f32_32x32x16_bf16 v[112:127], v[204:207], v[36:39], v[112:127]
v_exp_f32 v136, v136
v_exp_f32 v137, v137
v_exp_f32 v138, v138
v_exp_f32 v139, v139
v_cvt_pk_bf16_f32 v148, v136, v137
v_cvt_pk_bf16_f32 v149, v138, v139
v_mfma_f32_32x32x16_bf16 v[64:79], v[208:211], v[144:147], v[64:79]
v_exp_f32 v140, v140
v_exp_f32 v141, v141
v_exp_f32 v142, v142
v_exp_f32 v143, v143
v_cvt_pk_bf16_f32 v150, v140, v141
v_cvt_pk_bf16_f32 v151, v142, v143
v_exp_f32 v112, v112
v_exp_f32 v113, v113
v_mfma_f32_32x32x16_bf16 v[64:79], v[212:215], v[148:151], v[64:79]
v_exp_f32 v114, v114
v_exp_f32 v115, v115
v_cvt_pk_bf16_f32 v144, v112, v113
v_cvt_pk_bf16_f32 v145, v114, v115
v_mfma_f32_32x32x16_bf16 v[128:143], v[200:203], v[40:43], 0
v_exp_f32 v116, v116
v_exp_f32 v117, v117
v_exp_f32 v118, v118
v_exp_f32 v119, v119
v_cvt_pk_bf16_f32 v146, v116, v117
v_cvt_pk_bf16_f32 v147, v118, v119
v_mfma_f32_32x32x16_bf16 v[128:143], v[204:207], v[44:47], v[128:143]
v_exp_f32 v120, v120
v_exp_f32 v121, v121
v_exp_f32 v122, v122
v_exp_f32 v123, v123
v_cvt_pk_bf16_f32 v148, v120, v121
v_cvt_pk_bf16_f32 v149, v122, v123
v_mfma_f32_32x32x16_bf16 v[80:95], v[208:211], v[144:147], v[80:95]
v_exp_f32 v124, v124
v_exp_f32 v125, v125
v_exp_f32 v126, v126
v_exp_f32 v127, v127
v_cvt_pk_bf16_f32 v150, v124, v125
v_cvt_pk_bf16_f32 v151, v126, v127
v_exp_f32 v128, v128
v_exp_f32 v129, v129
s_waitcnt vmcnt(4)
v_mfma_f32_32x32x16_bf16 v[80:95], v[212:215], v[148:151], v[80:95]
v_exp_f32 v130, v130
v_exp_f32 v131, v131
v_cvt_pk_bf16_f32 v144, v128, v129
v_cvt_pk_bf16_f32 v145, v130, v131
v_mfma_f32_32x32x16_bf16 v[112:127], v[216:219], v[16:19], 0
v_exp_f32 v132, v132
v_exp_f32 v133, v133
v_exp_f32 v134, v134
v_exp_f32 v135, v135
v_cvt_pk_bf16_f32 v146, v132, v133
v_cvt_pk_bf16_f32 v147, v134, v135
v_mfma_f32_32x32x16_bf16 v[112:127], v[220:223], v[20:23], v[112:127]
v_exp_f32 v136, v136
v_exp_f32 v137, v137
v_exp_f32 v138, v138
v_exp_f32 v139, v139
v_cvt_pk_bf16_f32 v148, v136, v137
v_cvt_pk_bf16_f32 v149, v138, v139
v_mfma_f32_32x32x16_bf16 v[96:111], v[208:211], v[144:147], v[96:111]
v_exp_f32 v140, v140
v_exp_f32 v141, v141
v_exp_f32 v142, v142
v_exp_f32 v143, v143
v_cvt_pk_bf16_f32 v150, v140, v141
v_cvt_pk_bf16_f32 v151, v142, v143
v_exp_f32 v112, v112
v_exp_f32 v113, v113
v_mfma_f32_32x32x16_bf16 v[96:111], v[212:215], v[148:151], v[96:111]
v_exp_f32 v114, v114
v_exp_f32 v115, v115
v_cvt_pk_bf16_f32 v144, v112, v113
v_cvt_pk_bf16_f32 v145, v114, v115
v_mfma_f32_32x32x16_bf16 v[128:143], v[216:219], v[24:27], 0
v_exp_f32 v116, v116
v_exp_f32 v117, v117
v_exp_f32 v118, v118
v_exp_f32 v119, v119
v_cvt_pk_bf16_f32 v146, v116, v117
v_cvt_pk_bf16_f32 v147, v118, v119
v_mfma_f32_32x32x16_bf16 v[128:143], v[220:223], v[28:31], v[128:143]
v_exp_f32 v120, v120
v_exp_f32 v121, v121
v_exp_f32 v122, v122
v_exp_f32 v123, v123
v_cvt_pk_bf16_f32 v148, v120, v121
v_cvt_pk_bf16_f32 v149, v122, v123
v_mfma_f32_32x32x16_bf16 v[48:63], v[224:227], v[144:147], v[48:63]
v_exp_f32 v124, v124
v_exp_f32 v125, v125
v_exp_f32 v126, v126
v_exp_f32 v127, v127
v_cvt_pk_bf16_f32 v150, v124, v125
v_cvt_pk_bf16_f32 v151, v126, v127
v_exp_f32 v128, v128
v_exp_f32 v129, v129
v_mfma_f32_32x32x16_bf16 v[48:63], v[228:231], v[148:151], v[48:63]
v_exp_f32 v130, v130
v_exp_f32 v131, v131
v_cvt_pk_bf16_f32 v144, v128, v129
v_cvt_pk_bf16_f32 v145, v130, v131
v_mfma_f32_32x32x16_bf16 v[112:127], v[216:219], v[32:35], 0
v_exp_f32 v132, v132
v_exp_f32 v133, v133
v_exp_f32 v134, v134
v_exp_f32 v135, v135
v_cvt_pk_bf16_f32 v146, v132, v133
v_cvt_pk_bf16_f32 v147, v134, v135
v_mfma_f32_32x32x16_bf16 v[112:127], v[220:223], v[36:39], v[112:127]
v_exp_f32 v136, v136
v_exp_f32 v137, v137
v_exp_f32 v138, v138
v_exp_f32 v139, v139
v_cvt_pk_bf16_f32 v148, v136, v137
v_cvt_pk_bf16_f32 v149, v138, v139
v_mfma_f32_32x32x16_bf16 v[64:79], v[224:227], v[144:147], v[64:79]
v_exp_f32 v140, v140
v_exp_f32 v141, v141
v_exp_f32 v142, v142
v_exp_f32 v143, v143
v_cvt_pk_bf16_f32 v150, v140, v141
v_cvt_pk_bf16_f32 v151, v142, v143
v_exp_f32 v112, v112
v_exp_f32 v113, v113
v_mfma_f32_32x32x16_bf16 v[64:79], v[228:231], v[148:151], v[64:79]
v_exp_f32 v114, v114
v_exp_f32 v115, v115
v_cvt_pk_bf16_f32 v144, v112, v113
v_cvt_pk_bf16_f32 v145, v114, v115
v_mfma_f32_32x32x16_bf16 v[128:143], v[216:219], v[40:43], 0
v_exp_f32 v116, v116
v_exp_f32 v117, v117
v_exp_f32 v118, v118
v_exp_f32 v119, v119
v_cvt_pk_bf16_f32 v146, v116, v117
v_cvt_pk_bf16_f32 v147, v118, v119
v_mfma_f32_32x32x16_bf16 v[128:143], v[220:223], v[44:47], v[128:143]
v_exp_f32 v120, v120
v_exp_f32 v121, v121
v_exp_f32 v122, v122
v_exp_f32 v123, v123
v_cvt_pk_bf16_f32 v148, v120, v121
v_cvt_pk_bf16_f32 v149, v122, v123
v_mfma_f32_32x32x16_bf16 v[80:95], v[224:227], v[144:147], v[80:95]
v_exp_f32 v124, v124
v_exp_f32 v125, v125
v_exp_f32 v126, v126
v_exp_f32 v127, v127
v_cvt_pk_bf16_f32 v150, v124, v125
v_cvt_pk_bf16_f32 v151, v126, v127
v_exp_f32 v128, v128
v_exp_f32 v129, v129
s_waitcnt vmcnt(0)
v_mfma_f32_32x32x16_bf16 v[80:95], v[228:231], v[148:151], v[80:95]
v_exp_f32 v130, v130
v_exp_f32 v131, v131
v_cvt_pk_bf16_f32 v144, v128, v129
v_cvt_pk_bf16_f32 v145, v130, v131
v_mfma_f32_32x32x16_bf16 v[112:127], v[152:155], v[24:27], 0
v_exp_f32 v132, v132
v_exp_f32 v133, v133
v_exp_f32 v134, v134
v_exp_f32 v135, v135
v_cvt_pk_bf16_f32 v146, v132, v133
v_cvt_pk_bf16_f32 v147, v134, v135
v_mfma_f32_32x32x16_bf16 v[112:127], v[156:159], v[28:31], v[112:127]
v_exp_f32 v136, v136
v_exp_f32 v137, v137
v_exp_f32 v138, v138
v_exp_f32 v139, v139
v_cvt_pk_bf16_f32 v148, v136, v137
v_cvt_pk_bf16_f32 v149, v138, v139
v_mfma_f32_32x32x16_bf16 v[96:111], v[224:227], v[144:147], v[96:111]
v_exp_f32 v140, v140
v_exp_f32 v141, v141
v_exp_f32 v142, v142
v_exp_f32 v143, v143
v_cvt_pk_bf16_f32 v150, v140, v141
v_cvt_pk_bf16_f32 v151, v142, v143
v_exp_f32 v112, v112
v_exp_f32 v113, v113
v_mfma_f32_32x32x16_bf16 v[96:111], v[228:231], v[148:151], v[96:111]
v_exp_f32 v114, v114
v_exp_f32 v115, v115
v_cvt_pk_bf16_f32 v144, v112, v113
v_cvt_pk_bf16_f32 v145, v114, v115
v_mfma_f32_32x32x16_bf16 v[128:143], v[152:155], v[32:35], 0
v_exp_f32 v116, v116
v_exp_f32 v117, v117
v_exp_f32 v118, v118
v_exp_f32 v119, v119
v_cvt_pk_bf16_f32 v146, v116, v117
v_cvt_pk_bf16_f32 v147, v118, v119
v_mfma_f32_32x32x16_bf16 v[128:143], v[156:159], v[36:39], v[128:143]
v_exp_f32 v120, v120
v_exp_f32 v121, v121
v_exp_f32 v122, v122
v_exp_f32 v123, v123
v_cvt_pk_bf16_f32 v148, v120, v121
v_cvt_pk_bf16_f32 v149, v122, v123
v_mfma_f32_32x32x16_bf16 v[64:79], v[160:163], v[144:147], v[64:79]
v_exp_f32 v124, v124
v_exp_f32 v125, v125
v_exp_f32 v126, v126
v_exp_f32 v127, v127
v_cvt_pk_bf16_f32 v150, v124, v125
v_cvt_pk_bf16_f32 v151, v126, v127
v_exp_f32 v128, v128
v_exp_f32 v129, v129
v_mfma_f32_32x32x16_bf16 v[64:79], v[164:167], v[148:151], v[64:79]
v_exp_f32 v130, v130
v_exp_f32 v131, v131
v_cvt_pk_bf16_f32 v144, v128, v129
v_cvt_pk_bf16_f32 v145, v130, v131
v_mfma_f32_32x32x16_bf16 v[112:127], v[152:155], v[40:43], 0
v_exp_f32 v132, v132
v_exp_f32 v133, v133
v_exp_f32 v134, v134
v_exp_f32 v135, v135
v_cvt_pk_bf16_f32 v146, v132, v133
v_cvt_pk_bf16_f32 v147, v134, v135
v_mfma_f32_32x32x16_bf16 v[112:127], v[156:159], v[44:47], v[112:127]
v_exp_f32 v136, v136
v_exp_f32 v137, v137
v_exp_f32 v138, v138
v_exp_f32 v139, v139
v_cvt_pk_bf16_f32 v148, v136, v137
v_cvt_pk_bf16_f32 v149, v138, v139
v_mfma_f32_32x32x16_bf16 v[80:95], v[160:163], v[144:147], v[80:95]
v_exp_f32 v140, v140
v_exp_f32 v141, v141
v_exp_f32 v142, v142
v_exp_f32 v143, v143
v_cvt_pk_bf16_f32 v150, v140, v141
v_cvt_pk_bf16_f32 v151, v142, v143
ds_write_b128 v8, v[64:67] offset:0
ds_write_b128 v8, v[68:71] offset:1024
ds_write_b128 v8, v[72:75] offset:2048
ds_write_b128 v8, v[76:79] offset:3072
v_exp_f32 v112, v112
v_exp_f32 v113, v113
v_mfma_f32_32x32x16_bf16 v[80:95], v[164:167], v[148:151], v[80:95]
v_exp_f32 v114, v114
v_exp_f32 v115, v115
v_cvt_pk_bf16_f32 v144, v112, v113
v_cvt_pk_bf16_f32 v145, v114, v115
v_mfma_f32_32x32x16_bf16 v[128:143], v[152:155], v[16:19], 0
v_exp_f32 v116, v116
v_exp_f32 v117, v117
v_exp_f32 v118, v118
v_exp_f32 v119, v119
v_cvt_pk_bf16_f32 v146, v116, v117
v_cvt_pk_bf16_f32 v147, v118, v119
v_mfma_f32_32x32x16_bf16 v[128:143], v[156:159], v[20:23], v[128:143]
v_exp_f32 v120, v120
v_exp_f32 v121, v121
v_exp_f32 v122, v122
v_exp_f32 v123, v123
v_cvt_pk_bf16_f32 v148, v120, v121
v_cvt_pk_bf16_f32 v149, v122, v123
v_mfma_f32_32x32x16_bf16 v[96:111], v[160:163], v[144:147], v[96:111]
v_exp_f32 v124, v124
v_exp_f32 v125, v125
v_exp_f32 v126, v126
v_exp_f32 v127, v127
v_cvt_pk_bf16_f32 v150, v124, v125
v_cvt_pk_bf16_f32 v151, v126, v127
ds_write_b128 v9, v[80:83] offset:0
ds_write_b128 v9, v[84:87] offset:1024
ds_write_b128 v9, v[88:91] offset:2048
ds_write_b128 v9, v[92:95] offset:3072
v_exp_f32 v128, v128
v_exp_f32 v129, v129
v_mfma_f32_32x32x16_bf16 v[96:111], v[164:167], v[148:151], v[96:111]
v_exp_f32 v130, v130
v_exp_f32 v131, v131
v_cvt_pk_bf16_f32 v144, v128, v129
v_cvt_pk_bf16_f32 v145, v130, v131
v_exp_f32 v132, v132
v_exp_f32 v133, v133
v_exp_f32 v134, v134
v_exp_f32 v135, v135
v_cvt_pk_bf16_f32 v146, v132, v133
v_cvt_pk_bf16_f32 v147, v134, v135
v_exp_f32 v136, v136
v_exp_f32 v137, v137
v_exp_f32 v138, v138
v_exp_f32 v139, v139
v_cvt_pk_bf16_f32 v148, v136, v137
v_cvt_pk_bf16_f32 v149, v138, v139
v_mfma_f32_32x32x16_bf16 v[48:63], v[160:163], v[144:147], v[48:63]
v_exp_f32 v140, v140
v_exp_f32 v141, v141
v_exp_f32 v142, v142
v_exp_f32 v143, v143
v_cvt_pk_bf16_f32 v150, v140, v141
v_cvt_pk_bf16_f32 v151, v142, v143
ds_write_b128 v10, v[96:99] offset:0
ds_write_b128 v10, v[100:103] offset:1024
ds_write_b128 v10, v[104:107] offset:2048
ds_write_b128 v10, v[108:111] offset:3072
v_mfma_f32_32x32x16_bf16 v[48:63], v[164:167], v[148:151], v[48:63]
v_lshlrev_b32 v2, 4, v1
s_waitcnt lgkmcnt(0)
s_barrier
ds_read_b128 v[112:115], v11 offset:0
ds_read_b128 v[116:119], v11 offset:1024
ds_read_b128 v[120:123], v11 offset:2048
ds_read_b128 v[124:127], v11 offset:3072
ds_read_b128 v[128:131], v11 offset:4096
ds_read_b128 v[132:135], v11 offset:5120
ds_read_b128 v[136:139], v11 offset:6144
ds_read_b128 v[140:143], v11 offset:7168
ds_read_b128 v[144:147], v11 offset:8192
ds_read_b128 v[148:151], v11 offset:9216
ds_read_b128 v[152:155], v11 offset:10240
ds_read_b128 v[156:159], v11 offset:11264
s_waitcnt lgkmcnt(8)
v_add_f32 v48, v48, v112
v_add_f32 v49, v49, v113
v_add_f32 v50, v50, v114
v_add_f32 v51, v51, v115
v_add_f32 v52, v52, v116
v_add_f32 v53, v53, v117
v_add_f32 v54, v54, v118
v_add_f32 v55, v55, v119
v_add_f32 v56, v56, v120
v_add_f32 v57, v57, v121
v_add_f32 v58, v58, v122
v_add_f32 v59, v59, v123
v_add_f32 v60, v60, v124
v_add_f32 v61, v61, v125
v_add_f32 v62, v62, v126
v_add_f32 v63, v63, v127
s_waitcnt lgkmcnt(4)
v_add_f32 v48, v48, v128
v_add_f32 v49, v49, v129
v_add_f32 v50, v50, v130
v_add_f32 v51, v51, v131
v_add_f32 v52, v52, v132
v_add_f32 v53, v53, v133
v_add_f32 v54, v54, v134
v_add_f32 v55, v55, v135
v_add_f32 v56, v56, v136
v_add_f32 v57, v57, v137
v_add_f32 v58, v58, v138
v_add_f32 v59, v59, v139
v_add_f32 v60, v60, v140
v_add_f32 v61, v61, v141
v_add_f32 v62, v62, v142
v_add_f32 v63, v63, v143
s_waitcnt lgkmcnt(0)
v_add_f32 v48, v48, v144
v_add_f32 v49, v49, v145
v_add_f32 v50, v50, v146
v_add_f32 v51, v51, v147
v_add_f32 v52, v52, v148
v_add_f32 v53, v53, v149
v_add_f32 v54, v54, v150
v_add_f32 v55, v55, v151
v_add_f32 v56, v56, v152
v_add_f32 v57, v57, v153
v_add_f32 v58, v58, v154
v_add_f32 v59, v59, v155
v_add_f32 v60, v60, v156
v_add_f32 v61, v61, v157
v_add_f32 v62, v62, v158
v_add_f32 v63, v63, v159
v_mov_b32 v5, v60
v_mov_b32 v6, v60
s_nop 1
v_permlane32_swap_b32 v5, v6
v_mov_b32 v10, v6
v_rcp_f32 v6, v6
s_nop 0
v_mul_f32 v48, v48, v6
v_mul_f32 v49, v49, v6
v_mul_f32 v50, v50, v6
v_mul_f32 v51, v51, v6
v_mul_f32 v52, v52, v6
v_mul_f32 v53, v53, v6
v_mul_f32 v54, v54, v6
v_mul_f32 v55, v55, v6
v_mul_f32 v56, v56, v6
v_mul_f32 v57, v57, v6
v_mul_f32 v58, v58, v6
v_mul_f32 v59, v59, v6
v_mul_f32 v60, v60, v6
v_mul_f32 v61, v61, v6
v_mul_f32 v62, v62, v6
v_mul_f32 v63, v63, v6
v_cvt_pk_bf16_f32 v16, v48, v49
v_cvt_pk_bf16_f32 v17, v50, v51
v_cvt_pk_bf16_f32 v18, v52, v53
v_cvt_pk_bf16_f32 v19, v54, v55
v_cvt_pk_bf16_f32 v20, v56, v57
v_cvt_pk_bf16_f32 v21, v58, v59
v_cvt_pk_bf16_f32 v22, v60, v61
v_cvt_pk_bf16_f32 v23, v62, v63
v_cmp_lt_u32 vcc, 31, v1
v_mov_b32 v4, 0
s_nop 0
v_cndmask_b32 v22, v22, v4, vcc
v_cndmask_b32 v23, v23, v4, vcc
s_lshl_b32 s28, s7, 2
s_add_u32 s28, s28, s3
s_lshl_b32 s28, s28, 4
s_add_u32 s28, s28, s6
s_lshl_b32 s28, s28, 11
s_add_u32 s28, s28, 7340032
buffer_store_dwordx4 v[16:19], v2, s[8:11], s28 offen sc1
buffer_store_dwordx4 v[20:23], v2, s[8:11], s28 offen offset:1024 sc1
s_branch adaLN_cond__softmax_full_mha__glu_gated_geglu__prompt_kernel_exact_done
.section .rodata,"a"
.p2align 6
.amdhsa_kernel adaLN_cond__softmax_full_mha__glu_gated_geglu__prompt_kernel
  .amdhsa_next_free_vgpr 512
  .amdhsa_next_free_sgpr 100
  .amdhsa_accum_offset 256
  .amdhsa_group_segment_fixed_size 0
  .amdhsa_kernarg_size 96
  .amdhsa_user_sgpr_count 2
  .amdhsa_user_sgpr_kernarg_segment_ptr 1
  .amdhsa_system_sgpr_workgroup_id_x 1
  .amdhsa_float_denorm_mode_32 3
.end_amdhsa_kernel
```
